```python
import torch

def _softmax(x, axis=-1):
    return torch.softmax(x, dim=axis)
def _gelu(x):
    return torch.nn.functional.gelu(x, approximate="tanh")
def _silu(x):
    return torch.nn.functional.silu(x)
def _sigmoid(x):
    return torch.sigmoid(x)
def _layernorm(x, axis=-1, eps=1e-5):
    m = x.mean(dim=axis, keepdim=True)
    v = x.var(dim=axis, keepdim=True, unbiased=False)
    return (x - m) / torch.sqrt(v + eps)
def _scatter_add(tgt, idx, src, axis=0):
    return tgt.clone().index_add_(axis, idx, src)
def _segment_sum(src, seg, n):
    out = torch.zeros((n,) + src.shape[1:], dtype=src.dtype)
    return out.index_add_(0, seg, src)
def _pad(x, pw):
    flat = tuple(v for pair in reversed(pw) for v in pair)
    return torch.nn.functional.pad(x, flat)

kernel_name = 'concat_heads__mha_block_cached__mha_block_cached__near_ridge'

def setup_inputs():

    _w = (lambda a: (lambda t: t.to(torch.bfloat16) if t.is_floating_point() else t)(torch.as_tensor(a)))
    def _A_setup():
        B, Sq, D = 32, 64, 512
        H, Sk, Dh = 32, 512, 128
        return {
            "x": _w((lambda *s: torch.randn(*s, dtype=torch.bfloat16) * 0.8)(B, Sq, D)),
            "k_cache": _w((lambda *s: torch.randn(*s, dtype=torch.bfloat16) * 0.8)(B, H, Sk, Dh)),
            "v_cache": _w((lambda *s: torch.randn(*s, dtype=torch.bfloat16) * 0.05)(B, H, Sk, Dh)),
            "wq": _w((lambda *s: torch.randn(*s, dtype=torch.bfloat16) * 0.8)(D, H * Dh) * (D ** -0.5)),
            "wo": _w((lambda *s: torch.randn(*s, dtype=torch.bfloat16) * 0.05)(H * Dh, D) * ((H * Dh) ** -0.5)),
        }
    _A_in = _A_setup()

    def _B_setup():
        B, Sq, D = 32, 64, 512
        H, Sk, Dh = 32, 512, 128
        return {
            "x": _w((lambda *s: torch.randn(*s, dtype=torch.bfloat16) * 0.8)(B, Sq, D)),
            "k_cache": _w((lambda *s: torch.randn(*s, dtype=torch.bfloat16) * 0.8)(B, H, Sk, Dh)),
            "v_cache": _w((lambda *s: torch.randn(*s, dtype=torch.bfloat16) * 0.05)(B, H, Sk, Dh)),
            "wq": _w((lambda *s: torch.randn(*s, dtype=torch.bfloat16) * 0.8)(D, H * Dh) * (D ** -0.5)),
            "wo": _w((lambda *s: torch.randn(*s, dtype=torch.bfloat16) * 0.05)(H * Dh, D) * ((H * Dh) ** -0.5)),
        }
    _B_in = _B_setup()

    return {
        "A_x": _A_in["x"],
        "A_k_cache": _A_in["k_cache"],
        "A_v_cache": _A_in["v_cache"],
        "A_wq": _A_in["wq"],
        "A_wo": _A_in["wo"],
        "B_x": _B_in["x"],
        "B_k_cache": _B_in["k_cache"],
        "B_v_cache": _B_in["v_cache"],
        "B_wq": _B_in["wq"],
        "B_wo": _B_in["wo"],
    }

def reference(A_x, A_k_cache, A_v_cache, A_wq, A_wo, B_x, B_k_cache, B_v_cache, B_wq, B_wo):
    def _A_ref(x, k_cache, v_cache, wq, wo):
        B, Sq, D = x.shape
        H, Dh = 32, 128
        q = (lambda x, *d: x.permute(*d))((x @ wq).reshape(B, Sq, H, Dh), 0, 2, 1, 3)
        scores = torch.einsum("bhqd,bhkd->bhqk", q, k_cache) * (Dh ** -0.5)
        p = _softmax(scores, axis=-1)
        o = torch.einsum("bhqk,bhkd->bhqd", p, v_cache)
        return (lambda x, *d: x.permute(*d))(o, 0, 2, 1, 3).reshape(B, Sq, H * Dh) @ wo

    def _B_ref(x, k_cache, v_cache, wq, wo):
        B, Sq, D = x.shape
        H, Dh = 32, 128
        q = (lambda x, *d: x.permute(*d))((x @ wq).reshape(B, Sq, H, Dh), 0, 2, 1, 3)
        scores = torch.einsum("bhqd,bhkd->bhqk", q, k_cache) * (Dh ** -0.5)
        p = _softmax(scores, axis=-1)
        o = torch.einsum("bhqk,bhkd->bhqd", p, v_cache)
        return (lambda x, *d: x.permute(*d))(o, 0, 2, 1, 3).reshape(B, Sq, H * Dh) @ wo

    a = _A_ref(A_x, A_k_cache, A_v_cache, A_wq, A_wo)
    b = _B_ref(B_x, B_k_cache, B_v_cache, B_wq, B_wo)
    return torch.concatenate([a, b], axis=-1)
```

```asm
; @launch grid=(256,1,1) block=(256,1,1) lds=163840
.amdgcn_target "amdgcn-amd-amdhsa--gfx950"
.text
.globl concat_heads__mha_block_cached__mha_block_cached__near_ridge_kernel
.p2align 8
.type concat_heads__mha_block_cached__mha_block_cached__near_ridge_kernel,@function
concat_heads__mha_block_cached__mha_block_cached__near_ridge_kernel:
s_cmp_ge_u32 s2, 256
s_cbranch_scc1 L_end
s_load_dwordx16 s[36:51], s[0:1], 0
s_load_dwordx4 s[52:55], s[0:1], 64
s_load_dwordx2 s[56:57], s[0:1], 96
v_lshrrev_b32 v33, 6, v0
v_and_b32 v1, 63, v0
v_lshlrev_b32 v25, 7, v1
v_readfirstlane_b32 s28, v33
v_lshlrev_b32 v26, 4, v1
s_lshr_b32 s29, s2, 3
s_lshr_b32 s30, s2, 2
s_and_b32 s30, s30, 1
s_and_b32 s31, s2, 3
s_mul_i32 s32, s28, 40960
s_mov_b32 s62, 0x3e0293ee
s_mov_b32 s67, 0x429cd760
s_lshl_b32 s59, s31, 3
s_lshl_b32 s60, s28, 1
s_add_u32 s59, s59, s60
s_lshl_b32 s35, s59, 8
s_lshl_b32 s60, s29, 5
s_add_u32 s60, s60, s59
s_lshl_b32 s33, s60, 17
s_mov_b32 s34, s33
s_lshl_b32 s66, s31, 20
s_lshl_b32 s60, s28, 8
s_add_u32 s66, s66, s60
s_mov_b32 s64, 0
s_mov_b32 s65, 0
s_lshl_b32 s59, s30, 5
s_add_u32 s59, s59, s29
s_lshl_b32 s59, s59, 2
s_add_u32 s59, s59, s31
s_lshl_b32 s59, s59, 2
s_add_u32 s59, s59, s28
s_lshl_b32 s68, s59, 15
s_lshl_b32 s58, s29, 16
s_lshl_b32 s59, s28, 14
s_add_u32 s58, s58, s59
v_lshrrev_b32 v33, 4, v1
v_and_b32 v35, 15, v1
v_lshlrev_b32 v240, 2, v33
v_xor_b32 v240, v240, v35
v_lshlrev_b32 v240, 4, v240
v_lshl_add_u32 v22, v33, 8, v240
v_lshl_add_u32 v23, v33, 13, v240
v_lshl_add_u32 v24, v33, 10, v240
v_lshlrev_b32 v241, 7, v35
v_lshl_add_u32 v241, v33, 13, v241
s_lshl_b32 s61, s29, 4
s_lshl_b32 s60, s28, 2
s_add_u32 s61, s61, s60
s_lshl_b32 s61, s61, 13
s_lshl_b32 s60, s31, 11
s_add_u32 s61, s61, s60
s_waitcnt lgkmcnt(0)
s_cmp_eq_u32 s30, 0
s_cselect_b32 s20, s36, s46
s_cselect_b32 s21, s37, s47
s_mov_b32 s22, 0x200000
s_mov_b32 s23, 0x20000
s_cselect_b32 s4, s38, s48
s_cselect_b32 s5, s39, s49
s_mov_b32 s6, 0x8000000
s_mov_b32 s7, 0x20000
s_cselect_b32 s8, s40, s50
s_cselect_b32 s9, s41, s51
s_mov_b32 s10, 0x8000000
s_mov_b32 s11, 0x20000
s_cselect_b32 s12, s42, s52
s_cselect_b32 s13, s43, s53
s_mov_b32 s14, 0x400000
s_mov_b32 s15, 0x20000
s_cselect_b32 s16, s44, s54
s_cselect_b32 s17, s45, s55
s_mov_b32 s18, 0x400000
s_mov_b32 s19, 0x20000
s_mov_b32 s24, s56
s_mov_b32 s25, s57
s_mov_b32 s26, 0x4000000
s_mov_b32 s27, 0x20000
s_mov_b32 s54, 0
s_and_b32 s69, s29, 15
v_mov_b32 v30, 0
buffer_load_dword v37, v30, s[4:7], s33 offen nt
buffer_load_dword v37, v30, s[8:11], s34 offen nt
s_add_u32 m0, s32, 24576
s_add_u32 s59, s58, 0
v_xor_b32 v242, 0, v26
buffer_load_dwordx4 v242, s[20:23], s59 offen offset:0 nt lds
v_xor_b32 v242, 16, v26
buffer_load_dwordx4 v242, s[20:23], s59 offen offset:1024 nt lds
v_xor_b32 v242, 32, v26
buffer_load_dwordx4 v242, s[20:23], s59 offen offset:2048 nt lds
v_xor_b32 v242, 48, v26
buffer_load_dwordx4 v242, s[20:23], s59 offen offset:3072 nt lds
s_add_u32 m0, s32, 28672
s_add_u32 s59, s58, 4096
v_xor_b32 v242, 64, v26
buffer_load_dwordx4 v242, s[20:23], s59 offen offset:0 nt lds
v_xor_b32 v242, 80, v26
buffer_load_dwordx4 v242, s[20:23], s59 offen offset:1024 nt lds
v_xor_b32 v242, 96, v26
buffer_load_dwordx4 v242, s[20:23], s59 offen offset:2048 nt lds
v_xor_b32 v242, 112, v26
buffer_load_dwordx4 v242, s[20:23], s59 offen offset:3072 nt lds
s_add_u32 m0, s32, 32768
s_add_u32 s59, s58, 8192
v_xor_b32 v242, 128, v26
buffer_load_dwordx4 v242, s[20:23], s59 offen offset:0 nt lds
v_xor_b32 v242, 144, v26
buffer_load_dwordx4 v242, s[20:23], s59 offen offset:1024 nt lds
v_xor_b32 v242, 160, v26
buffer_load_dwordx4 v242, s[20:23], s59 offen offset:2048 nt lds
v_xor_b32 v242, 176, v26
buffer_load_dwordx4 v242, s[20:23], s59 offen offset:3072 nt lds
s_add_u32 m0, s32, 36864
s_add_u32 s59, s58, 12288
v_xor_b32 v242, 192, v26
buffer_load_dwordx4 v242, s[20:23], s59 offen offset:0 nt lds
v_xor_b32 v242, 208, v26
buffer_load_dwordx4 v242, s[20:23], s59 offen offset:1024 nt lds
v_xor_b32 v242, 224, v26
buffer_load_dwordx4 v242, s[20:23], s59 offen offset:2048 nt lds
v_xor_b32 v242, 240, v26
buffer_load_dwordx4 v242, s[20:23], s59 offen offset:3072 nt lds
s_add_u32 s56, s54, s69
s_and_b32 s56, s56, 15
s_lshl_b32 s56, s56, 18
s_add_u32 s56, s56, s35
s_add_u32 s54, s54, 1
s_add_u32 m0, s32, 16384
s_add_u32 s55, s56, 0
buffer_load_dwordx4 v23, s[12:15], s55 offen offset:0 lds
s_add_u32 s55, s56, 31744
buffer_load_dwordx4 v23, s[12:15], s55 offen offset:1024 lds
s_add_u32 s55, s56, 63488
buffer_load_dwordx4 v23, s[12:15], s55 offen offset:2048 lds
s_add_u32 s55, s56, 95232
buffer_load_dwordx4 v23, s[12:15], s55 offen offset:3072 lds
s_add_u32 m0, s32, 20480
s_add_u32 s55, s56, 131072
buffer_load_dwordx4 v23, s[12:15], s55 offen offset:0 lds
s_add_u32 s55, s56, 162816
buffer_load_dwordx4 v23, s[12:15], s55 offen offset:1024 lds
s_add_u32 s55, s56, 194560
buffer_load_dwordx4 v23, s[12:15], s55 offen offset:2048 lds
s_add_u32 s55, s56, 226304
buffer_load_dwordx4 v23, s[12:15], s55 offen offset:3072 lds
s_add_u32 s56, s54, s69
s_and_b32 s56, s56, 15
s_lshl_b32 s56, s56, 18
s_add_u32 s56, s56, s35
s_add_u32 s54, s54, 1
s_add_u32 m0, s32, 0
s_add_u32 s55, s56, 0
buffer_load_dwordx4 v23, s[12:15], s55 offen offset:0 lds
s_add_u32 s55, s56, 31744
buffer_load_dwordx4 v23, s[12:15], s55 offen offset:1024 lds
s_add_u32 s55, s56, 63488
buffer_load_dwordx4 v23, s[12:15], s55 offen offset:2048 lds
s_add_u32 s55, s56, 95232
buffer_load_dwordx4 v23, s[12:15], s55 offen offset:3072 lds
s_add_u32 m0, s32, 4096
s_add_u32 s55, s56, 131072
buffer_load_dwordx4 v23, s[12:15], s55 offen offset:0 lds
s_add_u32 s55, s56, 162816
buffer_load_dwordx4 v23, s[12:15], s55 offen offset:1024 lds
s_add_u32 s55, s56, 194560
buffer_load_dwordx4 v23, s[12:15], s55 offen offset:2048 lds
s_add_u32 s55, s56, 226304
buffer_load_dwordx4 v23, s[12:15], s55 offen offset:3072 lds
s_add_u32 s56, s54, s69
s_and_b32 s56, s56, 15
s_lshl_b32 s56, s56, 18
s_add_u32 s56, s56, s35
s_add_u32 s54, s54, 1
s_add_u32 m0, s32, 8192
s_add_u32 s55, s56, 0
buffer_load_dwordx4 v23, s[12:15], s55 offen offset:0 lds
s_add_u32 s55, s56, 31744
buffer_load_dwordx4 v23, s[12:15], s55 offen offset:1024 lds
s_add_u32 s55, s56, 63488
buffer_load_dwordx4 v23, s[12:15], s55 offen offset:2048 lds
s_add_u32 s55, s56, 95232
buffer_load_dwordx4 v23, s[12:15], s55 offen offset:3072 lds
s_add_u32 m0, s32, 12288
s_add_u32 s55, s56, 131072
buffer_load_dwordx4 v23, s[12:15], s55 offen offset:0 lds
s_add_u32 s55, s56, 162816
buffer_load_dwordx4 v23, s[12:15], s55 offen offset:1024 lds
s_add_u32 s55, s56, 194560
buffer_load_dwordx4 v23, s[12:15], s55 offen offset:2048 lds
s_add_u32 s55, s56, 226304
buffer_load_dwordx4 v23, s[12:15], s55 offen offset:3072 lds
buffer_load_dword v37, v30, s[16:19], s66 offen nt
buffer_load_dword v37, v30, s[24:27], s68 offen nt
s_mov_b32 s58, 0
v_add_u32 v240, 0, v33
v_xor_b32 v240, v240, v35
v_lshlrev_b32 v240, 4, v240
v_lshl_add_u32 v18, v33, 8, v240
v_add_u32 v240, 4, v33
v_xor_b32 v240, v240, v35
v_lshlrev_b32 v240, 4, v240
v_lshl_add_u32 v19, v33, 8, v240
v_add_u32 v240, 8, v33
v_xor_b32 v240, v240, v35
v_lshlrev_b32 v240, 4, v240
v_lshl_add_u32 v20, v33, 8, v240
v_add_u32 v240, 12, v33
v_xor_b32 v240, v240, v35
v_lshlrev_b32 v240, 4, v240
v_lshl_add_u32 v21, v33, 8, v240
v_and_b32 v33, 31, v1
v_lshrrev_b32 v34, 5, v1
v_and_b32 v35, 15, v1
v_xor_b32 v36, v35, v34
v_lshlrev_b32 v36, 4, v36
v_lshrrev_b32 v240, 4, v33
v_mul_u32_u24 v240, 40960, v240
v_lshl_add_u32 v240, v35, 10, v240
v_add_u32 v240, v240, v36
v_add_u32 v38, 24576, v240
v_add_u32 v39, 106496, v240
v_lshl_add_u32 v35, v33, 8, v36
v_xor_b32 v2, 0, v35
v_add_u32 v2, s32, v2
v_xor_b32 v3, 32, v35
v_add_u32 v3, s32, v3
v_xor_b32 v4, 64, v35
v_add_u32 v4, s32, v4
v_xor_b32 v5, 96, v35
v_add_u32 v5, s32, v5
v_xor_b32 v6, 128, v35
v_add_u32 v6, s32, v6
v_xor_b32 v7, 160, v35
v_add_u32 v7, s32, v7
v_xor_b32 v8, 192, v35
v_add_u32 v8, s32, v8
v_xor_b32 v9, 224, v35
v_add_u32 v9, s32, v9
v_lshrrev_b32 v33, 2, v1
v_and_b32 v33, 3, v33
v_and_b32 v35, 3, v1
v_lshrrev_b32 v36, 4, v1
v_and_b32 v36, 1, v36
v_lshl_add_u32 v240, v34, 2, v33
v_lshlrev_b32 v240, 8, v240
v_lshl_add_u32 v240, v36, 5, v240
v_lshl_add_u32 v240, v35, 3, v240
v_add_u32 v240, s32, v240
v_xor_b32 v241, 0, v33
v_lshl_add_u32 v10, v241, 6, v240
v_xor_b32 v241, 1, v33
v_lshl_add_u32 v11, v241, 6, v240
v_xor_b32 v241, 2, v33
v_lshl_add_u32 v12, v241, 6, v240
v_xor_b32 v241, 3, v33
v_lshl_add_u32 v13, v241, 6, v240
v_lshl_add_u32 v240, v34, 3, v33
v_lshlrev_b32 v240, 8, v240
v_lshl_add_u32 v240, v36, 5, v240
v_lshrrev_b32 v241, 1, v35
v_and_b32 v242, 1, v35
v_lshl_add_u32 v241, v242, 1, v241
v_lshl_add_u32 v240, v241, 3, v240
v_add_u32 v240, s32, v240
v_xor_b32 v241, 0, v33
v_lshl_add_u32 v14, v241, 6, v240
v_xor_b32 v241, 1, v33
v_lshl_add_u32 v15, v241, 6, v240
v_xor_b32 v241, 2, v33
v_lshl_add_u32 v16, v241, 6, v240
v_xor_b32 v241, 3, v33
v_lshl_add_u32 v17, v241, 6, v240
v_add_u32 v28, s32, v26
v_add_u32 v28, 24576, v28
s_waitcnt vmcnt(26)
s_barrier
s_add_u32 s61, s58, s69
s_and_b32 s61, s61, 15
s_lshl_b32 s61, s61, 6
s_xor_b32 s60, s61, 32
v_xor_b32 v33, s61, v38
v_xor_b32 v34, s61, v39
v_xor_b32 v35, s60, v38
v_xor_b32 v36, s60, v39
ds_read_b128 v[224:227], v33
ds_read_b128 v[228:231], v34
ds_read_b128 v[232:235], v35
ds_read_b128 v[236:239], v36
s_add_u32 s58, s58, 1
s_waitcnt vmcnt(18)
ds_read_b64_tr_b16 v[160:161], v14 offset:16384
ds_read_b64_tr_b16 v[162:163], v14 offset:17408
ds_read_b64_tr_b16 v[164:165], v15 offset:16384
ds_read_b64_tr_b16 v[166:167], v15 offset:17408
ds_read_b64_tr_b16 v[168:169], v16 offset:16384
ds_read_b64_tr_b16 v[170:171], v16 offset:17408
ds_read_b64_tr_b16 v[172:173], v17 offset:16384
ds_read_b64_tr_b16 v[174:175], v17 offset:17408
ds_read_b64_tr_b16 v[176:177], v14 offset:20480
ds_read_b64_tr_b16 v[178:179], v14 offset:21504
s_waitcnt lgkmcnt(8)
v_mfma_f32_32x32x16_bf16 a[128:143], v[160:163], v[224:227], 0
ds_read_b64_tr_b16 v[180:181], v15 offset:20480
ds_read_b64_tr_b16 v[182:183], v15 offset:21504
ds_read_b64_tr_b16 v[184:185], v16 offset:20480
ds_read_b64_tr_b16 v[186:187], v16 offset:21504
v_mfma_f32_32x32x16_bf16 a[144:159], v[160:163], v[228:231], 0
s_waitcnt lgkmcnt(10)
v_mfma_f32_32x32x16_bf16 a[160:175], v[164:167], v[224:227], 0
ds_read_b64_tr_b16 v[188:189], v17 offset:20480
ds_read_b64_tr_b16 v[190:191], v17 offset:21504
v_mfma_f32_32x32x16_bf16 a[176:191], v[164:167], v[228:231], 0
s_waitcnt lgkmcnt(10)
v_mfma_f32_32x32x16_bf16 a[192:207], v[168:171], v[224:227], 0
v_mfma_f32_32x32x16_bf16 a[208:223], v[168:171], v[228:231], 0
s_waitcnt lgkmcnt(8)
v_mfma_f32_32x32x16_bf16 a[224:239], v[172:175], v[224:227], 0
s_add_u32 s61, s58, s69
s_and_b32 s61, s61, 15
s_lshl_b32 s61, s61, 6
s_xor_b32 s60, s61, 32
v_xor_b32 v33, s61, v38
v_xor_b32 v34, s61, v39
v_xor_b32 v35, s60, v38
v_xor_b32 v36, s60, v39
ds_read_b128 v[144:147], v33
ds_read_b128 v[148:151], v34
ds_read_b128 v[152:155], v35
ds_read_b128 v[156:159], v36
s_add_u32 s58, s58, 1
s_waitcnt vmcnt(10)
ds_read_b64_tr_b16 v[192:193], v14 offset:0
ds_read_b64_tr_b16 v[194:195], v14 offset:1024
v_mfma_f32_32x32x16_bf16 a[240:255], v[172:175], v[228:231], 0
s_waitcnt lgkmcnt(12)
v_mfma_f32_32x32x16_bf16 a[128:143], v[176:179], v[232:235], a[128:143]
ds_read_b64_tr_b16 v[196:197], v15 offset:0
ds_read_b64_tr_b16 v[198:199], v15 offset:1024
v_mfma_f32_32x32x16_bf16 a[144:159], v[176:179], v[236:239], a[144:159]
s_waitcnt lgkmcnt(12)
v_mfma_f32_32x32x16_bf16 a[160:175], v[180:183], v[232:235], a[160:175]
ds_read_b64_tr_b16 v[200:201], v16 offset:0
ds_read_b64_tr_b16 v[202:203], v16 offset:1024
v_mfma_f32_32x32x16_bf16 a[176:191], v[180:183], v[236:239], a[176:191]
s_waitcnt lgkmcnt(12)
v_mfma_f32_32x32x16_bf16 a[192:207], v[184:187], v[232:235], a[192:207]
ds_read_b64_tr_b16 v[204:205], v17 offset:0
ds_read_b64_tr_b16 v[206:207], v17 offset:1024
v_mfma_f32_32x32x16_bf16 a[208:223], v[184:187], v[236:239], a[208:223]
s_waitcnt lgkmcnt(12)
v_mfma_f32_32x32x16_bf16 a[224:239], v[188:191], v[232:235], a[224:239]
ds_read_b64_tr_b16 v[208:209], v14 offset:4096
ds_read_b64_tr_b16 v[210:211], v14 offset:5120
v_mfma_f32_32x32x16_bf16 a[240:255], v[188:191], v[236:239], a[240:255]
s_add_u32 s56, s54, s69
s_and_b32 s56, s56, 15
s_lshl_b32 s56, s56, 18
s_add_u32 s56, s56, s35
s_add_u32 s54, s54, 1
s_add_u32 m0, s32, 16384
s_add_u32 s55, s56, 0
buffer_load_dwordx4 v23, s[12:15], s55 offen offset:0 lds
s_waitcnt lgkmcnt(8)
v_mfma_f32_32x32x16_bf16 a[128:143], v[192:195], v[144:147], a[128:143]
ds_read_b64_tr_b16 v[212:213], v15 offset:4096
ds_read_b64_tr_b16 v[214:215], v15 offset:5120
ds_read_b64_tr_b16 v[216:217], v16 offset:4096
ds_read_b64_tr_b16 v[218:219], v16 offset:5120
v_mfma_f32_32x32x16_bf16 a[144:159], v[192:195], v[148:151], a[144:159]
s_add_u32 s55, s56, 31744
buffer_load_dwordx4 v23, s[12:15], s55 offen offset:1024 lds
s_waitcnt lgkmcnt(10)
v_mfma_f32_32x32x16_bf16 a[160:175], v[196:199], v[144:147], a[160:175]
ds_read_b64_tr_b16 v[220:221], v17 offset:4096
ds_read_b64_tr_b16 v[222:223], v17 offset:5120
v_mfma_f32_32x32x16_bf16 a[176:191], v[196:199], v[148:151], a[176:191]
s_add_u32 s55, s56, 63488
buffer_load_dwordx4 v23, s[12:15], s55 offen offset:2048 lds
s_waitcnt lgkmcnt(10)
v_mfma_f32_32x32x16_bf16 a[192:207], v[200:203], v[144:147], a[192:207]
v_mfma_f32_32x32x16_bf16 a[208:223], v[200:203], v[148:151], a[208:223]
s_add_u32 s55, s56, 95232
buffer_load_dwordx4 v23, s[12:15], s55 offen offset:3072 lds
s_waitcnt lgkmcnt(8)
v_mfma_f32_32x32x16_bf16 a[224:239], v[204:207], v[144:147], a[224:239]
s_add_u32 s61, s58, s69
s_and_b32 s61, s61, 15
s_lshl_b32 s61, s61, 6
s_xor_b32 s60, s61, 32
v_xor_b32 v33, s61, v38
v_xor_b32 v34, s61, v39
v_xor_b32 v35, s60, v38
v_xor_b32 v36, s60, v39
ds_read_b128 v[224:227], v33
ds_read_b128 v[228:231], v34
ds_read_b128 v[232:235], v35
ds_read_b128 v[236:239], v36
s_add_u32 s58, s58, 1
s_waitcnt vmcnt(6)
ds_read_b64_tr_b16 v[160:161], v14 offset:8192
ds_read_b64_tr_b16 v[162:163], v14 offset:9216
v_mfma_f32_32x32x16_bf16 a[240:255], v[204:207], v[148:151], a[240:255]
s_add_u32 m0, s32, 20480
s_add_u32 s55, s56, 131072
buffer_load_dwordx4 v23, s[12:15], s55 offen offset:0 lds
s_waitcnt lgkmcnt(12)
v_mfma_f32_32x32x16_bf16 a[128:143], v[208:211], v[152:155], a[128:143]
ds_read_b64_tr_b16 v[164:165], v15 offset:8192
ds_read_b64_tr_b16 v[166:167], v15 offset:9216
v_mfma_f32_32x32x16_bf16 a[144:159], v[208:211], v[156:159], a[144:159]
s_add_u32 s55, s56, 162816
buffer_load_dwordx4 v23, s[12:15], s55 offen offset:1024 lds
s_waitcnt lgkmcnt(12)
v_mfma_f32_32x32x16_bf16 a[160:175], v[212:215], v[152:155], a[160:175]
ds_read_b64_tr_b16 v[168:169], v16 offset:8192
ds_read_b64_tr_b16 v[170:171], v16 offset:9216
v_mfma_f32_32x32x16_bf16 a[176:191], v[212:215], v[156:159], a[176:191]
s_add_u32 s55, s56, 194560
buffer_load_dwordx4 v23, s[12:15], s55 offen offset:2048 lds
s_waitcnt lgkmcnt(12)
v_mfma_f32_32x32x16_bf16 a[192:207], v[216:219], v[152:155], a[192:207]
ds_read_b64_tr_b16 v[172:173], v17 offset:8192
ds_read_b64_tr_b16 v[174:175], v17 offset:9216
v_mfma_f32_32x32x16_bf16 a[208:223], v[216:219], v[156:159], a[208:223]
s_add_u32 s55, s56, 226304
buffer_load_dwordx4 v23, s[12:15], s55 offen offset:3072 lds
s_waitcnt lgkmcnt(12)
v_mfma_f32_32x32x16_bf16 a[224:239], v[220:223], v[152:155], a[224:239]
ds_read_b64_tr_b16 v[176:177], v14 offset:12288
ds_read_b64_tr_b16 v[178:179], v14 offset:13312
v_mfma_f32_32x32x16_bf16 a[240:255], v[220:223], v[156:159], a[240:255]
s_add_u32 s56, s54, s69
s_and_b32 s56, s56, 15
s_lshl_b32 s56, s56, 18
s_add_u32 s56, s56, s35
s_add_u32 s54, s54, 1
s_add_u32 m0, s32, 0
s_add_u32 s55, s56, 0
buffer_load_dwordx4 v23, s[12:15], s55 offen offset:0 lds
s_waitcnt lgkmcnt(8)
v_mfma_f32_32x32x16_bf16 a[128:143], v[160:163], v[224:227], a[128:143]
ds_read_b64_tr_b16 v[180:181], v15 offset:12288
ds_read_b64_tr_b16 v[182:183], v15 offset:13312
ds_read_b64_tr_b16 v[184:185], v16 offset:12288
ds_read_b64_tr_b16 v[186:187], v16 offset:13312
v_mfma_f32_32x32x16_bf16 a[144:159], v[160:163], v[228:231], a[144:159]
s_add_u32 s55, s56, 31744
buffer_load_dwordx4 v23, s[12:15], s55 offen offset:1024 lds
s_waitcnt lgkmcnt(10)
v_mfma_f32_32x32x16_bf16 a[160:175], v[164:167], v[224:227], a[160:175]
ds_read_b64_tr_b16 v[188:189], v17 offset:12288
ds_read_b64_tr_b16 v[190:191], v17 offset:13312
v_mfma_f32_32x32x16_bf16 a[176:191], v[164:167], v[228:231], a[176:191]
s_add_u32 s55, s56, 63488
buffer_load_dwordx4 v23, s[12:15], s55 offen offset:2048 lds
s_waitcnt lgkmcnt(10)
v_mfma_f32_32x32x16_bf16 a[192:207], v[168:171], v[224:227], a[192:207]
v_mfma_f32_32x32x16_bf16 a[208:223], v[168:171], v[228:231], a[208:223]
s_add_u32 s55, s56, 95232
buffer_load_dwordx4 v23, s[12:15], s55 offen offset:3072 lds
s_waitcnt lgkmcnt(8)
v_mfma_f32_32x32x16_bf16 a[224:239], v[172:175], v[224:227], a[224:239]
s_add_u32 s61, s58, s69
s_and_b32 s61, s61, 15
s_lshl_b32 s61, s61, 6
s_xor_b32 s60, s61, 32
v_xor_b32 v33, s61, v38
v_xor_b32 v34, s61, v39
v_xor_b32 v35, s60, v38
v_xor_b32 v36, s60, v39
ds_read_b128 v[144:147], v33
ds_read_b128 v[148:151], v34
ds_read_b128 v[152:155], v35
ds_read_b128 v[156:159], v36
s_add_u32 s58, s58, 1
s_waitcnt vmcnt(4)
ds_read_b64_tr_b16 v[192:193], v14 offset:16384
ds_read_b64_tr_b16 v[194:195], v14 offset:17408
v_mfma_f32_32x32x16_bf16 a[240:255], v[172:175], v[228:231], a[240:255]
s_add_u32 m0, s32, 4096
s_add_u32 s55, s56, 131072
buffer_load_dwordx4 v23, s[12:15], s55 offen offset:0 lds
s_waitcnt lgkmcnt(12)
v_mfma_f32_32x32x16_bf16 a[128:143], v[176:179], v[232:235], a[128:143]
ds_read_b64_tr_b16 v[196:197], v15 offset:16384
ds_read_b64_tr_b16 v[198:199], v15 offset:17408
v_mfma_f32_32x32x16_bf16 a[144:159], v[176:179], v[236:239], a[144:159]
s_add_u32 s55, s56, 162816
buffer_load_dwordx4 v23, s[12:15], s55 offen offset:1024 lds
s_waitcnt lgkmcnt(12)
v_mfma_f32_32x32x16_bf16 a[160:175], v[180:183], v[232:235], a[160:175]
ds_read_b64_tr_b16 v[200:201], v16 offset:16384
ds_read_b64_tr_b16 v[202:203], v16 offset:17408
v_mfma_f32_32x32x16_bf16 a[176:191], v[180:183], v[236:239], a[176:191]
s_add_u32 s55, s56, 194560
buffer_load_dwordx4 v23, s[12:15], s55 offen offset:2048 lds
s_waitcnt lgkmcnt(12)
v_mfma_f32_32x32x16_bf16 a[192:207], v[184:187], v[232:235], a[192:207]
ds_read_b64_tr_b16 v[204:205], v17 offset:16384
ds_read_b64_tr_b16 v[206:207], v17 offset:17408
v_mfma_f32_32x32x16_bf16 a[208:223], v[184:187], v[236:239], a[208:223]
s_add_u32 s55, s56, 226304
buffer_load_dwordx4 v23, s[12:15], s55 offen offset:3072 lds
s_waitcnt lgkmcnt(12)
v_mfma_f32_32x32x16_bf16 a[224:239], v[188:191], v[232:235], a[224:239]
ds_read_b64_tr_b16 v[208:209], v14 offset:20480
ds_read_b64_tr_b16 v[210:211], v14 offset:21504
v_mfma_f32_32x32x16_bf16 a[240:255], v[188:191], v[236:239], a[240:255]
s_add_u32 s56, s54, s69
s_and_b32 s56, s56, 15
s_lshl_b32 s56, s56, 18
s_add_u32 s56, s56, s35
s_add_u32 s54, s54, 1
s_add_u32 m0, s32, 8192
s_add_u32 s55, s56, 0
buffer_load_dwordx4 v23, s[12:15], s55 offen offset:0 lds
s_waitcnt lgkmcnt(8)
v_mfma_f32_32x32x16_bf16 a[128:143], v[192:195], v[144:147], a[128:143]
ds_read_b64_tr_b16 v[212:213], v15 offset:20480
ds_read_b64_tr_b16 v[214:215], v15 offset:21504
ds_read_b64_tr_b16 v[216:217], v16 offset:20480
ds_read_b64_tr_b16 v[218:219], v16 offset:21504
v_mfma_f32_32x32x16_bf16 a[144:159], v[192:195], v[148:151], a[144:159]
s_add_u32 s55, s56, 31744
buffer_load_dwordx4 v23, s[12:15], s55 offen offset:1024 lds
s_waitcnt lgkmcnt(10)
v_mfma_f32_32x32x16_bf16 a[160:175], v[196:199], v[144:147], a[160:175]
ds_read_b64_tr_b16 v[220:221], v17 offset:20480
ds_read_b64_tr_b16 v[222:223], v17 offset:21504
v_mfma_f32_32x32x16_bf16 a[176:191], v[196:199], v[148:151], a[176:191]
s_add_u32 s55, s56, 63488
buffer_load_dwordx4 v23, s[12:15], s55 offen offset:2048 lds
s_waitcnt lgkmcnt(10)
v_mfma_f32_32x32x16_bf16 a[192:207], v[200:203], v[144:147], a[192:207]
v_mfma_f32_32x32x16_bf16 a[208:223], v[200:203], v[148:151], a[208:223]
s_add_u32 s55, s56, 95232
buffer_load_dwordx4 v23, s[12:15], s55 offen offset:3072 lds
s_waitcnt lgkmcnt(8)
v_mfma_f32_32x32x16_bf16 a[224:239], v[204:207], v[144:147], a[224:239]
s_add_u32 s61, s58, s69
s_and_b32 s61, s61, 15
s_lshl_b32 s61, s61, 6
s_xor_b32 s60, s61, 32
v_xor_b32 v33, s61, v38
v_xor_b32 v34, s61, v39
v_xor_b32 v35, s60, v38
v_xor_b32 v36, s60, v39
ds_read_b128 v[224:227], v33
ds_read_b128 v[228:231], v34
ds_read_b128 v[232:235], v35
ds_read_b128 v[236:239], v36
s_add_u32 s58, s58, 1
s_waitcnt vmcnt(4)
ds_read_b64_tr_b16 v[160:161], v14 offset:0
ds_read_b64_tr_b16 v[162:163], v14 offset:1024
v_mfma_f32_32x32x16_bf16 a[240:255], v[204:207], v[148:151], a[240:255]
s_add_u32 m0, s32, 12288
s_add_u32 s55, s56, 131072
buffer_load_dwordx4 v23, s[12:15], s55 offen offset:0 lds
s_waitcnt lgkmcnt(12)
v_mfma_f32_32x32x16_bf16 a[128:143], v[208:211], v[152:155], a[128:143]
ds_read_b64_tr_b16 v[164:165], v15 offset:0
ds_read_b64_tr_b16 v[166:167], v15 offset:1024
v_mfma_f32_32x32x16_bf16 a[144:159], v[208:211], v[156:159], a[144:159]
s_add_u32 s55, s56, 162816
buffer_load_dwordx4 v23, s[12:15], s55 offen offset:1024 lds
s_waitcnt lgkmcnt(12)
v_mfma_f32_32x32x16_bf16 a[160:175], v[212:215], v[152:155], a[160:175]
ds_read_b64_tr_b16 v[168:169], v16 offset:0
ds_read_b64_tr_b16 v[170:171], v16 offset:1024
v_mfma_f32_32x32x16_bf16 a[176:191], v[212:215], v[156:159], a[176:191]
s_add_u32 s55, s56, 194560
buffer_load_dwordx4 v23, s[12:15], s55 offen offset:2048 lds
s_waitcnt lgkmcnt(12)
v_mfma_f32_32x32x16_bf16 a[192:207], v[216:219], v[152:155], a[192:207]
ds_read_b64_tr_b16 v[172:173], v17 offset:0
ds_read_b64_tr_b16 v[174:175], v17 offset:1024
v_mfma_f32_32x32x16_bf16 a[208:223], v[216:219], v[156:159], a[208:223]
s_add_u32 s55, s56, 226304
buffer_load_dwordx4 v23, s[12:15], s55 offen offset:3072 lds
s_waitcnt lgkmcnt(12)
v_mfma_f32_32x32x16_bf16 a[224:239], v[220:223], v[152:155], a[224:239]
ds_read_b64_tr_b16 v[176:177], v14 offset:4096
ds_read_b64_tr_b16 v[178:179], v14 offset:5120
v_mfma_f32_32x32x16_bf16 a[240:255], v[220:223], v[156:159], a[240:255]
s_add_u32 s56, s54, s69
s_and_b32 s56, s56, 15
s_lshl_b32 s56, s56, 18
s_add_u32 s56, s56, s35
s_add_u32 s54, s54, 1
s_add_u32 m0, s32, 16384
s_add_u32 s55, s56, 0
buffer_load_dwordx4 v23, s[12:15], s55 offen offset:0 lds
s_waitcnt lgkmcnt(8)
v_mfma_f32_32x32x16_bf16 a[128:143], v[160:163], v[224:227], a[128:143]
ds_read_b64_tr_b16 v[180:181], v15 offset:4096
ds_read_b64_tr_b16 v[182:183], v15 offset:5120
ds_read_b64_tr_b16 v[184:185], v16 offset:4096
ds_read_b64_tr_b16 v[186:187], v16 offset:5120
v_mfma_f32_32x32x16_bf16 a[144:159], v[160:163], v[228:231], a[144:159]
s_add_u32 s55, s56, 31744
buffer_load_dwordx4 v23, s[12:15], s55 offen offset:1024 lds
s_waitcnt lgkmcnt(10)
v_mfma_f32_32x32x16_bf16 a[160:175], v[164:167], v[224:227], a[160:175]
ds_read_b64_tr_b16 v[188:189], v17 offset:4096
ds_read_b64_tr_b16 v[190:191], v17 offset:5120
v_mfma_f32_32x32x16_bf16 a[176:191], v[164:167], v[228:231], a[176:191]
s_add_u32 s55, s56, 63488
buffer_load_dwordx4 v23, s[12:15], s55 offen offset:2048 lds
s_waitcnt lgkmcnt(10)
v_mfma_f32_32x32x16_bf16 a[192:207], v[168:171], v[224:227], a[192:207]
v_mfma_f32_32x32x16_bf16 a[208:223], v[168:171], v[228:231], a[208:223]
s_add_u32 s55, s56, 95232
buffer_load_dwordx4 v23, s[12:15], s55 offen offset:3072 lds
s_waitcnt lgkmcnt(8)
v_mfma_f32_32x32x16_bf16 a[224:239], v[172:175], v[224:227], a[224:239]
s_add_u32 s61, s58, s69
s_and_b32 s61, s61, 15
s_lshl_b32 s61, s61, 6
s_xor_b32 s60, s61, 32
v_xor_b32 v33, s61, v38
v_xor_b32 v34, s61, v39
v_xor_b32 v35, s60, v38
v_xor_b32 v36, s60, v39
ds_read_b128 v[144:147], v33
ds_read_b128 v[148:151], v34
ds_read_b128 v[152:155], v35
ds_read_b128 v[156:159], v36
s_add_u32 s58, s58, 1
s_waitcnt vmcnt(4)
ds_read_b64_tr_b16 v[192:193], v14 offset:8192
ds_read_b64_tr_b16 v[194:195], v14 offset:9216
v_mfma_f32_32x32x16_bf16 a[240:255], v[172:175], v[228:231], a[240:255]
s_add_u32 m0, s32, 20480
s_add_u32 s55, s56, 131072
buffer_load_dwordx4 v23, s[12:15], s55 offen offset:0 lds
s_waitcnt lgkmcnt(12)
v_mfma_f32_32x32x16_bf16 a[128:143], v[176:179], v[232:235], a[128:143]
ds_read_b64_tr_b16 v[196:197], v15 offset:8192
ds_read_b64_tr_b16 v[198:199], v15 offset:9216
v_mfma_f32_32x32x16_bf16 a[144:159], v[176:179], v[236:239], a[144:159]
s_add_u32 s55, s56, 162816
buffer_load_dwordx4 v23, s[12:15], s55 offen offset:1024 lds
s_waitcnt lgkmcnt(12)
v_mfma_f32_32x32x16_bf16 a[160:175], v[180:183], v[232:235], a[160:175]
ds_read_b64_tr_b16 v[200:201], v16 offset:8192
ds_read_b64_tr_b16 v[202:203], v16 offset:9216
v_mfma_f32_32x32x16_bf16 a[176:191], v[180:183], v[236:239], a[176:191]
s_add_u32 s55, s56, 194560
buffer_load_dwordx4 v23, s[12:15], s55 offen offset:2048 lds
s_waitcnt lgkmcnt(12)
v_mfma_f32_32x32x16_bf16 a[192:207], v[184:187], v[232:235], a[192:207]
ds_read_b64_tr_b16 v[204:205], v17 offset:8192
ds_read_b64_tr_b16 v[206:207], v17 offset:9216
v_mfma_f32_32x32x16_bf16 a[208:223], v[184:187], v[236:239], a[208:223]
s_add_u32 s55, s56, 226304
buffer_load_dwordx4 v23, s[12:15], s55 offen offset:3072 lds
s_waitcnt lgkmcnt(12)
v_mfma_f32_32x32x16_bf16 a[224:239], v[188:191], v[232:235], a[224:239]
ds_read_b64_tr_b16 v[208:209], v14 offset:12288
ds_read_b64_tr_b16 v[210:211], v14 offset:13312
v_mfma_f32_32x32x16_bf16 a[240:255], v[188:191], v[236:239], a[240:255]
s_add_u32 s56, s54, s69
s_and_b32 s56, s56, 15
s_lshl_b32 s56, s56, 18
s_add_u32 s56, s56, s35
s_add_u32 s54, s54, 1
s_add_u32 m0, s32, 0
s_add_u32 s55, s56, 0
buffer_load_dwordx4 v23, s[12:15], s55 offen offset:0 lds
s_waitcnt lgkmcnt(8)
v_mfma_f32_32x32x16_bf16 a[128:143], v[192:195], v[144:147], a[128:143]
ds_read_b64_tr_b16 v[212:213], v15 offset:12288
ds_read_b64_tr_b16 v[214:215], v15 offset:13312
ds_read_b64_tr_b16 v[216:217], v16 offset:12288
ds_read_b64_tr_b16 v[218:219], v16 offset:13312
v_mfma_f32_32x32x16_bf16 a[144:159], v[192:195], v[148:151], a[144:159]
s_add_u32 s55, s56, 31744
buffer_load_dwordx4 v23, s[12:15], s55 offen offset:1024 lds
s_waitcnt lgkmcnt(10)
v_mfma_f32_32x32x16_bf16 a[160:175], v[196:199], v[144:147], a[160:175]
ds_read_b64_tr_b16 v[220:221], v17 offset:12288
ds_read_b64_tr_b16 v[222:223], v17 offset:13312
v_mfma_f32_32x32x16_bf16 a[176:191], v[196:199], v[148:151], a[176:191]
s_add_u32 s55, s56, 63488
buffer_load_dwordx4 v23, s[12:15], s55 offen offset:2048 lds
s_waitcnt lgkmcnt(10)
v_mfma_f32_32x32x16_bf16 a[192:207], v[200:203], v[144:147], a[192:207]
v_mfma_f32_32x32x16_bf16 a[208:223], v[200:203], v[148:151], a[208:223]
s_add_u32 s55, s56, 95232
buffer_load_dwordx4 v23, s[12:15], s55 offen offset:3072 lds
s_waitcnt lgkmcnt(8)
v_mfma_f32_32x32x16_bf16 a[224:239], v[204:207], v[144:147], a[224:239]
s_add_u32 s61, s58, s69
s_and_b32 s61, s61, 15
s_lshl_b32 s61, s61, 6
s_xor_b32 s60, s61, 32
v_xor_b32 v33, s61, v38
v_xor_b32 v34, s61, v39
v_xor_b32 v35, s60, v38
v_xor_b32 v36, s60, v39
ds_read_b128 v[224:227], v33
ds_read_b128 v[228:231], v34
ds_read_b128 v[232:235], v35
ds_read_b128 v[236:239], v36
s_add_u32 s58, s58, 1
s_waitcnt vmcnt(4)
ds_read_b64_tr_b16 v[160:161], v14 offset:16384
ds_read_b64_tr_b16 v[162:163], v14 offset:17408
v_mfma_f32_32x32x16_bf16 a[240:255], v[204:207], v[148:151], a[240:255]
s_add_u32 m0, s32, 4096
s_add_u32 s55, s56, 131072
buffer_load_dwordx4 v23, s[12:15], s55 offen offset:0 lds
s_waitcnt lgkmcnt(12)
v_mfma_f32_32x32x16_bf16 a[128:143], v[208:211], v[152:155], a[128:143]
ds_read_b64_tr_b16 v[164:165], v15 offset:16384
ds_read_b64_tr_b16 v[166:167], v15 offset:17408
v_mfma_f32_32x32x16_bf16 a[144:159], v[208:211], v[156:159], a[144:159]
s_add_u32 s55, s56, 162816
buffer_load_dwordx4 v23, s[12:15], s55 offen offset:1024 lds
s_waitcnt lgkmcnt(12)
v_mfma_f32_32x32x16_bf16 a[160:175], v[212:215], v[152:155], a[160:175]
ds_read_b64_tr_b16 v[168:169], v16 offset:16384
ds_read_b64_tr_b16 v[170:171], v16 offset:17408
v_mfma_f32_32x32x16_bf16 a[176:191], v[212:215], v[156:159], a[176:191]
s_add_u32 s55, s56, 194560
buffer_load_dwordx4 v23, s[12:15], s55 offen offset:2048 lds
s_waitcnt lgkmcnt(12)
v_mfma_f32_32x32x16_bf16 a[192:207], v[216:219], v[152:155], a[192:207]
ds_read_b64_tr_b16 v[172:173], v17 offset:16384
ds_read_b64_tr_b16 v[174:175], v17 offset:17408
v_mfma_f32_32x32x16_bf16 a[208:223], v[216:219], v[156:159], a[208:223]
s_add_u32 s55, s56, 226304
buffer_load_dwordx4 v23, s[12:15], s55 offen offset:3072 lds
s_waitcnt lgkmcnt(12)
v_mfma_f32_32x32x16_bf16 a[224:239], v[220:223], v[152:155], a[224:239]
ds_read_b64_tr_b16 v[176:177], v14 offset:20480
ds_read_b64_tr_b16 v[178:179], v14 offset:21504
v_mfma_f32_32x32x16_bf16 a[240:255], v[220:223], v[156:159], a[240:255]
s_add_u32 s56, s54, s69
s_and_b32 s56, s56, 15
s_lshl_b32 s56, s56, 18
s_add_u32 s56, s56, s35
s_add_u32 s54, s54, 1
s_add_u32 m0, s32, 8192
s_add_u32 s55, s56, 0
buffer_load_dwordx4 v23, s[12:15], s55 offen offset:0 lds
s_waitcnt lgkmcnt(8)
v_mfma_f32_32x32x16_bf16 a[128:143], v[160:163], v[224:227], a[128:143]
ds_read_b64_tr_b16 v[180:181], v15 offset:20480
ds_read_b64_tr_b16 v[182:183], v15 offset:21504
ds_read_b64_tr_b16 v[184:185], v16 offset:20480
ds_read_b64_tr_b16 v[186:187], v16 offset:21504
v_mfma_f32_32x32x16_bf16 a[144:159], v[160:163], v[228:231], a[144:159]
s_add_u32 s55, s56, 31744
buffer_load_dwordx4 v23, s[12:15], s55 offen offset:1024 lds
s_waitcnt lgkmcnt(10)
v_mfma_f32_32x32x16_bf16 a[160:175], v[164:167], v[224:227], a[160:175]
ds_read_b64_tr_b16 v[188:189], v17 offset:20480
ds_read_b64_tr_b16 v[190:191], v17 offset:21504
v_mfma_f32_32x32x16_bf16 a[176:191], v[164:167], v[228:231], a[176:191]
s_add_u32 s55, s56, 63488
buffer_load_dwordx4 v23, s[12:15], s55 offen offset:2048 lds
s_waitcnt lgkmcnt(10)
v_mfma_f32_32x32x16_bf16 a[192:207], v[168:171], v[224:227], a[192:207]
v_mfma_f32_32x32x16_bf16 a[208:223], v[168:171], v[228:231], a[208:223]
s_add_u32 s55, s56, 95232
buffer_load_dwordx4 v23, s[12:15], s55 offen offset:3072 lds
s_waitcnt lgkmcnt(8)
v_mfma_f32_32x32x16_bf16 a[224:239], v[172:175], v[224:227], a[224:239]
s_add_u32 s61, s58, s69
s_and_b32 s61, s61, 15
s_lshl_b32 s61, s61, 6
s_xor_b32 s60, s61, 32
v_xor_b32 v33, s61, v38
v_xor_b32 v34, s61, v39
v_xor_b32 v35, s60, v38
v_xor_b32 v36, s60, v39
ds_read_b128 v[144:147], v33
ds_read_b128 v[148:151], v34
ds_read_b128 v[152:155], v35
ds_read_b128 v[156:159], v36
s_add_u32 s58, s58, 1
s_waitcnt vmcnt(4)
ds_read_b64_tr_b16 v[192:193], v14 offset:0
ds_read_b64_tr_b16 v[194:195], v14 offset:1024
v_mfma_f32_32x32x16_bf16 a[240:255], v[172:175], v[228:231], a[240:255]
s_add_u32 m0, s32, 12288
s_add_u32 s55, s56, 131072
buffer_load_dwordx4 v23, s[12:15], s55 offen offset:0 lds
s_waitcnt lgkmcnt(12)
v_mfma_f32_32x32x16_bf16 a[128:143], v[176:179], v[232:235], a[128:143]
ds_read_b64_tr_b16 v[196:197], v15 offset:0
ds_read_b64_tr_b16 v[198:199], v15 offset:1024
v_mfma_f32_32x32x16_bf16 a[144:159], v[176:179], v[236:239], a[144:159]
s_add_u32 s55, s56, 162816
buffer_load_dwordx4 v23, s[12:15], s55 offen offset:1024 lds
s_waitcnt lgkmcnt(12)
v_mfma_f32_32x32x16_bf16 a[160:175], v[180:183], v[232:235], a[160:175]
ds_read_b64_tr_b16 v[200:201], v16 offset:0
ds_read_b64_tr_b16 v[202:203], v16 offset:1024
v_mfma_f32_32x32x16_bf16 a[176:191], v[180:183], v[236:239], a[176:191]
s_add_u32 s55, s56, 194560
buffer_load_dwordx4 v23, s[12:15], s55 offen offset:2048 lds
s_waitcnt lgkmcnt(12)
v_mfma_f32_32x32x16_bf16 a[192:207], v[184:187], v[232:235], a[192:207]
ds_read_b64_tr_b16 v[204:205], v17 offset:0
ds_read_b64_tr_b16 v[206:207], v17 offset:1024
v_mfma_f32_32x32x16_bf16 a[208:223], v[184:187], v[236:239], a[208:223]
s_add_u32 s55, s56, 226304
buffer_load_dwordx4 v23, s[12:15], s55 offen offset:3072 lds
s_waitcnt lgkmcnt(12)
v_mfma_f32_32x32x16_bf16 a[224:239], v[188:191], v[232:235], a[224:239]
ds_read_b64_tr_b16 v[208:209], v14 offset:4096
ds_read_b64_tr_b16 v[210:211], v14 offset:5120
v_mfma_f32_32x32x16_bf16 a[240:255], v[188:191], v[236:239], a[240:255]
s_add_u32 s56, s54, s69
s_and_b32 s56, s56, 15
s_lshl_b32 s56, s56, 18
s_add_u32 s56, s56, s35
s_add_u32 s54, s54, 1
s_add_u32 m0, s32, 16384
s_add_u32 s55, s56, 0
buffer_load_dwordx4 v23, s[12:15], s55 offen offset:0 lds
s_waitcnt lgkmcnt(8)
v_mfma_f32_32x32x16_bf16 a[128:143], v[192:195], v[144:147], a[128:143]
ds_read_b64_tr_b16 v[212:213], v15 offset:4096
ds_read_b64_tr_b16 v[214:215], v15 offset:5120
ds_read_b64_tr_b16 v[216:217], v16 offset:4096
ds_read_b64_tr_b16 v[218:219], v16 offset:5120
v_mfma_f32_32x32x16_bf16 a[144:159], v[192:195], v[148:151], a[144:159]
s_add_u32 s55, s56, 31744
buffer_load_dwordx4 v23, s[12:15], s55 offen offset:1024 lds
s_waitcnt lgkmcnt(10)
v_mfma_f32_32x32x16_bf16 a[160:175], v[196:199], v[144:147], a[160:175]
ds_read_b64_tr_b16 v[220:221], v17 offset:4096
ds_read_b64_tr_b16 v[222:223], v17 offset:5120
v_mfma_f32_32x32x16_bf16 a[176:191], v[196:199], v[148:151], a[176:191]
s_add_u32 s55, s56, 63488
buffer_load_dwordx4 v23, s[12:15], s55 offen offset:2048 lds
s_waitcnt lgkmcnt(10)
v_mfma_f32_32x32x16_bf16 a[192:207], v[200:203], v[144:147], a[192:207]
v_mfma_f32_32x32x16_bf16 a[208:223], v[200:203], v[148:151], a[208:223]
s_add_u32 s55, s56, 95232
buffer_load_dwordx4 v23, s[12:15], s55 offen offset:3072 lds
s_waitcnt lgkmcnt(8)
v_mfma_f32_32x32x16_bf16 a[224:239], v[204:207], v[144:147], a[224:239]
s_add_u32 s61, s58, s69
s_and_b32 s61, s61, 15
s_lshl_b32 s61, s61, 6
s_xor_b32 s60, s61, 32
v_xor_b32 v33, s61, v38
v_xor_b32 v34, s61, v39
v_xor_b32 v35, s60, v38
v_xor_b32 v36, s60, v39
ds_read_b128 v[224:227], v33
ds_read_b128 v[228:231], v34
ds_read_b128 v[232:235], v35
ds_read_b128 v[236:239], v36
s_add_u32 s58, s58, 1
s_waitcnt vmcnt(4)
ds_read_b64_tr_b16 v[160:161], v14 offset:8192
ds_read_b64_tr_b16 v[162:163], v14 offset:9216
v_mfma_f32_32x32x16_bf16 a[240:255], v[204:207], v[148:151], a[240:255]
s_add_u32 m0, s32, 20480
s_add_u32 s55, s56, 131072
buffer_load_dwordx4 v23, s[12:15], s55 offen offset:0 lds
s_waitcnt lgkmcnt(12)
v_mfma_f32_32x32x16_bf16 a[128:143], v[208:211], v[152:155], a[128:143]
ds_read_b64_tr_b16 v[164:165], v15 offset:8192
ds_read_b64_tr_b16 v[166:167], v15 offset:9216
v_mfma_f32_32x32x16_bf16 a[144:159], v[208:211], v[156:159], a[144:159]
s_add_u32 s55, s56, 162816
buffer_load_dwordx4 v23, s[12:15], s55 offen offset:1024 lds
s_waitcnt lgkmcnt(12)
v_mfma_f32_32x32x16_bf16 a[160:175], v[212:215], v[152:155], a[160:175]
ds_read_b64_tr_b16 v[168:169], v16 offset:8192
ds_read_b64_tr_b16 v[170:171], v16 offset:9216
v_mfma_f32_32x32x16_bf16 a[176:191], v[212:215], v[156:159], a[176:191]
s_add_u32 s55, s56, 194560
buffer_load_dwordx4 v23, s[12:15], s55 offen offset:2048 lds
s_waitcnt lgkmcnt(12)
v_mfma_f32_32x32x16_bf16 a[192:207], v[216:219], v[152:155], a[192:207]
ds_read_b64_tr_b16 v[172:173], v17 offset:8192
ds_read_b64_tr_b16 v[174:175], v17 offset:9216
v_mfma_f32_32x32x16_bf16 a[208:223], v[216:219], v[156:159], a[208:223]
s_add_u32 s55, s56, 226304
buffer_load_dwordx4 v23, s[12:15], s55 offen offset:3072 lds
s_waitcnt lgkmcnt(12)
v_mfma_f32_32x32x16_bf16 a[224:239], v[220:223], v[152:155], a[224:239]
ds_read_b64_tr_b16 v[176:177], v14 offset:12288
ds_read_b64_tr_b16 v[178:179], v14 offset:13312
v_mfma_f32_32x32x16_bf16 a[240:255], v[220:223], v[156:159], a[240:255]
s_add_u32 s56, s54, s69
s_and_b32 s56, s56, 15
s_lshl_b32 s56, s56, 18
s_add_u32 s56, s56, s35
s_add_u32 s54, s54, 1
s_add_u32 m0, s32, 0
s_add_u32 s55, s56, 0
buffer_load_dwordx4 v23, s[12:15], s55 offen offset:0 lds
s_waitcnt lgkmcnt(8)
v_mfma_f32_32x32x16_bf16 a[128:143], v[160:163], v[224:227], a[128:143]
ds_read_b64_tr_b16 v[180:181], v15 offset:12288
ds_read_b64_tr_b16 v[182:183], v15 offset:13312
ds_read_b64_tr_b16 v[184:185], v16 offset:12288
ds_read_b64_tr_b16 v[186:187], v16 offset:13312
v_mfma_f32_32x32x16_bf16 a[144:159], v[160:163], v[228:231], a[144:159]
s_add_u32 s55, s56, 31744
buffer_load_dwordx4 v23, s[12:15], s55 offen offset:1024 lds
s_waitcnt lgkmcnt(10)
v_mfma_f32_32x32x16_bf16 a[160:175], v[164:167], v[224:227], a[160:175]
ds_read_b64_tr_b16 v[188:189], v17 offset:12288
ds_read_b64_tr_b16 v[190:191], v17 offset:13312
v_mfma_f32_32x32x16_bf16 a[176:191], v[164:167], v[228:231], a[176:191]
s_add_u32 s55, s56, 63488
buffer_load_dwordx4 v23, s[12:15], s55 offen offset:2048 lds
s_waitcnt lgkmcnt(10)
v_mfma_f32_32x32x16_bf16 a[192:207], v[168:171], v[224:227], a[192:207]
v_mfma_f32_32x32x16_bf16 a[208:223], v[168:171], v[228:231], a[208:223]
s_add_u32 s55, s56, 95232
buffer_load_dwordx4 v23, s[12:15], s55 offen offset:3072 lds
s_waitcnt lgkmcnt(8)
v_mfma_f32_32x32x16_bf16 a[224:239], v[172:175], v[224:227], a[224:239]
s_add_u32 s61, s58, s69
s_and_b32 s61, s61, 15
s_lshl_b32 s61, s61, 6
s_xor_b32 s60, s61, 32
v_xor_b32 v33, s61, v38
v_xor_b32 v34, s61, v39
v_xor_b32 v35, s60, v38
v_xor_b32 v36, s60, v39
ds_read_b128 v[144:147], v33
ds_read_b128 v[148:151], v34
ds_read_b128 v[152:155], v35
ds_read_b128 v[156:159], v36
s_add_u32 s58, s58, 1
s_waitcnt vmcnt(4)
ds_read_b64_tr_b16 v[192:193], v14 offset:16384
ds_read_b64_tr_b16 v[194:195], v14 offset:17408
v_mfma_f32_32x32x16_bf16 a[240:255], v[172:175], v[228:231], a[240:255]
s_add_u32 m0, s32, 4096
s_add_u32 s55, s56, 131072
buffer_load_dwordx4 v23, s[12:15], s55 offen offset:0 lds
s_waitcnt lgkmcnt(12)
v_mfma_f32_32x32x16_bf16 a[128:143], v[176:179], v[232:235], a[128:143]
ds_read_b64_tr_b16 v[196:197], v15 offset:16384
ds_read_b64_tr_b16 v[198:199], v15 offset:17408
v_mfma_f32_32x32x16_bf16 a[144:159], v[176:179], v[236:239], a[144:159]
s_add_u32 s55, s56, 162816
buffer_load_dwordx4 v23, s[12:15], s55 offen offset:1024 lds
s_waitcnt lgkmcnt(12)
v_mfma_f32_32x32x16_bf16 a[160:175], v[180:183], v[232:235], a[160:175]
ds_read_b64_tr_b16 v[200:201], v16 offset:16384
ds_read_b64_tr_b16 v[202:203], v16 offset:17408
v_mfma_f32_32x32x16_bf16 a[176:191], v[180:183], v[236:239], a[176:191]
s_add_u32 s55, s56, 194560
buffer_load_dwordx4 v23, s[12:15], s55 offen offset:2048 lds
s_waitcnt lgkmcnt(12)
v_mfma_f32_32x32x16_bf16 a[192:207], v[184:187], v[232:235], a[192:207]
ds_read_b64_tr_b16 v[204:205], v17 offset:16384
ds_read_b64_tr_b16 v[206:207], v17 offset:17408
v_mfma_f32_32x32x16_bf16 a[208:223], v[184:187], v[236:239], a[208:223]
s_add_u32 s55, s56, 226304
buffer_load_dwordx4 v23, s[12:15], s55 offen offset:3072 lds
s_waitcnt lgkmcnt(12)
v_mfma_f32_32x32x16_bf16 a[224:239], v[188:191], v[232:235], a[224:239]
ds_read_b64_tr_b16 v[208:209], v14 offset:20480
ds_read_b64_tr_b16 v[210:211], v14 offset:21504
v_mfma_f32_32x32x16_bf16 a[240:255], v[188:191], v[236:239], a[240:255]
s_add_u32 s56, s54, s69
s_and_b32 s56, s56, 15
s_lshl_b32 s56, s56, 18
s_add_u32 s56, s56, s35
s_add_u32 s54, s54, 1
s_add_u32 m0, s32, 8192
s_add_u32 s55, s56, 0
buffer_load_dwordx4 v23, s[12:15], s55 offen offset:0 lds
s_waitcnt lgkmcnt(8)
v_mfma_f32_32x32x16_bf16 a[128:143], v[192:195], v[144:147], a[128:143]
ds_read_b64_tr_b16 v[212:213], v15 offset:20480
ds_read_b64_tr_b16 v[214:215], v15 offset:21504
ds_read_b64_tr_b16 v[216:217], v16 offset:20480
ds_read_b64_tr_b16 v[218:219], v16 offset:21504
v_mfma_f32_32x32x16_bf16 a[144:159], v[192:195], v[148:151], a[144:159]
s_add_u32 s55, s56, 31744
buffer_load_dwordx4 v23, s[12:15], s55 offen offset:1024 lds
s_waitcnt lgkmcnt(10)
v_mfma_f32_32x32x16_bf16 a[160:175], v[196:199], v[144:147], a[160:175]
ds_read_b64_tr_b16 v[220:221], v17 offset:20480
ds_read_b64_tr_b16 v[222:223], v17 offset:21504
v_mfma_f32_32x32x16_bf16 a[176:191], v[196:199], v[148:151], a[176:191]
s_add_u32 s55, s56, 63488
buffer_load_dwordx4 v23, s[12:15], s55 offen offset:2048 lds
s_waitcnt lgkmcnt(10)
v_mfma_f32_32x32x16_bf16 a[192:207], v[200:203], v[144:147], a[192:207]
v_mfma_f32_32x32x16_bf16 a[208:223], v[200:203], v[148:151], a[208:223]
s_add_u32 s55, s56, 95232
buffer_load_dwordx4 v23, s[12:15], s55 offen offset:3072 lds
s_waitcnt lgkmcnt(8)
v_mfma_f32_32x32x16_bf16 a[224:239], v[204:207], v[144:147], a[224:239]
s_add_u32 s61, s58, s69
s_and_b32 s61, s61, 15
s_lshl_b32 s61, s61, 6
s_xor_b32 s60, s61, 32
v_xor_b32 v33, s61, v38
v_xor_b32 v34, s61, v39
v_xor_b32 v35, s60, v38
v_xor_b32 v36, s60, v39
ds_read_b128 v[224:227], v33
ds_read_b128 v[228:231], v34
ds_read_b128 v[232:235], v35
ds_read_b128 v[236:239], v36
s_add_u32 s58, s58, 1
s_waitcnt vmcnt(4)
ds_read_b64_tr_b16 v[160:161], v14 offset:0
ds_read_b64_tr_b16 v[162:163], v14 offset:1024
v_mfma_f32_32x32x16_bf16 a[240:255], v[204:207], v[148:151], a[240:255]
s_add_u32 m0, s32, 12288
s_add_u32 s55, s56, 131072
buffer_load_dwordx4 v23, s[12:15], s55 offen offset:0 lds
s_waitcnt lgkmcnt(12)
v_mfma_f32_32x32x16_bf16 a[128:143], v[208:211], v[152:155], a[128:143]
ds_read_b64_tr_b16 v[164:165], v15 offset:0
ds_read_b64_tr_b16 v[166:167], v15 offset:1024
v_mfma_f32_32x32x16_bf16 a[144:159], v[208:211], v[156:159], a[144:159]
s_add_u32 s55, s56, 162816
buffer_load_dwordx4 v23, s[12:15], s55 offen offset:1024 lds
s_waitcnt lgkmcnt(12)
v_mfma_f32_32x32x16_bf16 a[160:175], v[212:215], v[152:155], a[160:175]
ds_read_b64_tr_b16 v[168:169], v16 offset:0
ds_read_b64_tr_b16 v[170:171], v16 offset:1024
v_mfma_f32_32x32x16_bf16 a[176:191], v[212:215], v[156:159], a[176:191]
s_add_u32 s55, s56, 194560
buffer_load_dwordx4 v23, s[12:15], s55 offen offset:2048 lds
s_waitcnt lgkmcnt(12)
v_mfma_f32_32x32x16_bf16 a[192:207], v[216:219], v[152:155], a[192:207]
ds_read_b64_tr_b16 v[172:173], v17 offset:0
ds_read_b64_tr_b16 v[174:175], v17 offset:1024
v_mfma_f32_32x32x16_bf16 a[208:223], v[216:219], v[156:159], a[208:223]
s_add_u32 s55, s56, 226304
buffer_load_dwordx4 v23, s[12:15], s55 offen offset:3072 lds
s_waitcnt lgkmcnt(12)
v_mfma_f32_32x32x16_bf16 a[224:239], v[220:223], v[152:155], a[224:239]
ds_read_b64_tr_b16 v[176:177], v14 offset:4096
ds_read_b64_tr_b16 v[178:179], v14 offset:5120
v_mfma_f32_32x32x16_bf16 a[240:255], v[220:223], v[156:159], a[240:255]
s_add_u32 s56, s54, s69
s_and_b32 s56, s56, 15
s_lshl_b32 s56, s56, 18
s_add_u32 s56, s56, s35
s_add_u32 s54, s54, 1
s_add_u32 m0, s32, 16384
s_add_u32 s55, s56, 0
buffer_load_dwordx4 v23, s[12:15], s55 offen offset:0 lds
s_waitcnt lgkmcnt(8)
v_mfma_f32_32x32x16_bf16 a[128:143], v[160:163], v[224:227], a[128:143]
ds_read_b64_tr_b16 v[180:181], v15 offset:4096
ds_read_b64_tr_b16 v[182:183], v15 offset:5120
ds_read_b64_tr_b16 v[184:185], v16 offset:4096
ds_read_b64_tr_b16 v[186:187], v16 offset:5120
v_mfma_f32_32x32x16_bf16 a[144:159], v[160:163], v[228:231], a[144:159]
s_add_u32 s55, s56, 31744
buffer_load_dwordx4 v23, s[12:15], s55 offen offset:1024 lds
s_waitcnt lgkmcnt(10)
v_mfma_f32_32x32x16_bf16 a[160:175], v[164:167], v[224:227], a[160:175]
ds_read_b64_tr_b16 v[188:189], v17 offset:4096
ds_read_b64_tr_b16 v[190:191], v17 offset:5120
v_mfma_f32_32x32x16_bf16 a[176:191], v[164:167], v[228:231], a[176:191]
s_add_u32 s55, s56, 63488
buffer_load_dwordx4 v23, s[12:15], s55 offen offset:2048 lds
s_waitcnt lgkmcnt(10)
v_mfma_f32_32x32x16_bf16 a[192:207], v[168:171], v[224:227], a[192:207]
v_mfma_f32_32x32x16_bf16 a[208:223], v[168:171], v[228:231], a[208:223]
s_add_u32 s55, s56, 95232
buffer_load_dwordx4 v23, s[12:15], s55 offen offset:3072 lds
s_waitcnt lgkmcnt(8)
v_mfma_f32_32x32x16_bf16 a[224:239], v[172:175], v[224:227], a[224:239]
s_add_u32 s61, s58, s69
s_and_b32 s61, s61, 15
s_lshl_b32 s61, s61, 6
s_xor_b32 s60, s61, 32
v_xor_b32 v33, s61, v38
v_xor_b32 v34, s61, v39
v_xor_b32 v35, s60, v38
v_xor_b32 v36, s60, v39
ds_read_b128 v[144:147], v33
ds_read_b128 v[148:151], v34
ds_read_b128 v[152:155], v35
ds_read_b128 v[156:159], v36
s_add_u32 s58, s58, 1
s_waitcnt vmcnt(4)
ds_read_b64_tr_b16 v[192:193], v14 offset:8192
ds_read_b64_tr_b16 v[194:195], v14 offset:9216
v_mfma_f32_32x32x16_bf16 a[240:255], v[172:175], v[228:231], a[240:255]
s_add_u32 m0, s32, 20480
s_add_u32 s55, s56, 131072
buffer_load_dwordx4 v23, s[12:15], s55 offen offset:0 lds
s_waitcnt lgkmcnt(12)
v_mfma_f32_32x32x16_bf16 a[128:143], v[176:179], v[232:235], a[128:143]
ds_read_b64_tr_b16 v[196:197], v15 offset:8192
ds_read_b64_tr_b16 v[198:199], v15 offset:9216
v_mfma_f32_32x32x16_bf16 a[144:159], v[176:179], v[236:239], a[144:159]
s_add_u32 s55, s56, 162816
buffer_load_dwordx4 v23, s[12:15], s55 offen offset:1024 lds
s_waitcnt lgkmcnt(12)
v_mfma_f32_32x32x16_bf16 a[160:175], v[180:183], v[232:235], a[160:175]
ds_read_b64_tr_b16 v[200:201], v16 offset:8192
ds_read_b64_tr_b16 v[202:203], v16 offset:9216
v_mfma_f32_32x32x16_bf16 a[176:191], v[180:183], v[236:239], a[176:191]
s_add_u32 s55, s56, 194560
buffer_load_dwordx4 v23, s[12:15], s55 offen offset:2048 lds
s_waitcnt lgkmcnt(12)
v_mfma_f32_32x32x16_bf16 a[192:207], v[184:187], v[232:235], a[192:207]
ds_read_b64_tr_b16 v[204:205], v17 offset:8192
ds_read_b64_tr_b16 v[206:207], v17 offset:9216
v_mfma_f32_32x32x16_bf16 a[208:223], v[184:187], v[236:239], a[208:223]
s_add_u32 s55, s56, 226304
buffer_load_dwordx4 v23, s[12:15], s55 offen offset:3072 lds
s_waitcnt lgkmcnt(12)
v_mfma_f32_32x32x16_bf16 a[224:239], v[188:191], v[232:235], a[224:239]
ds_read_b64_tr_b16 v[208:209], v14 offset:12288
ds_read_b64_tr_b16 v[210:211], v14 offset:13312
v_mfma_f32_32x32x16_bf16 a[240:255], v[188:191], v[236:239], a[240:255]
s_add_u32 s56, s54, s69
s_and_b32 s56, s56, 15
s_lshl_b32 s56, s56, 18
s_add_u32 s56, s56, s35
s_add_u32 s54, s54, 1
s_add_u32 m0, s32, 0
s_add_u32 s55, s56, 0
buffer_load_dwordx4 v23, s[12:15], s55 offen offset:0 lds
s_waitcnt lgkmcnt(8)
v_mfma_f32_32x32x16_bf16 a[128:143], v[192:195], v[144:147], a[128:143]
ds_read_b64_tr_b16 v[212:213], v15 offset:12288
ds_read_b64_tr_b16 v[214:215], v15 offset:13312
ds_read_b64_tr_b16 v[216:217], v16 offset:12288
ds_read_b64_tr_b16 v[218:219], v16 offset:13312
v_mfma_f32_32x32x16_bf16 a[144:159], v[192:195], v[148:151], a[144:159]
s_add_u32 s55, s56, 31744
buffer_load_dwordx4 v23, s[12:15], s55 offen offset:1024 lds
s_waitcnt lgkmcnt(10)
v_mfma_f32_32x32x16_bf16 a[160:175], v[196:199], v[144:147], a[160:175]
ds_read_b64_tr_b16 v[220:221], v17 offset:12288
ds_read_b64_tr_b16 v[222:223], v17 offset:13312
v_mfma_f32_32x32x16_bf16 a[176:191], v[196:199], v[148:151], a[176:191]
s_add_u32 s55, s56, 63488
buffer_load_dwordx4 v23, s[12:15], s55 offen offset:2048 lds
s_waitcnt lgkmcnt(10)
v_mfma_f32_32x32x16_bf16 a[192:207], v[200:203], v[144:147], a[192:207]
v_mfma_f32_32x32x16_bf16 a[208:223], v[200:203], v[148:151], a[208:223]
s_add_u32 s55, s56, 95232
buffer_load_dwordx4 v23, s[12:15], s55 offen offset:3072 lds
s_waitcnt lgkmcnt(8)
v_mfma_f32_32x32x16_bf16 a[224:239], v[204:207], v[144:147], a[224:239]
s_add_u32 s61, s58, s69
s_and_b32 s61, s61, 15
s_lshl_b32 s61, s61, 6
s_xor_b32 s60, s61, 32
v_xor_b32 v33, s61, v38
v_xor_b32 v34, s61, v39
v_xor_b32 v35, s60, v38
v_xor_b32 v36, s60, v39
ds_read_b128 v[224:227], v33
ds_read_b128 v[228:231], v34
ds_read_b128 v[232:235], v35
ds_read_b128 v[236:239], v36
s_add_u32 s58, s58, 1
s_waitcnt vmcnt(4)
ds_read_b64_tr_b16 v[160:161], v14 offset:16384
ds_read_b64_tr_b16 v[162:163], v14 offset:17408
v_mfma_f32_32x32x16_bf16 a[240:255], v[204:207], v[148:151], a[240:255]
s_add_u32 m0, s32, 4096
s_add_u32 s55, s56, 131072
buffer_load_dwordx4 v23, s[12:15], s55 offen offset:0 lds
s_waitcnt lgkmcnt(12)
v_mfma_f32_32x32x16_bf16 a[128:143], v[208:211], v[152:155], a[128:143]
ds_read_b64_tr_b16 v[164:165], v15 offset:16384
ds_read_b64_tr_b16 v[166:167], v15 offset:17408
v_mfma_f32_32x32x16_bf16 a[144:159], v[208:211], v[156:159], a[144:159]
s_add_u32 s55, s56, 162816
buffer_load_dwordx4 v23, s[12:15], s55 offen offset:1024 lds
s_waitcnt lgkmcnt(12)
v_mfma_f32_32x32x16_bf16 a[160:175], v[212:215], v[152:155], a[160:175]
ds_read_b64_tr_b16 v[168:169], v16 offset:16384
ds_read_b64_tr_b16 v[170:171], v16 offset:17408
v_mfma_f32_32x32x16_bf16 a[176:191], v[212:215], v[156:159], a[176:191]
s_add_u32 s55, s56, 194560
buffer_load_dwordx4 v23, s[12:15], s55 offen offset:2048 lds
s_waitcnt lgkmcnt(12)
v_mfma_f32_32x32x16_bf16 a[192:207], v[216:219], v[152:155], a[192:207]
ds_read_b64_tr_b16 v[172:173], v17 offset:16384
ds_read_b64_tr_b16 v[174:175], v17 offset:17408
v_mfma_f32_32x32x16_bf16 a[208:223], v[216:219], v[156:159], a[208:223]
s_add_u32 s55, s56, 226304
buffer_load_dwordx4 v23, s[12:15], s55 offen offset:3072 lds
s_waitcnt lgkmcnt(12)
v_mfma_f32_32x32x16_bf16 a[224:239], v[220:223], v[152:155], a[224:239]
ds_read_b64_tr_b16 v[176:177], v14 offset:20480
ds_read_b64_tr_b16 v[178:179], v14 offset:21504
v_mfma_f32_32x32x16_bf16 a[240:255], v[220:223], v[156:159], a[240:255]
s_add_u32 s56, s54, s69
s_and_b32 s56, s56, 15
s_lshl_b32 s56, s56, 18
s_add_u32 s56, s56, s35
s_add_u32 s54, s54, 1
s_add_u32 m0, s32, 8192
s_add_u32 s55, s56, 0
buffer_load_dwordx4 v23, s[12:15], s55 offen offset:0 lds
s_waitcnt lgkmcnt(8)
v_mfma_f32_32x32x16_bf16 a[128:143], v[160:163], v[224:227], a[128:143]
ds_read_b64_tr_b16 v[180:181], v15 offset:20480
ds_read_b64_tr_b16 v[182:183], v15 offset:21504
ds_read_b64_tr_b16 v[184:185], v16 offset:20480
ds_read_b64_tr_b16 v[186:187], v16 offset:21504
v_mfma_f32_32x32x16_bf16 a[144:159], v[160:163], v[228:231], a[144:159]
s_add_u32 s55, s56, 31744
buffer_load_dwordx4 v23, s[12:15], s55 offen offset:1024 lds
s_waitcnt lgkmcnt(10)
v_mfma_f32_32x32x16_bf16 a[160:175], v[164:167], v[224:227], a[160:175]
ds_read_b64_tr_b16 v[188:189], v17 offset:20480
ds_read_b64_tr_b16 v[190:191], v17 offset:21504
v_mfma_f32_32x32x16_bf16 a[176:191], v[164:167], v[228:231], a[176:191]
s_add_u32 s55, s56, 63488
buffer_load_dwordx4 v23, s[12:15], s55 offen offset:2048 lds
s_waitcnt lgkmcnt(10)
v_mfma_f32_32x32x16_bf16 a[192:207], v[168:171], v[224:227], a[192:207]
v_mfma_f32_32x32x16_bf16 a[208:223], v[168:171], v[228:231], a[208:223]
s_add_u32 s55, s56, 95232
buffer_load_dwordx4 v23, s[12:15], s55 offen offset:3072 lds
s_waitcnt lgkmcnt(8)
v_mfma_f32_32x32x16_bf16 a[224:239], v[172:175], v[224:227], a[224:239]
s_add_u32 s61, s58, s69
s_and_b32 s61, s61, 15
s_lshl_b32 s61, s61, 6
s_xor_b32 s60, s61, 32
v_xor_b32 v33, s61, v38
v_xor_b32 v34, s61, v39
v_xor_b32 v35, s60, v38
v_xor_b32 v36, s60, v39
ds_read_b128 v[144:147], v33
ds_read_b128 v[148:151], v34
ds_read_b128 v[152:155], v35
ds_read_b128 v[156:159], v36
s_add_u32 s58, s58, 1
s_waitcnt vmcnt(4)
ds_read_b64_tr_b16 v[192:193], v14 offset:0
ds_read_b64_tr_b16 v[194:195], v14 offset:1024
v_mfma_f32_32x32x16_bf16 a[240:255], v[172:175], v[228:231], a[240:255]
s_add_u32 m0, s32, 12288
s_add_u32 s55, s56, 131072
buffer_load_dwordx4 v23, s[12:15], s55 offen offset:0 lds
s_waitcnt lgkmcnt(12)
v_mfma_f32_32x32x16_bf16 a[128:143], v[176:179], v[232:235], a[128:143]
ds_read_b64_tr_b16 v[196:197], v15 offset:0
ds_read_b64_tr_b16 v[198:199], v15 offset:1024
v_mfma_f32_32x32x16_bf16 a[144:159], v[176:179], v[236:239], a[144:159]
s_add_u32 s55, s56, 162816
buffer_load_dwordx4 v23, s[12:15], s55 offen offset:1024 lds
s_waitcnt lgkmcnt(12)
v_mfma_f32_32x32x16_bf16 a[160:175], v[180:183], v[232:235], a[160:175]
ds_read_b64_tr_b16 v[200:201], v16 offset:0
ds_read_b64_tr_b16 v[202:203], v16 offset:1024
v_mfma_f32_32x32x16_bf16 a[176:191], v[180:183], v[236:239], a[176:191]
s_add_u32 s55, s56, 194560
buffer_load_dwordx4 v23, s[12:15], s55 offen offset:2048 lds
s_waitcnt lgkmcnt(12)
v_mfma_f32_32x32x16_bf16 a[192:207], v[184:187], v[232:235], a[192:207]
ds_read_b64_tr_b16 v[204:205], v17 offset:0
ds_read_b64_tr_b16 v[206:207], v17 offset:1024
v_mfma_f32_32x32x16_bf16 a[208:223], v[184:187], v[236:239], a[208:223]
s_add_u32 s55, s56, 226304
buffer_load_dwordx4 v23, s[12:15], s55 offen offset:3072 lds
s_waitcnt lgkmcnt(12)
v_mfma_f32_32x32x16_bf16 a[224:239], v[188:191], v[232:235], a[224:239]
ds_read_b64_tr_b16 v[208:209], v14 offset:4096
ds_read_b64_tr_b16 v[210:211], v14 offset:5120
v_mfma_f32_32x32x16_bf16 a[240:255], v[188:191], v[236:239], a[240:255]
s_add_u32 s56, s54, s69
s_and_b32 s56, s56, 15
s_lshl_b32 s56, s56, 18
s_add_u32 s56, s56, s35
s_add_u32 s54, s54, 1
s_add_u32 m0, s32, 16384
s_add_u32 s55, s56, 0
buffer_load_dwordx4 v23, s[12:15], s55 offen offset:0 lds
s_waitcnt lgkmcnt(8)
v_mfma_f32_32x32x16_bf16 a[128:143], v[192:195], v[144:147], a[128:143]
ds_read_b64_tr_b16 v[212:213], v15 offset:4096
ds_read_b64_tr_b16 v[214:215], v15 offset:5120
ds_read_b64_tr_b16 v[216:217], v16 offset:4096
ds_read_b64_tr_b16 v[218:219], v16 offset:5120
v_mfma_f32_32x32x16_bf16 a[144:159], v[192:195], v[148:151], a[144:159]
s_add_u32 s55, s56, 31744
buffer_load_dwordx4 v23, s[12:15], s55 offen offset:1024 lds
s_waitcnt lgkmcnt(10)
v_mfma_f32_32x32x16_bf16 a[160:175], v[196:199], v[144:147], a[160:175]
ds_read_b64_tr_b16 v[220:221], v17 offset:4096
ds_read_b64_tr_b16 v[222:223], v17 offset:5120
v_mfma_f32_32x32x16_bf16 a[176:191], v[196:199], v[148:151], a[176:191]
s_add_u32 s55, s56, 63488
buffer_load_dwordx4 v23, s[12:15], s55 offen offset:2048 lds
s_waitcnt lgkmcnt(10)
v_mfma_f32_32x32x16_bf16 a[192:207], v[200:203], v[144:147], a[192:207]
v_mfma_f32_32x32x16_bf16 a[208:223], v[200:203], v[148:151], a[208:223]
s_add_u32 s55, s56, 95232
buffer_load_dwordx4 v23, s[12:15], s55 offen offset:3072 lds
s_waitcnt lgkmcnt(8)
v_mfma_f32_32x32x16_bf16 a[224:239], v[204:207], v[144:147], a[224:239]
s_add_u32 s61, s58, s69
s_and_b32 s61, s61, 15
s_lshl_b32 s61, s61, 6
s_xor_b32 s60, s61, 32
v_xor_b32 v33, s61, v38
v_xor_b32 v34, s61, v39
v_xor_b32 v35, s60, v38
v_xor_b32 v36, s60, v39
ds_read_b128 v[224:227], v33
ds_read_b128 v[228:231], v34
ds_read_b128 v[232:235], v35
ds_read_b128 v[236:239], v36
s_add_u32 s58, s58, 1
s_waitcnt vmcnt(4)
ds_read_b64_tr_b16 v[160:161], v14 offset:8192
ds_read_b64_tr_b16 v[162:163], v14 offset:9216
v_mfma_f32_32x32x16_bf16 a[240:255], v[204:207], v[148:151], a[240:255]
s_add_u32 m0, s32, 20480
s_add_u32 s55, s56, 131072
buffer_load_dwordx4 v23, s[12:15], s55 offen offset:0 lds
s_waitcnt lgkmcnt(12)
v_mfma_f32_32x32x16_bf16 a[128:143], v[208:211], v[152:155], a[128:143]
ds_read_b64_tr_b16 v[164:165], v15 offset:8192
ds_read_b64_tr_b16 v[166:167], v15 offset:9216
v_mfma_f32_32x32x16_bf16 a[144:159], v[208:211], v[156:159], a[144:159]
s_add_u32 s55, s56, 162816
buffer_load_dwordx4 v23, s[12:15], s55 offen offset:1024 lds
s_waitcnt lgkmcnt(12)
v_mfma_f32_32x32x16_bf16 a[160:175], v[212:215], v[152:155], a[160:175]
ds_read_b64_tr_b16 v[168:169], v16 offset:8192
ds_read_b64_tr_b16 v[170:171], v16 offset:9216
v_mfma_f32_32x32x16_bf16 a[176:191], v[212:215], v[156:159], a[176:191]
s_add_u32 s55, s56, 194560
buffer_load_dwordx4 v23, s[12:15], s55 offen offset:2048 lds
s_waitcnt lgkmcnt(12)
v_mfma_f32_32x32x16_bf16 a[192:207], v[216:219], v[152:155], a[192:207]
ds_read_b64_tr_b16 v[172:173], v17 offset:8192
ds_read_b64_tr_b16 v[174:175], v17 offset:9216
v_mfma_f32_32x32x16_bf16 a[208:223], v[216:219], v[156:159], a[208:223]
s_add_u32 s55, s56, 226304
buffer_load_dwordx4 v23, s[12:15], s55 offen offset:3072 lds
s_waitcnt lgkmcnt(12)
v_mfma_f32_32x32x16_bf16 a[224:239], v[220:223], v[152:155], a[224:239]
ds_read_b64_tr_b16 v[176:177], v14 offset:12288
ds_read_b64_tr_b16 v[178:179], v14 offset:13312
v_mfma_f32_32x32x16_bf16 a[240:255], v[220:223], v[156:159], a[240:255]
s_add_u32 m0, s32, 0
s_add_u32 s55, s33, 0
buffer_load_dwordx4 v18, s[4:7], s55 offen offset:0 nt lds
s_waitcnt lgkmcnt(8)
v_mfma_f32_32x32x16_bf16 a[128:143], v[160:163], v[224:227], a[128:143]
ds_read_b64_tr_b16 v[180:181], v15 offset:12288
ds_read_b64_tr_b16 v[182:183], v15 offset:13312
ds_read_b64_tr_b16 v[184:185], v16 offset:12288
ds_read_b64_tr_b16 v[186:187], v16 offset:13312
v_mfma_f32_32x32x16_bf16 a[144:159], v[160:163], v[228:231], a[144:159]
buffer_load_dwordx4 v19, s[4:7], s55 offen offset:1024 nt lds
s_waitcnt lgkmcnt(10)
v_mfma_f32_32x32x16_bf16 a[160:175], v[164:167], v[224:227], a[160:175]
ds_read_b64_tr_b16 v[188:189], v17 offset:12288
ds_read_b64_tr_b16 v[190:191], v17 offset:13312
v_mfma_f32_32x32x16_bf16 a[176:191], v[164:167], v[228:231], a[176:191]
buffer_load_dwordx4 v20, s[4:7], s55 offen offset:2048 nt lds
s_waitcnt lgkmcnt(10)
v_mfma_f32_32x32x16_bf16 a[192:207], v[168:171], v[224:227], a[192:207]
v_mfma_f32_32x32x16_bf16 a[208:223], v[168:171], v[228:231], a[208:223]
buffer_load_dwordx4 v21, s[4:7], s55 offen offset:3072 nt lds
s_waitcnt lgkmcnt(8)
v_mfma_f32_32x32x16_bf16 a[224:239], v[172:175], v[224:227], a[224:239]
s_add_u32 s61, s58, s69
s_and_b32 s61, s61, 15
s_lshl_b32 s61, s61, 6
s_xor_b32 s60, s61, 32
v_xor_b32 v33, s61, v38
v_xor_b32 v34, s61, v39
v_xor_b32 v35, s60, v38
v_xor_b32 v36, s60, v39
ds_read_b128 v[144:147], v33
ds_read_b128 v[148:151], v34
ds_read_b128 v[152:155], v35
ds_read_b128 v[156:159], v36
s_add_u32 s58, s58, 1
s_waitcnt vmcnt(4)
ds_read_b64_tr_b16 v[192:193], v14 offset:16384
ds_read_b64_tr_b16 v[194:195], v14 offset:17408
v_mfma_f32_32x32x16_bf16 a[240:255], v[172:175], v[228:231], a[240:255]
s_add_u32 m0, s32, 4096
s_add_u32 s55, s33, 4096
buffer_load_dwordx4 v18, s[4:7], s55 offen offset:0 nt lds
s_waitcnt lgkmcnt(12)
v_mfma_f32_32x32x16_bf16 a[128:143], v[176:179], v[232:235], a[128:143]
ds_read_b64_tr_b16 v[196:197], v15 offset:16384
ds_read_b64_tr_b16 v[198:199], v15 offset:17408
v_mfma_f32_32x32x16_bf16 a[144:159], v[176:179], v[236:239], a[144:159]
buffer_load_dwordx4 v19, s[4:7], s55 offen offset:1024 nt lds
s_waitcnt lgkmcnt(12)
v_mfma_f32_32x32x16_bf16 a[160:175], v[180:183], v[232:235], a[160:175]
ds_read_b64_tr_b16 v[200:201], v16 offset:16384
ds_read_b64_tr_b16 v[202:203], v16 offset:17408
v_mfma_f32_32x32x16_bf16 a[176:191], v[180:183], v[236:239], a[176:191]
buffer_load_dwordx4 v20, s[4:7], s55 offen offset:2048 nt lds
s_waitcnt lgkmcnt(12)
v_mfma_f32_32x32x16_bf16 a[192:207], v[184:187], v[232:235], a[192:207]
ds_read_b64_tr_b16 v[204:205], v17 offset:16384
ds_read_b64_tr_b16 v[206:207], v17 offset:17408
v_mfma_f32_32x32x16_bf16 a[208:223], v[184:187], v[236:239], a[208:223]
buffer_load_dwordx4 v21, s[4:7], s55 offen offset:3072 nt lds
s_add_u32 s33, s33, 8192
s_waitcnt lgkmcnt(12)
v_mfma_f32_32x32x16_bf16 a[224:239], v[188:191], v[232:235], a[224:239]
ds_read_b64_tr_b16 v[208:209], v14 offset:20480
ds_read_b64_tr_b16 v[210:211], v14 offset:21504
v_mfma_f32_32x32x16_bf16 a[240:255], v[188:191], v[236:239], a[240:255]
s_add_u32 m0, s32, 8192
s_add_u32 s55, s34, 0
buffer_load_dwordx4 v22, s[8:11], s55 offen offset:0 nt lds
s_waitcnt lgkmcnt(8)
v_mfma_f32_32x32x16_bf16 a[128:143], v[192:195], v[144:147], a[128:143]
ds_read_b64_tr_b16 v[212:213], v15 offset:20480
ds_read_b64_tr_b16 v[214:215], v15 offset:21504
ds_read_b64_tr_b16 v[216:217], v16 offset:20480
ds_read_b64_tr_b16 v[218:219], v16 offset:21504
v_mfma_f32_32x32x16_bf16 a[144:159], v[192:195], v[148:151], a[144:159]
buffer_load_dwordx4 v22, s[8:11], s55 offen offset:1024 nt lds
s_waitcnt lgkmcnt(10)
v_mfma_f32_32x32x16_bf16 a[160:175], v[196:199], v[144:147], a[160:175]
ds_read_b64_tr_b16 v[220:221], v17 offset:20480
ds_read_b64_tr_b16 v[222:223], v17 offset:21504
v_mfma_f32_32x32x16_bf16 a[176:191], v[196:199], v[148:151], a[176:191]
buffer_load_dwordx4 v22, s[8:11], s55 offen offset:2048 nt lds
s_waitcnt lgkmcnt(10)
v_mfma_f32_32x32x16_bf16 a[192:207], v[200:203], v[144:147], a[192:207]
v_mfma_f32_32x32x16_bf16 a[208:223], v[200:203], v[148:151], a[208:223]
buffer_load_dwordx4 v22, s[8:11], s55 offen offset:3072 nt lds
s_waitcnt lgkmcnt(8)
v_mfma_f32_32x32x16_bf16 a[224:239], v[204:207], v[144:147], a[224:239]
v_mfma_f32_32x32x16_bf16 a[240:255], v[204:207], v[148:151], a[240:255]
s_add_u32 m0, s32, 12288
s_add_u32 s55, s34, 4096
buffer_load_dwordx4 v22, s[8:11], s55 offen offset:0 nt lds
s_waitcnt lgkmcnt(6)
v_mfma_f32_32x32x16_bf16 a[128:143], v[208:211], v[152:155], a[128:143]
v_mfma_f32_32x32x16_bf16 a[144:159], v[208:211], v[156:159], a[144:159]
buffer_load_dwordx4 v22, s[8:11], s55 offen offset:1024 nt lds
s_waitcnt lgkmcnt(4)
v_mfma_f32_32x32x16_bf16 a[160:175], v[212:215], v[152:155], a[160:175]
v_mfma_f32_32x32x16_bf16 a[176:191], v[212:215], v[156:159], a[176:191]
buffer_load_dwordx4 v22, s[8:11], s55 offen offset:2048 nt lds
s_waitcnt lgkmcnt(2)
v_mfma_f32_32x32x16_bf16 a[192:207], v[216:219], v[152:155], a[192:207]
v_mfma_f32_32x32x16_bf16 a[208:223], v[216:219], v[156:159], a[208:223]
buffer_load_dwordx4 v22, s[8:11], s55 offen offset:3072 nt lds
s_add_u32 s34, s34, 8192
s_waitcnt lgkmcnt(0)
v_mfma_f32_32x32x16_bf16 a[224:239], v[220:223], v[152:155], a[224:239]
v_mfma_f32_32x32x16_bf16 a[240:255], v[220:223], v[156:159], a[240:255]
s_add_u32 s35, s35, 256
s_add_u32 s56, s54, s69
s_and_b32 s56, s56, 15
s_lshl_b32 s56, s56, 18
s_add_u32 s56, s56, s35
s_add_u32 s54, s54, 1
s_add_u32 m0, s32, 16384
s_add_u32 s55, s56, 0
buffer_load_dwordx4 v23, s[12:15], s55 offen offset:0 lds
s_add_u32 s55, s56, 31744
buffer_load_dwordx4 v23, s[12:15], s55 offen offset:1024 lds
s_add_u32 s55, s56, 63488
buffer_load_dwordx4 v23, s[12:15], s55 offen offset:2048 lds
s_add_u32 s55, s56, 95232
buffer_load_dwordx4 v23, s[12:15], s55 offen offset:3072 lds
s_add_u32 m0, s32, 20480
s_add_u32 s55, s56, 131072
buffer_load_dwordx4 v23, s[12:15], s55 offen offset:0 lds
s_add_u32 s55, s56, 162816
buffer_load_dwordx4 v23, s[12:15], s55 offen offset:1024 lds
s_add_u32 s55, s56, 194560
buffer_load_dwordx4 v23, s[12:15], s55 offen offset:2048 lds
s_add_u32 s55, s56, 226304
buffer_load_dwordx4 v23, s[12:15], s55 offen offset:3072 lds
s_nop 7
s_nop 7
v_accvgpr_read_b32 v240, a128
v_accvgpr_read_b32 v241, a129
v_accvgpr_read_b32 v242, a130
v_accvgpr_read_b32 v243, a131
v_accvgpr_read_b32 v244, a132
v_accvgpr_read_b32 v245, a133
v_accvgpr_read_b32 v246, a134
v_accvgpr_read_b32 v247, a135
v_accvgpr_read_b32 v248, a136
v_accvgpr_read_b32 v249, a137
v_accvgpr_read_b32 v250, a138
v_accvgpr_read_b32 v251, a139
v_accvgpr_read_b32 v252, a140
v_accvgpr_read_b32 v253, a141
v_accvgpr_read_b32 v254, a142
v_accvgpr_read_b32 v255, a143
v_cvt_pk_bf16_f32 v48, v240, v241
v_cvt_pk_bf16_f32 v49, v242, v243
v_cvt_pk_bf16_f32 v50, v244, v245
v_cvt_pk_bf16_f32 v51, v246, v247
v_cvt_pk_bf16_f32 v56, v248, v249
v_cvt_pk_bf16_f32 v57, v250, v251
v_cvt_pk_bf16_f32 v58, v252, v253
v_cvt_pk_bf16_f32 v59, v254, v255
v_accvgpr_read_b32 v240, a144
v_accvgpr_read_b32 v241, a145
v_accvgpr_read_b32 v242, a146
v_accvgpr_read_b32 v243, a147
v_accvgpr_read_b32 v244, a148
v_accvgpr_read_b32 v245, a149
v_accvgpr_read_b32 v246, a150
v_accvgpr_read_b32 v247, a151
v_accvgpr_read_b32 v248, a152
v_accvgpr_read_b32 v249, a153
v_accvgpr_read_b32 v250, a154
v_accvgpr_read_b32 v251, a155
v_accvgpr_read_b32 v252, a156
v_accvgpr_read_b32 v253, a157
v_accvgpr_read_b32 v254, a158
v_accvgpr_read_b32 v255, a159
v_cvt_pk_bf16_f32 v52, v240, v241
v_cvt_pk_bf16_f32 v53, v242, v243
v_cvt_pk_bf16_f32 v54, v244, v245
v_cvt_pk_bf16_f32 v55, v246, v247
v_cvt_pk_bf16_f32 v60, v248, v249
v_cvt_pk_bf16_f32 v61, v250, v251
v_cvt_pk_bf16_f32 v62, v252, v253
v_cvt_pk_bf16_f32 v63, v254, v255
v_accvgpr_read_b32 v240, a160
v_accvgpr_read_b32 v241, a161
v_accvgpr_read_b32 v242, a162
v_accvgpr_read_b32 v243, a163
v_accvgpr_read_b32 v244, a164
v_accvgpr_read_b32 v245, a165
v_accvgpr_read_b32 v246, a166
v_accvgpr_read_b32 v247, a167
v_accvgpr_read_b32 v248, a168
v_accvgpr_read_b32 v249, a169
v_accvgpr_read_b32 v250, a170
v_accvgpr_read_b32 v251, a171
v_accvgpr_read_b32 v252, a172
v_accvgpr_read_b32 v253, a173
v_accvgpr_read_b32 v254, a174
v_accvgpr_read_b32 v255, a175
v_cvt_pk_bf16_f32 v64, v240, v241
v_cvt_pk_bf16_f32 v65, v242, v243
v_cvt_pk_bf16_f32 v66, v244, v245
v_cvt_pk_bf16_f32 v67, v246, v247
v_cvt_pk_bf16_f32 v72, v248, v249
v_cvt_pk_bf16_f32 v73, v250, v251
v_cvt_pk_bf16_f32 v74, v252, v253
v_cvt_pk_bf16_f32 v75, v254, v255
v_accvgpr_read_b32 v240, a176
v_accvgpr_read_b32 v241, a177
v_accvgpr_read_b32 v242, a178
v_accvgpr_read_b32 v243, a179
v_accvgpr_read_b32 v244, a180
v_accvgpr_read_b32 v245, a181
v_accvgpr_read_b32 v246, a182
v_accvgpr_read_b32 v247, a183
v_accvgpr_read_b32 v248, a184
v_accvgpr_read_b32 v249, a185
v_accvgpr_read_b32 v250, a186
v_accvgpr_read_b32 v251, a187
v_accvgpr_read_b32 v252, a188
v_accvgpr_read_b32 v253, a189
v_accvgpr_read_b32 v254, a190
v_accvgpr_read_b32 v255, a191
v_cvt_pk_bf16_f32 v68, v240, v241
v_cvt_pk_bf16_f32 v69, v242, v243
v_cvt_pk_bf16_f32 v70, v244, v245
v_cvt_pk_bf16_f32 v71, v246, v247
v_cvt_pk_bf16_f32 v76, v248, v249
v_cvt_pk_bf16_f32 v77, v250, v251
v_cvt_pk_bf16_f32 v78, v252, v253
v_cvt_pk_bf16_f32 v79, v254, v255
v_accvgpr_read_b32 v240, a192
v_accvgpr_read_b32 v241, a193
v_accvgpr_read_b32 v242, a194
v_accvgpr_read_b32 v243, a195
v_accvgpr_read_b32 v244, a196
v_accvgpr_read_b32 v245, a197
v_accvgpr_read_b32 v246, a198
v_accvgpr_read_b32 v247, a199
v_accvgpr_read_b32 v248, a200
v_accvgpr_read_b32 v249, a201
v_accvgpr_read_b32 v250, a202
v_accvgpr_read_b32 v251, a203
v_accvgpr_read_b32 v252, a204
v_accvgpr_read_b32 v253, a205
v_accvgpr_read_b32 v254, a206
v_accvgpr_read_b32 v255, a207
v_cvt_pk_bf16_f32 v80, v240, v241
v_cvt_pk_bf16_f32 v81, v242, v243
v_cvt_pk_bf16_f32 v82, v244, v245
v_cvt_pk_bf16_f32 v83, v246, v247
v_cvt_pk_bf16_f32 v88, v248, v249
v_cvt_pk_bf16_f32 v89, v250, v251
v_cvt_pk_bf16_f32 v90, v252, v253
v_cvt_pk_bf16_f32 v91, v254, v255
v_accvgpr_read_b32 v240, a208
v_accvgpr_read_b32 v241, a209
v_accvgpr_read_b32 v242, a210
v_accvgpr_read_b32 v243, a211
v_accvgpr_read_b32 v244, a212
v_accvgpr_read_b32 v245, a213
v_accvgpr_read_b32 v246, a214
v_accvgpr_read_b32 v247, a215
v_accvgpr_read_b32 v248, a216
v_accvgpr_read_b32 v249, a217
v_accvgpr_read_b32 v250, a218
v_accvgpr_read_b32 v251, a219
v_accvgpr_read_b32 v252, a220
v_accvgpr_read_b32 v253, a221
v_accvgpr_read_b32 v254, a222
v_accvgpr_read_b32 v255, a223
v_cvt_pk_bf16_f32 v84, v240, v241
v_cvt_pk_bf16_f32 v85, v242, v243
v_cvt_pk_bf16_f32 v86, v244, v245
v_cvt_pk_bf16_f32 v87, v246, v247
v_cvt_pk_bf16_f32 v92, v248, v249
v_cvt_pk_bf16_f32 v93, v250, v251
v_cvt_pk_bf16_f32 v94, v252, v253
v_cvt_pk_bf16_f32 v95, v254, v255
v_accvgpr_read_b32 v240, a224
v_accvgpr_read_b32 v241, a225
v_accvgpr_read_b32 v242, a226
v_accvgpr_read_b32 v243, a227
v_accvgpr_read_b32 v244, a228
v_accvgpr_read_b32 v245, a229
v_accvgpr_read_b32 v246, a230
v_accvgpr_read_b32 v247, a231
v_accvgpr_read_b32 v248, a232
v_accvgpr_read_b32 v249, a233
v_accvgpr_read_b32 v250, a234
v_accvgpr_read_b32 v251, a235
v_accvgpr_read_b32 v252, a236
v_accvgpr_read_b32 v253, a237
v_accvgpr_read_b32 v254, a238
v_accvgpr_read_b32 v255, a239
v_cvt_pk_bf16_f32 v96, v240, v241
v_cvt_pk_bf16_f32 v97, v242, v243
v_cvt_pk_bf16_f32 v98, v244, v245
v_cvt_pk_bf16_f32 v99, v246, v247
v_cvt_pk_bf16_f32 v104, v248, v249
v_cvt_pk_bf16_f32 v105, v250, v251
v_cvt_pk_bf16_f32 v106, v252, v253
v_cvt_pk_bf16_f32 v107, v254, v255
v_accvgpr_read_b32 v240, a240
v_accvgpr_read_b32 v241, a241
v_accvgpr_read_b32 v242, a242
v_accvgpr_read_b32 v243, a243
v_accvgpr_read_b32 v244, a244
v_accvgpr_read_b32 v245, a245
v_accvgpr_read_b32 v246, a246
v_accvgpr_read_b32 v247, a247
v_accvgpr_read_b32 v248, a248
v_accvgpr_read_b32 v249, a249
v_accvgpr_read_b32 v250, a250
v_accvgpr_read_b32 v251, a251
v_accvgpr_read_b32 v252, a252
v_accvgpr_read_b32 v253, a253
v_accvgpr_read_b32 v254, a254
v_accvgpr_read_b32 v255, a255
v_cvt_pk_bf16_f32 v100, v240, v241
v_cvt_pk_bf16_f32 v101, v242, v243
v_cvt_pk_bf16_f32 v102, v244, v245
v_cvt_pk_bf16_f32 v103, v246, v247
v_cvt_pk_bf16_f32 v108, v248, v249
v_cvt_pk_bf16_f32 v109, v250, v251
v_cvt_pk_bf16_f32 v110, v252, v253
v_cvt_pk_bf16_f32 v111, v254, v255
s_waitcnt vmcnt(16)
ds_read_b128 v[192:195], v2 offset:0
ds_read_b128 v[196:199], v3 offset:0
ds_read_b128 v[200:203], v4 offset:0
ds_read_b128 v[204:207], v5 offset:0
ds_read_b128 v[208:211], v6 offset:0
ds_read_b128 v[212:215], v7 offset:0
ds_read_b128 v[216:219], v8 offset:0
ds_read_b128 v[220:223], v9 offset:0
s_waitcnt lgkmcnt(7)
v_mfma_f32_32x32x16_bf16 v[112:127], v[192:195], v[48:51], 0
v_mfma_f32_32x32x16_bf16 v[128:143], v[192:195], v[52:55], 0
s_waitcnt lgkmcnt(6)
v_mfma_f32_32x32x16_bf16 v[112:127], v[196:199], v[56:59], v[112:127]
v_mfma_f32_32x32x16_bf16 v[128:143], v[196:199], v[60:63], v[128:143]
s_waitcnt lgkmcnt(5)
v_mfma_f32_32x32x16_bf16 v[112:127], v[200:203], v[64:67], v[112:127]
v_mfma_f32_32x32x16_bf16 v[128:143], v[200:203], v[68:71], v[128:143]
s_waitcnt lgkmcnt(4)
v_mfma_f32_32x32x16_bf16 v[112:127], v[204:207], v[72:75], v[112:127]
v_mfma_f32_32x32x16_bf16 v[128:143], v[204:207], v[76:79], v[128:143]
s_waitcnt lgkmcnt(3)
v_mfma_f32_32x32x16_bf16 v[112:127], v[208:211], v[80:83], v[112:127]
v_mfma_f32_32x32x16_bf16 v[128:143], v[208:211], v[84:87], v[128:143]
s_waitcnt lgkmcnt(2)
v_mfma_f32_32x32x16_bf16 v[112:127], v[212:215], v[88:91], v[112:127]
v_mfma_f32_32x32x16_bf16 v[128:143], v[212:215], v[92:95], v[128:143]
s_waitcnt lgkmcnt(1)
v_mfma_f32_32x32x16_bf16 v[112:127], v[216:219], v[96:99], v[112:127]
v_mfma_f32_32x32x16_bf16 v[128:143], v[216:219], v[100:103], v[128:143]
s_waitcnt lgkmcnt(0)
v_mfma_f32_32x32x16_bf16 v[112:127], v[220:223], v[104:107], v[112:127]
v_mfma_f32_32x32x16_bf16 v[128:143], v[220:223], v[108:111], v[128:143]
s_add_u32 m0, s32, 0
s_add_u32 s55, s33, 0
buffer_load_dwordx4 v18, s[4:7], s55 offen offset:0 nt lds
buffer_load_dwordx4 v19, s[4:7], s55 offen offset:1024 nt lds
buffer_load_dwordx4 v20, s[4:7], s55 offen offset:2048 nt lds
buffer_load_dwordx4 v21, s[4:7], s55 offen offset:3072 nt lds
s_add_u32 m0, s32, 4096
s_add_u32 s55, s33, 4096
buffer_load_dwordx4 v18, s[4:7], s55 offen offset:0 nt lds
buffer_load_dwordx4 v19, s[4:7], s55 offen offset:1024 nt lds
buffer_load_dwordx4 v20, s[4:7], s55 offen offset:2048 nt lds
buffer_load_dwordx4 v21, s[4:7], s55 offen offset:3072 nt lds
s_add_u32 s33, s33, 8192
s_nop 7
s_nop 7
v_max3_f32 v33, v112, v113, v114
v_max3_f32 v34, v128, v129, v130
v_max3_f32 v33, v33, v115, v116
v_max3_f32 v34, v34, v131, v132
v_max3_f32 v33, v33, v117, v118
v_max3_f32 v34, v34, v133, v134
v_max3_f32 v33, v33, v119, v120
v_max3_f32 v34, v34, v135, v136
v_max3_f32 v33, v33, v121, v122
v_max3_f32 v34, v34, v137, v138
v_max3_f32 v33, v33, v123, v124
v_max3_f32 v34, v34, v139, v140
v_max3_f32 v33, v33, v125, v126
v_max3_f32 v34, v34, v141, v142
v_max_f32 v33, v33, v127
v_max_f32 v34, v34, v143
s_nop 1
v_permlane32_swap_b32 v33, v34
s_nop 1
v_max_f32 v35, v33, v34
v_mov_b32 v29, v35
v_add_f32 v30, s67, v35
v_mul_f32 v31, s62, v35
v_mul_f32 v32, s62, v35
v_mov_b32 v40, 0
v_mov_b32 v41, 0
v_mov_b32 v42, 0
v_mov_b32 v43, 0
v_mov_b32 v44, 0
v_mov_b32 v45, 0
v_mov_b32 v46, 0
v_mov_b32 v47, 0
v_permlane32_swap_b32 v31, v32
s_nop 1
v_fma_f32 v112, v112, s62, -v31
v_fma_f32 v128, v128, s62, -v32
v_fma_f32 v113, v113, s62, -v31
v_fma_f32 v129, v129, s62, -v32
v_fma_f32 v114, v114, s62, -v31
v_fma_f32 v130, v130, s62, -v32
v_fma_f32 v115, v115, s62, -v31
v_fma_f32 v131, v131, s62, -v32
v_fma_f32 v116, v116, s62, -v31
v_fma_f32 v132, v132, s62, -v32
v_fma_f32 v117, v117, s62, -v31
v_fma_f32 v133, v133, s62, -v32
v_fma_f32 v118, v118, s62, -v31
v_fma_f32 v134, v134, s62, -v32
v_fma_f32 v119, v119, s62, -v31
v_fma_f32 v135, v135, s62, -v32
v_fma_f32 v120, v120, s62, -v31
v_fma_f32 v136, v136, s62, -v32
v_fma_f32 v121, v121, s62, -v31
v_fma_f32 v137, v137, s62, -v32
v_fma_f32 v122, v122, s62, -v31
v_fma_f32 v138, v138, s62, -v32
v_fma_f32 v123, v123, s62, -v31
v_fma_f32 v139, v139, s62, -v32
v_fma_f32 v124, v124, s62, -v31
v_fma_f32 v140, v140, s62, -v32
v_fma_f32 v125, v125, s62, -v31
v_fma_f32 v141, v141, s62, -v32
v_fma_f32 v126, v126, s62, -v31
v_fma_f32 v142, v142, s62, -v32
v_fma_f32 v127, v127, s62, -v31
v_fma_f32 v143, v143, s62, -v32
v_exp_f32 v112, v112
v_exp_f32 v128, v128
v_exp_f32 v113, v113
v_exp_f32 v129, v129
v_exp_f32 v114, v114
v_exp_f32 v130, v130
v_exp_f32 v115, v115
v_exp_f32 v131, v131
v_exp_f32 v116, v116
v_exp_f32 v132, v132
v_exp_f32 v117, v117
v_exp_f32 v133, v133
v_exp_f32 v118, v118
v_exp_f32 v134, v134
v_exp_f32 v119, v119
v_exp_f32 v135, v135
v_exp_f32 v120, v120
v_exp_f32 v136, v136
v_exp_f32 v121, v121
v_exp_f32 v137, v137
v_exp_f32 v122, v122
v_exp_f32 v138, v138
v_exp_f32 v123, v123
v_exp_f32 v139, v139
v_exp_f32 v124, v124
v_exp_f32 v140, v140
v_exp_f32 v125, v125
v_exp_f32 v141, v141
v_exp_f32 v126, v126
v_exp_f32 v142, v142
v_exp_f32 v127, v127
v_exp_f32 v143, v143
s_nop 0
v_add_f32 v40, v40, v112
v_add_f32 v44, v44, v128
v_add_f32 v41, v41, v113
v_add_f32 v45, v45, v129
v_add_f32 v42, v42, v114
v_add_f32 v46, v46, v130
v_add_f32 v43, v43, v115
v_add_f32 v47, v47, v131
v_add_f32 v40, v40, v116
v_add_f32 v44, v44, v132
v_add_f32 v41, v41, v117
v_add_f32 v45, v45, v133
v_add_f32 v42, v42, v118
v_add_f32 v46, v46, v134
v_add_f32 v43, v43, v119
v_add_f32 v47, v47, v135
v_add_f32 v40, v40, v120
v_add_f32 v44, v44, v136
v_add_f32 v41, v41, v121
v_add_f32 v45, v45, v137
v_add_f32 v42, v42, v122
v_add_f32 v46, v46, v138
v_add_f32 v43, v43, v123
v_add_f32 v47, v47, v139
v_add_f32 v40, v40, v124
v_add_f32 v44, v44, v140
v_add_f32 v41, v41, v125
v_add_f32 v45, v45, v141
v_add_f32 v42, v42, v126
v_add_f32 v46, v46, v142
v_add_f32 v43, v43, v127
v_add_f32 v47, v47, v143
v_cvt_pk_bf16_f32 v144, v112, v113
v_cvt_pk_bf16_f32 v145, v114, v115
v_cvt_pk_bf16_f32 v146, v116, v117
v_cvt_pk_bf16_f32 v147, v118, v119
v_cvt_pk_bf16_f32 v148, v120, v121
v_cvt_pk_bf16_f32 v149, v122, v123
v_cvt_pk_bf16_f32 v150, v124, v125
v_cvt_pk_bf16_f32 v151, v126, v127
v_cvt_pk_bf16_f32 v152, v128, v129
v_cvt_pk_bf16_f32 v153, v130, v131
v_cvt_pk_bf16_f32 v154, v132, v133
v_cvt_pk_bf16_f32 v155, v134, v135
v_cvt_pk_bf16_f32 v156, v136, v137
v_cvt_pk_bf16_f32 v157, v138, v139
v_cvt_pk_bf16_f32 v158, v140, v141
v_cvt_pk_bf16_f32 v159, v142, v143
s_waitcnt vmcnt(16)
ds_read_b64_tr_b16 v[160:161], v10 offset:8192
ds_read_b64_tr_b16 v[162:163], v10 offset:10240
ds_read_b64_tr_b16 v[164:165], v11 offset:8192
ds_read_b64_tr_b16 v[166:167], v11 offset:10240
ds_read_b64_tr_b16 v[168:169], v12 offset:8192
ds_read_b64_tr_b16 v[170:171], v12 offset:10240
ds_read_b64_tr_b16 v[172:173], v13 offset:8192
ds_read_b64_tr_b16 v[174:175], v13 offset:10240
ds_read_b64_tr_b16 v[176:177], v10 offset:12288
ds_read_b64_tr_b16 v[178:179], v10 offset:14336
ds_read_b64_tr_b16 v[180:181], v11 offset:12288
ds_read_b64_tr_b16 v[182:183], v11 offset:14336
s_waitcnt lgkmcnt(10)
v_mfma_f32_32x32x16_bf16 a[0:15], v[160:163], v[144:147], 0
v_mfma_f32_32x32x16_bf16 a[16:31], v[160:163], v[152:155], 0
ds_read_b64_tr_b16 v[184:185], v12 offset:12288
ds_read_b64_tr_b16 v[186:187], v12 offset:14336
s_waitcnt lgkmcnt(10)
v_mfma_f32_32x32x16_bf16 a[32:47], v[164:167], v[144:147], 0
v_mfma_f32_32x32x16_bf16 a[48:63], v[164:167], v[152:155], 0
ds_read_b64_tr_b16 v[188:189], v13 offset:12288
ds_read_b64_tr_b16 v[190:191], v13 offset:14336
s_waitcnt lgkmcnt(10)
v_mfma_f32_32x32x16_bf16 a[64:79], v[168:171], v[144:147], 0
v_mfma_f32_32x32x16_bf16 a[80:95], v[168:171], v[152:155], 0
s_waitcnt lgkmcnt(8)
v_mfma_f32_32x32x16_bf16 a[96:111], v[172:175], v[144:147], 0
v_mfma_f32_32x32x16_bf16 a[112:127], v[172:175], v[152:155], 0
s_waitcnt lgkmcnt(6)
v_mfma_f32_32x32x16_bf16 a[0:15], v[176:179], v[148:151], a[0:15]
v_mfma_f32_32x32x16_bf16 a[16:31], v[176:179], v[156:159], a[16:31]
s_waitcnt lgkmcnt(4)
v_mfma_f32_32x32x16_bf16 a[32:47], v[180:183], v[148:151], a[32:47]
v_mfma_f32_32x32x16_bf16 a[48:63], v[180:183], v[156:159], a[48:63]
s_waitcnt lgkmcnt(2)
v_mfma_f32_32x32x16_bf16 a[64:79], v[184:187], v[148:151], a[64:79]
v_mfma_f32_32x32x16_bf16 a[80:95], v[184:187], v[156:159], a[80:95]
s_waitcnt lgkmcnt(0)
v_mfma_f32_32x32x16_bf16 a[96:111], v[188:191], v[148:151], a[96:111]
v_mfma_f32_32x32x16_bf16 a[112:127], v[188:191], v[156:159], a[112:127]
s_add_u32 m0, s32, 8192
s_add_u32 s55, s34, 0
buffer_load_dwordx4 v22, s[8:11], s55 offen offset:0 nt lds
buffer_load_dwordx4 v22, s[8:11], s55 offen offset:1024 nt lds
buffer_load_dwordx4 v22, s[8:11], s55 offen offset:2048 nt lds
buffer_load_dwordx4 v22, s[8:11], s55 offen offset:3072 nt lds
s_add_u32 m0, s32, 12288
s_add_u32 s55, s34, 4096
buffer_load_dwordx4 v22, s[8:11], s55 offen offset:0 nt lds
buffer_load_dwordx4 v22, s[8:11], s55 offen offset:1024 nt lds
buffer_load_dwordx4 v22, s[8:11], s55 offen offset:2048 nt lds
buffer_load_dwordx4 v22, s[8:11], s55 offen offset:3072 nt lds
s_add_u32 s34, s34, 8192
s_add_u32 s61, s58, s69
s_and_b32 s61, s61, 15
s_lshl_b32 s61, s61, 6
s_xor_b32 s60, s61, 32
v_xor_b32 v33, s61, v38
v_xor_b32 v34, s61, v39
v_xor_b32 v35, s60, v38
v_xor_b32 v36, s60, v39
ds_read_b128 v[224:227], v33
ds_read_b128 v[228:231], v34
ds_read_b128 v[232:235], v35
ds_read_b128 v[236:239], v36
s_add_u32 s58, s58, 1
s_waitcnt vmcnt(16)
s_waitcnt lgkmcnt(0)
ds_read_b64_tr_b16 v[160:161], v14 offset:16384
ds_read_b64_tr_b16 v[162:163], v14 offset:17408
ds_read_b64_tr_b16 v[164:165], v15 offset:16384
ds_read_b64_tr_b16 v[166:167], v15 offset:17408
ds_read_b64_tr_b16 v[168:169], v16 offset:16384
ds_read_b64_tr_b16 v[170:171], v16 offset:17408
ds_read_b64_tr_b16 v[172:173], v17 offset:16384
ds_read_b64_tr_b16 v[174:175], v17 offset:17408
ds_read_b64_tr_b16 v[176:177], v14 offset:20480
ds_read_b64_tr_b16 v[178:179], v14 offset:21504
ds_read_b64_tr_b16 v[180:181], v15 offset:20480
ds_read_b64_tr_b16 v[182:183], v15 offset:21504
s_waitcnt lgkmcnt(10)
v_mfma_f32_32x32x16_bf16 a[128:143], v[160:163], v[224:227], 0
v_mfma_f32_32x32x16_bf16 a[144:159], v[160:163], v[228:231], 0
ds_read_b64_tr_b16 v[184:185], v16 offset:20480
ds_read_b64_tr_b16 v[186:187], v16 offset:21504
s_waitcnt lgkmcnt(10)
v_mfma_f32_32x32x16_bf16 a[160:175], v[164:167], v[224:227], 0
v_mfma_f32_32x32x16_bf16 a[176:191], v[164:167], v[228:231], 0
ds_read_b64_tr_b16 v[188:189], v17 offset:20480
ds_read_b64_tr_b16 v[190:191], v17 offset:21504
s_waitcnt lgkmcnt(10)
v_mfma_f32_32x32x16_bf16 a[192:207], v[168:171], v[224:227], 0
v_mfma_f32_32x32x16_bf16 a[208:223], v[168:171], v[228:231], 0
s_waitcnt lgkmcnt(8)
v_mfma_f32_32x32x16_bf16 a[224:239], v[172:175], v[224:227], 0
v_mfma_f32_32x32x16_bf16 a[240:255], v[172:175], v[228:231], 0
s_waitcnt lgkmcnt(6)
v_mfma_f32_32x32x16_bf16 a[128:143], v[176:179], v[232:235], a[128:143]
v_mfma_f32_32x32x16_bf16 a[144:159], v[176:179], v[236:239], a[144:159]
s_waitcnt lgkmcnt(4)
v_mfma_f32_32x32x16_bf16 a[160:175], v[180:183], v[232:235], a[160:175]
v_mfma_f32_32x32x16_bf16 a[176:191], v[180:183], v[236:239], a[176:191]
s_waitcnt lgkmcnt(2)
v_mfma_f32_32x32x16_bf16 a[192:207], v[184:187], v[232:235], a[192:207]
v_mfma_f32_32x32x16_bf16 a[208:223], v[184:187], v[236:239], a[208:223]
s_waitcnt lgkmcnt(0)
v_mfma_f32_32x32x16_bf16 a[224:239], v[188:191], v[232:235], a[224:239]
v_mfma_f32_32x32x16_bf16 a[240:255], v[188:191], v[236:239], a[240:255]
s_add_u32 s56, s54, s69
s_and_b32 s56, s56, 15
s_lshl_b32 s56, s56, 18
s_add_u32 s56, s56, s35
s_add_u32 s54, s54, 1
s_add_u32 m0, s32, 16384
s_add_u32 s55, s56, 0
buffer_load_dwordx4 v23, s[12:15], s55 offen offset:0 lds
s_add_u32 s55, s56, 31744
buffer_load_dwordx4 v23, s[12:15], s55 offen offset:1024 lds
s_add_u32 s55, s56, 63488
buffer_load_dwordx4 v23, s[12:15], s55 offen offset:2048 lds
s_add_u32 s55, s56, 95232
buffer_load_dwordx4 v23, s[12:15], s55 offen offset:3072 lds
s_add_u32 m0, s32, 20480
s_add_u32 s55, s56, 131072
buffer_load_dwordx4 v23, s[12:15], s55 offen offset:0 lds
s_add_u32 s55, s56, 162816
buffer_load_dwordx4 v23, s[12:15], s55 offen offset:1024 lds
s_add_u32 s55, s56, 194560
buffer_load_dwordx4 v23, s[12:15], s55 offen offset:2048 lds
s_add_u32 s55, s56, 226304
buffer_load_dwordx4 v23, s[12:15], s55 offen offset:3072 lds
s_mov_b32 s63, 14
.p2align 3
L_loop7:
s_waitcnt vmcnt(16)
ds_read_b128 v[192:195], v2 offset:0
ds_read_b128 v[196:199], v3 offset:0
ds_read_b128 v[200:203], v4 offset:0
ds_read_b128 v[204:207], v5 offset:0
ds_read_b128 v[208:211], v6 offset:0
ds_read_b128 v[212:215], v7 offset:0
ds_read_b128 v[216:219], v8 offset:0
ds_read_b128 v[220:223], v9 offset:0
s_waitcnt lgkmcnt(7)
v_mfma_f32_32x32x16_bf16 v[112:127], v[192:195], v[48:51], 0
v_mfma_f32_32x32x16_bf16 v[128:143], v[192:195], v[52:55], 0
s_waitcnt lgkmcnt(6)
v_mfma_f32_32x32x16_bf16 v[112:127], v[196:199], v[56:59], v[112:127]
v_mfma_f32_32x32x16_bf16 v[128:143], v[196:199], v[60:63], v[128:143]
s_waitcnt lgkmcnt(5)
v_mfma_f32_32x32x16_bf16 v[112:127], v[200:203], v[64:67], v[112:127]
v_mfma_f32_32x32x16_bf16 v[128:143], v[200:203], v[68:71], v[128:143]
s_waitcnt lgkmcnt(4)
v_mfma_f32_32x32x16_bf16 v[112:127], v[204:207], v[72:75], v[112:127]
v_mfma_f32_32x32x16_bf16 v[128:143], v[204:207], v[76:79], v[128:143]
s_waitcnt lgkmcnt(3)
v_mfma_f32_32x32x16_bf16 v[112:127], v[208:211], v[80:83], v[112:127]
v_mfma_f32_32x32x16_bf16 v[128:143], v[208:211], v[84:87], v[128:143]
s_waitcnt lgkmcnt(2)
v_mfma_f32_32x32x16_bf16 v[112:127], v[212:215], v[88:91], v[112:127]
v_mfma_f32_32x32x16_bf16 v[128:143], v[212:215], v[92:95], v[128:143]
s_waitcnt lgkmcnt(1)
v_mfma_f32_32x32x16_bf16 v[112:127], v[216:219], v[96:99], v[112:127]
v_mfma_f32_32x32x16_bf16 v[128:143], v[216:219], v[100:103], v[128:143]
s_waitcnt lgkmcnt(0)
v_mfma_f32_32x32x16_bf16 v[112:127], v[220:223], v[104:107], v[112:127]
v_mfma_f32_32x32x16_bf16 v[128:143], v[220:223], v[108:111], v[128:143]
s_add_u32 m0, s32, 0
s_add_u32 s55, s33, 0
buffer_load_dwordx4 v18, s[4:7], s55 offen offset:0 nt lds
buffer_load_dwordx4 v19, s[4:7], s55 offen offset:1024 nt lds
buffer_load_dwordx4 v20, s[4:7], s55 offen offset:2048 nt lds
buffer_load_dwordx4 v21, s[4:7], s55 offen offset:3072 nt lds
s_add_u32 m0, s32, 4096
s_add_u32 s55, s33, 4096
buffer_load_dwordx4 v18, s[4:7], s55 offen offset:0 nt lds
buffer_load_dwordx4 v19, s[4:7], s55 offen offset:1024 nt lds
buffer_load_dwordx4 v20, s[4:7], s55 offen offset:2048 nt lds
buffer_load_dwordx4 v21, s[4:7], s55 offen offset:3072 nt lds
s_add_u32 s33, s33, 8192
s_nop 7
s_nop 7
v_max3_f32 v33, v112, v113, v114
v_max3_f32 v34, v128, v129, v130
v_max3_f32 v33, v33, v115, v116
v_max3_f32 v34, v34, v131, v132
v_max3_f32 v33, v33, v117, v118
v_max3_f32 v34, v34, v133, v134
v_max3_f32 v33, v33, v119, v120
v_max3_f32 v34, v34, v135, v136
v_max3_f32 v33, v33, v121, v122
v_max3_f32 v34, v34, v137, v138
v_max3_f32 v33, v33, v123, v124
v_max3_f32 v34, v34, v139, v140
v_max3_f32 v33, v33, v125, v126
v_max3_f32 v34, v34, v141, v142
v_max_f32 v33, v33, v127
v_max_f32 v34, v34, v143
s_nop 1
v_permlane32_swap_b32 v33, v34
s_nop 1
v_max_f32 v35, v33, v34
v_cmp_gt_f32 vcc, v35, v30
s_nop 4
s_cbranch_vccnz L_rare_l7
L_back_l7:
v_fma_f32 v112, v112, s62, -v31
v_fma_f32 v128, v128, s62, -v32
v_fma_f32 v113, v113, s62, -v31
v_fma_f32 v129, v129, s62, -v32
v_fma_f32 v114, v114, s62, -v31
v_fma_f32 v130, v130, s62, -v32
v_fma_f32 v115, v115, s62, -v31
v_fma_f32 v131, v131, s62, -v32
v_fma_f32 v116, v116, s62, -v31
v_fma_f32 v132, v132, s62, -v32
v_fma_f32 v117, v117, s62, -v31
v_fma_f32 v133, v133, s62, -v32
v_fma_f32 v118, v118, s62, -v31
v_fma_f32 v134, v134, s62, -v32
v_fma_f32 v119, v119, s62, -v31
v_fma_f32 v135, v135, s62, -v32
v_fma_f32 v120, v120, s62, -v31
v_fma_f32 v136, v136, s62, -v32
v_fma_f32 v121, v121, s62, -v31
v_fma_f32 v137, v137, s62, -v32
v_fma_f32 v122, v122, s62, -v31
v_fma_f32 v138, v138, s62, -v32
v_fma_f32 v123, v123, s62, -v31
v_fma_f32 v139, v139, s62, -v32
v_fma_f32 v124, v124, s62, -v31
v_fma_f32 v140, v140, s62, -v32
v_fma_f32 v125, v125, s62, -v31
v_fma_f32 v141, v141, s62, -v32
v_fma_f32 v126, v126, s62, -v31
v_fma_f32 v142, v142, s62, -v32
v_fma_f32 v127, v127, s62, -v31
v_fma_f32 v143, v143, s62, -v32
v_exp_f32 v112, v112
v_exp_f32 v128, v128
v_exp_f32 v113, v113
v_exp_f32 v129, v129
v_exp_f32 v114, v114
v_exp_f32 v130, v130
v_exp_f32 v115, v115
v_exp_f32 v131, v131
v_exp_f32 v116, v116
v_exp_f32 v132, v132
v_exp_f32 v117, v117
v_exp_f32 v133, v133
v_exp_f32 v118, v118
v_exp_f32 v134, v134
v_exp_f32 v119, v119
v_exp_f32 v135, v135
v_exp_f32 v120, v120
v_exp_f32 v136, v136
v_exp_f32 v121, v121
v_exp_f32 v137, v137
v_exp_f32 v122, v122
v_exp_f32 v138, v138
v_exp_f32 v123, v123
v_exp_f32 v139, v139
v_exp_f32 v124, v124
v_exp_f32 v140, v140
v_exp_f32 v125, v125
v_exp_f32 v141, v141
v_exp_f32 v126, v126
v_exp_f32 v142, v142
v_exp_f32 v127, v127
v_exp_f32 v143, v143
s_nop 0
v_add_f32 v40, v40, v112
v_add_f32 v44, v44, v128
v_add_f32 v41, v41, v113
v_add_f32 v45, v45, v129
v_add_f32 v42, v42, v114
v_add_f32 v46, v46, v130
v_add_f32 v43, v43, v115
v_add_f32 v47, v47, v131
v_add_f32 v40, v40, v116
v_add_f32 v44, v44, v132
v_add_f32 v41, v41, v117
v_add_f32 v45, v45, v133
v_add_f32 v42, v42, v118
v_add_f32 v46, v46, v134
v_add_f32 v43, v43, v119
v_add_f32 v47, v47, v135
v_add_f32 v40, v40, v120
v_add_f32 v44, v44, v136
v_add_f32 v41, v41, v121
v_add_f32 v45, v45, v137
v_add_f32 v42, v42, v122
v_add_f32 v46, v46, v138
v_add_f32 v43, v43, v123
v_add_f32 v47, v47, v139
v_add_f32 v40, v40, v124
v_add_f32 v44, v44, v140
v_add_f32 v41, v41, v125
v_add_f32 v45, v45, v141
v_add_f32 v42, v42, v126
v_add_f32 v46, v46, v142
v_add_f32 v43, v43, v127
v_add_f32 v47, v47, v143
v_cvt_pk_bf16_f32 v144, v112, v113
v_cvt_pk_bf16_f32 v145, v114, v115
v_cvt_pk_bf16_f32 v146, v116, v117
v_cvt_pk_bf16_f32 v147, v118, v119
v_cvt_pk_bf16_f32 v148, v120, v121
v_cvt_pk_bf16_f32 v149, v122, v123
v_cvt_pk_bf16_f32 v150, v124, v125
v_cvt_pk_bf16_f32 v151, v126, v127
v_cvt_pk_bf16_f32 v152, v128, v129
v_cvt_pk_bf16_f32 v153, v130, v131
v_cvt_pk_bf16_f32 v154, v132, v133
v_cvt_pk_bf16_f32 v155, v134, v135
v_cvt_pk_bf16_f32 v156, v136, v137
v_cvt_pk_bf16_f32 v157, v138, v139
v_cvt_pk_bf16_f32 v158, v140, v141
v_cvt_pk_bf16_f32 v159, v142, v143
s_waitcnt vmcnt(16)
ds_read_b64_tr_b16 v[160:161], v10 offset:8192
ds_read_b64_tr_b16 v[162:163], v10 offset:10240
ds_read_b64_tr_b16 v[164:165], v11 offset:8192
ds_read_b64_tr_b16 v[166:167], v11 offset:10240
ds_read_b64_tr_b16 v[168:169], v12 offset:8192
ds_read_b64_tr_b16 v[170:171], v12 offset:10240
ds_read_b64_tr_b16 v[172:173], v13 offset:8192
ds_read_b64_tr_b16 v[174:175], v13 offset:10240
ds_read_b64_tr_b16 v[176:177], v10 offset:12288
ds_read_b64_tr_b16 v[178:179], v10 offset:14336
ds_read_b64_tr_b16 v[180:181], v11 offset:12288
ds_read_b64_tr_b16 v[182:183], v11 offset:14336
s_waitcnt lgkmcnt(10)
v_mfma_f32_32x32x16_bf16 a[0:15], v[160:163], v[144:147], a[0:15]
v_mfma_f32_32x32x16_bf16 a[16:31], v[160:163], v[152:155], a[16:31]
ds_read_b64_tr_b16 v[184:185], v12 offset:12288
ds_read_b64_tr_b16 v[186:187], v12 offset:14336
s_waitcnt lgkmcnt(10)
v_mfma_f32_32x32x16_bf16 a[32:47], v[164:167], v[144:147], a[32:47]
v_mfma_f32_32x32x16_bf16 a[48:63], v[164:167], v[152:155], a[48:63]
ds_read_b64_tr_b16 v[188:189], v13 offset:12288
ds_read_b64_tr_b16 v[190:191], v13 offset:14336
s_waitcnt lgkmcnt(10)
v_mfma_f32_32x32x16_bf16 a[64:79], v[168:171], v[144:147], a[64:79]
v_mfma_f32_32x32x16_bf16 a[80:95], v[168:171], v[152:155], a[80:95]
s_waitcnt lgkmcnt(8)
v_mfma_f32_32x32x16_bf16 a[96:111], v[172:175], v[144:147], a[96:111]
v_mfma_f32_32x32x16_bf16 a[112:127], v[172:175], v[152:155], a[112:127]
s_waitcnt lgkmcnt(6)
v_mfma_f32_32x32x16_bf16 a[0:15], v[176:179], v[148:151], a[0:15]
v_mfma_f32_32x32x16_bf16 a[16:31], v[176:179], v[156:159], a[16:31]
s_waitcnt lgkmcnt(4)
v_mfma_f32_32x32x16_bf16 a[32:47], v[180:183], v[148:151], a[32:47]
v_mfma_f32_32x32x16_bf16 a[48:63], v[180:183], v[156:159], a[48:63]
s_waitcnt lgkmcnt(2)
v_mfma_f32_32x32x16_bf16 a[64:79], v[184:187], v[148:151], a[64:79]
v_mfma_f32_32x32x16_bf16 a[80:95], v[184:187], v[156:159], a[80:95]
s_waitcnt lgkmcnt(0)
v_mfma_f32_32x32x16_bf16 a[96:111], v[188:191], v[148:151], a[96:111]
v_mfma_f32_32x32x16_bf16 a[112:127], v[188:191], v[156:159], a[112:127]
s_add_u32 m0, s32, 8192
s_add_u32 s55, s34, 0
buffer_load_dwordx4 v22, s[8:11], s55 offen offset:0 nt lds
buffer_load_dwordx4 v22, s[8:11], s55 offen offset:1024 nt lds
buffer_load_dwordx4 v22, s[8:11], s55 offen offset:2048 nt lds
buffer_load_dwordx4 v22, s[8:11], s55 offen offset:3072 nt lds
s_add_u32 m0, s32, 12288
s_add_u32 s55, s34, 4096
buffer_load_dwordx4 v22, s[8:11], s55 offen offset:0 nt lds
buffer_load_dwordx4 v22, s[8:11], s55 offen offset:1024 nt lds
buffer_load_dwordx4 v22, s[8:11], s55 offen offset:2048 nt lds
buffer_load_dwordx4 v22, s[8:11], s55 offen offset:3072 nt lds
s_add_u32 s34, s34, 8192
s_add_u32 s61, s58, s69
s_and_b32 s61, s61, 15
s_lshl_b32 s61, s61, 6
s_xor_b32 s60, s61, 32
v_xor_b32 v33, s61, v38
v_xor_b32 v34, s61, v39
v_xor_b32 v35, s60, v38
v_xor_b32 v36, s60, v39
ds_read_b128 v[224:227], v33
ds_read_b128 v[228:231], v34
ds_read_b128 v[232:235], v35
ds_read_b128 v[236:239], v36
s_add_u32 s58, s58, 1
s_waitcnt vmcnt(16)
s_waitcnt lgkmcnt(0)
ds_read_b64_tr_b16 v[160:161], v14 offset:16384
ds_read_b64_tr_b16 v[162:163], v14 offset:17408
ds_read_b64_tr_b16 v[164:165], v15 offset:16384
ds_read_b64_tr_b16 v[166:167], v15 offset:17408
ds_read_b64_tr_b16 v[168:169], v16 offset:16384
ds_read_b64_tr_b16 v[170:171], v16 offset:17408
ds_read_b64_tr_b16 v[172:173], v17 offset:16384
ds_read_b64_tr_b16 v[174:175], v17 offset:17408
ds_read_b64_tr_b16 v[176:177], v14 offset:20480
ds_read_b64_tr_b16 v[178:179], v14 offset:21504
ds_read_b64_tr_b16 v[180:181], v15 offset:20480
ds_read_b64_tr_b16 v[182:183], v15 offset:21504
s_waitcnt lgkmcnt(10)
v_mfma_f32_32x32x16_bf16 a[128:143], v[160:163], v[224:227], a[128:143]
v_mfma_f32_32x32x16_bf16 a[144:159], v[160:163], v[228:231], a[144:159]
ds_read_b64_tr_b16 v[184:185], v16 offset:20480
ds_read_b64_tr_b16 v[186:187], v16 offset:21504
s_waitcnt lgkmcnt(10)
v_mfma_f32_32x32x16_bf16 a[160:175], v[164:167], v[224:227], a[160:175]
v_mfma_f32_32x32x16_bf16 a[176:191], v[164:167], v[228:231], a[176:191]
ds_read_b64_tr_b16 v[188:189], v17 offset:20480
ds_read_b64_tr_b16 v[190:191], v17 offset:21504
s_waitcnt lgkmcnt(10)
v_mfma_f32_32x32x16_bf16 a[192:207], v[168:171], v[224:227], a[192:207]
v_mfma_f32_32x32x16_bf16 a[208:223], v[168:171], v[228:231], a[208:223]
s_waitcnt lgkmcnt(8)
v_mfma_f32_32x32x16_bf16 a[224:239], v[172:175], v[224:227], a[224:239]
v_mfma_f32_32x32x16_bf16 a[240:255], v[172:175], v[228:231], a[240:255]
s_waitcnt lgkmcnt(6)
v_mfma_f32_32x32x16_bf16 a[128:143], v[176:179], v[232:235], a[128:143]
v_mfma_f32_32x32x16_bf16 a[144:159], v[176:179], v[236:239], a[144:159]
s_waitcnt lgkmcnt(4)
v_mfma_f32_32x32x16_bf16 a[160:175], v[180:183], v[232:235], a[160:175]
v_mfma_f32_32x32x16_bf16 a[176:191], v[180:183], v[236:239], a[176:191]
s_waitcnt lgkmcnt(2)
v_mfma_f32_32x32x16_bf16 a[192:207], v[184:187], v[232:235], a[192:207]
v_mfma_f32_32x32x16_bf16 a[208:223], v[184:187], v[236:239], a[208:223]
s_waitcnt lgkmcnt(0)
v_mfma_f32_32x32x16_bf16 a[224:239], v[188:191], v[232:235], a[224:239]
v_mfma_f32_32x32x16_bf16 a[240:255], v[188:191], v[236:239], a[240:255]
s_add_u32 s56, s54, s69
s_and_b32 s56, s56, 15
s_lshl_b32 s56, s56, 18
s_add_u32 s56, s56, s35
s_add_u32 s54, s54, 1
s_add_u32 m0, s32, 16384
s_add_u32 s55, s56, 0
buffer_load_dwordx4 v23, s[12:15], s55 offen offset:0 lds
s_add_u32 s55, s56, 31744
buffer_load_dwordx4 v23, s[12:15], s55 offen offset:1024 lds
s_add_u32 s55, s56, 63488
buffer_load_dwordx4 v23, s[12:15], s55 offen offset:2048 lds
s_add_u32 s55, s56, 95232
buffer_load_dwordx4 v23, s[12:15], s55 offen offset:3072 lds
s_add_u32 m0, s32, 20480
s_add_u32 s55, s56, 131072
buffer_load_dwordx4 v23, s[12:15], s55 offen offset:0 lds
s_add_u32 s55, s56, 162816
buffer_load_dwordx4 v23, s[12:15], s55 offen offset:1024 lds
s_add_u32 s55, s56, 194560
buffer_load_dwordx4 v23, s[12:15], s55 offen offset:2048 lds
s_add_u32 s55, s56, 226304
buffer_load_dwordx4 v23, s[12:15], s55 offen offset:3072 lds
s_sub_u32 s63, s63, 1
s_cmp_lg_u32 s63, 0
s_cbranch_scc1 L_loop7
s_waitcnt vmcnt(16)
ds_read_b128 v[192:195], v2 offset:0
ds_read_b128 v[196:199], v3 offset:0
ds_read_b128 v[200:203], v4 offset:0
ds_read_b128 v[204:207], v5 offset:0
ds_read_b128 v[208:211], v6 offset:0
ds_read_b128 v[212:215], v7 offset:0
ds_read_b128 v[216:219], v8 offset:0
ds_read_b128 v[220:223], v9 offset:0
s_waitcnt lgkmcnt(7)
v_mfma_f32_32x32x16_bf16 v[112:127], v[192:195], v[48:51], 0
v_mfma_f32_32x32x16_bf16 v[128:143], v[192:195], v[52:55], 0
s_waitcnt lgkmcnt(6)
v_mfma_f32_32x32x16_bf16 v[112:127], v[196:199], v[56:59], v[112:127]
v_mfma_f32_32x32x16_bf16 v[128:143], v[196:199], v[60:63], v[128:143]
s_waitcnt lgkmcnt(5)
v_mfma_f32_32x32x16_bf16 v[112:127], v[200:203], v[64:67], v[112:127]
v_mfma_f32_32x32x16_bf16 v[128:143], v[200:203], v[68:71], v[128:143]
s_waitcnt lgkmcnt(4)
v_mfma_f32_32x32x16_bf16 v[112:127], v[204:207], v[72:75], v[112:127]
v_mfma_f32_32x32x16_bf16 v[128:143], v[204:207], v[76:79], v[128:143]
s_waitcnt lgkmcnt(3)
v_mfma_f32_32x32x16_bf16 v[112:127], v[208:211], v[80:83], v[112:127]
v_mfma_f32_32x32x16_bf16 v[128:143], v[208:211], v[84:87], v[128:143]
s_waitcnt lgkmcnt(2)
v_mfma_f32_32x32x16_bf16 v[112:127], v[212:215], v[88:91], v[112:127]
v_mfma_f32_32x32x16_bf16 v[128:143], v[212:215], v[92:95], v[128:143]
s_waitcnt lgkmcnt(1)
v_mfma_f32_32x32x16_bf16 v[112:127], v[216:219], v[96:99], v[112:127]
v_mfma_f32_32x32x16_bf16 v[128:143], v[216:219], v[100:103], v[128:143]
s_waitcnt lgkmcnt(0)
v_mfma_f32_32x32x16_bf16 v[112:127], v[220:223], v[104:107], v[112:127]
v_mfma_f32_32x32x16_bf16 v[128:143], v[220:223], v[108:111], v[128:143]
s_add_u32 m0, s32, 0
s_add_u32 s55, s33, 0
buffer_load_dwordx4 v18, s[4:7], s55 offen offset:0 nt lds
buffer_load_dwordx4 v19, s[4:7], s55 offen offset:1024 nt lds
buffer_load_dwordx4 v20, s[4:7], s55 offen offset:2048 nt lds
buffer_load_dwordx4 v21, s[4:7], s55 offen offset:3072 nt lds
s_add_u32 m0, s32, 4096
s_add_u32 s55, s33, 4096
buffer_load_dwordx4 v18, s[4:7], s55 offen offset:0 nt lds
buffer_load_dwordx4 v19, s[4:7], s55 offen offset:1024 nt lds
buffer_load_dwordx4 v20, s[4:7], s55 offen offset:2048 nt lds
buffer_load_dwordx4 v21, s[4:7], s55 offen offset:3072 nt lds
s_add_u32 s33, s33, 8192
s_nop 7
s_nop 7
v_max3_f32 v33, v112, v113, v114
v_max3_f32 v34, v128, v129, v130
v_max3_f32 v33, v33, v115, v116
v_max3_f32 v34, v34, v131, v132
v_max3_f32 v33, v33, v117, v118
v_max3_f32 v34, v34, v133, v134
v_max3_f32 v33, v33, v119, v120
v_max3_f32 v34, v34, v135, v136
v_max3_f32 v33, v33, v121, v122
v_max3_f32 v34, v34, v137, v138
v_max3_f32 v33, v33, v123, v124
v_max3_f32 v34, v34, v139, v140
v_max3_f32 v33, v33, v125, v126
v_max3_f32 v34, v34, v141, v142
v_max_f32 v33, v33, v127
v_max_f32 v34, v34, v143
s_nop 1
v_permlane32_swap_b32 v33, v34
s_nop 1
v_max_f32 v35, v33, v34
v_cmp_gt_f32 vcc, v35, v30
s_nop 4
s_cbranch_vccnz L_rare_l8
L_back_l8:
v_fma_f32 v112, v112, s62, -v31
v_fma_f32 v128, v128, s62, -v32
v_fma_f32 v113, v113, s62, -v31
v_fma_f32 v129, v129, s62, -v32
v_fma_f32 v114, v114, s62, -v31
v_fma_f32 v130, v130, s62, -v32
v_fma_f32 v115, v115, s62, -v31
v_fma_f32 v131, v131, s62, -v32
v_fma_f32 v116, v116, s62, -v31
v_fma_f32 v132, v132, s62, -v32
v_fma_f32 v117, v117, s62, -v31
v_fma_f32 v133, v133, s62, -v32
v_fma_f32 v118, v118, s62, -v31
v_fma_f32 v134, v134, s62, -v32
v_fma_f32 v119, v119, s62, -v31
v_fma_f32 v135, v135, s62, -v32
v_fma_f32 v120, v120, s62, -v31
v_fma_f32 v136, v136, s62, -v32
v_fma_f32 v121, v121, s62, -v31
v_fma_f32 v137, v137, s62, -v32
v_fma_f32 v122, v122, s62, -v31
v_fma_f32 v138, v138, s62, -v32
v_fma_f32 v123, v123, s62, -v31
v_fma_f32 v139, v139, s62, -v32
v_fma_f32 v124, v124, s62, -v31
v_fma_f32 v140, v140, s62, -v32
v_fma_f32 v125, v125, s62, -v31
v_fma_f32 v141, v141, s62, -v32
v_fma_f32 v126, v126, s62, -v31
v_fma_f32 v142, v142, s62, -v32
v_fma_f32 v127, v127, s62, -v31
v_fma_f32 v143, v143, s62, -v32
v_exp_f32 v112, v112
v_exp_f32 v128, v128
v_exp_f32 v113, v113
v_exp_f32 v129, v129
v_exp_f32 v114, v114
v_exp_f32 v130, v130
v_exp_f32 v115, v115
v_exp_f32 v131, v131
v_exp_f32 v116, v116
v_exp_f32 v132, v132
v_exp_f32 v117, v117
v_exp_f32 v133, v133
v_exp_f32 v118, v118
v_exp_f32 v134, v134
v_exp_f32 v119, v119
v_exp_f32 v135, v135
v_exp_f32 v120, v120
v_exp_f32 v136, v136
v_exp_f32 v121, v121
v_exp_f32 v137, v137
v_exp_f32 v122, v122
v_exp_f32 v138, v138
v_exp_f32 v123, v123
v_exp_f32 v139, v139
v_exp_f32 v124, v124
v_exp_f32 v140, v140
v_exp_f32 v125, v125
v_exp_f32 v141, v141
v_exp_f32 v126, v126
v_exp_f32 v142, v142
v_exp_f32 v127, v127
v_exp_f32 v143, v143
s_nop 0
v_add_f32 v40, v40, v112
v_add_f32 v44, v44, v128
v_add_f32 v41, v41, v113
v_add_f32 v45, v45, v129
v_add_f32 v42, v42, v114
v_add_f32 v46, v46, v130
v_add_f32 v43, v43, v115
v_add_f32 v47, v47, v131
v_add_f32 v40, v40, v116
v_add_f32 v44, v44, v132
v_add_f32 v41, v41, v117
v_add_f32 v45, v45, v133
v_add_f32 v42, v42, v118
v_add_f32 v46, v46, v134
v_add_f32 v43, v43, v119
v_add_f32 v47, v47, v135
v_add_f32 v40, v40, v120
v_add_f32 v44, v44, v136
v_add_f32 v41, v41, v121
v_add_f32 v45, v45, v137
v_add_f32 v42, v42, v122
v_add_f32 v46, v46, v138
v_add_f32 v43, v43, v123
v_add_f32 v47, v47, v139
v_add_f32 v40, v40, v124
v_add_f32 v44, v44, v140
v_add_f32 v41, v41, v125
v_add_f32 v45, v45, v141
v_add_f32 v42, v42, v126
v_add_f32 v46, v46, v142
v_add_f32 v43, v43, v127
v_add_f32 v47, v47, v143
v_cvt_pk_bf16_f32 v144, v112, v113
v_cvt_pk_bf16_f32 v145, v114, v115
v_cvt_pk_bf16_f32 v146, v116, v117
v_cvt_pk_bf16_f32 v147, v118, v119
v_cvt_pk_bf16_f32 v148, v120, v121
v_cvt_pk_bf16_f32 v149, v122, v123
v_cvt_pk_bf16_f32 v150, v124, v125
v_cvt_pk_bf16_f32 v151, v126, v127
v_cvt_pk_bf16_f32 v152, v128, v129
v_cvt_pk_bf16_f32 v153, v130, v131
v_cvt_pk_bf16_f32 v154, v132, v133
v_cvt_pk_bf16_f32 v155, v134, v135
v_cvt_pk_bf16_f32 v156, v136, v137
v_cvt_pk_bf16_f32 v157, v138, v139
v_cvt_pk_bf16_f32 v158, v140, v141
v_cvt_pk_bf16_f32 v159, v142, v143
s_waitcnt vmcnt(16)
ds_read_b64_tr_b16 v[160:161], v10 offset:8192
ds_read_b64_tr_b16 v[162:163], v10 offset:10240
ds_read_b64_tr_b16 v[164:165], v11 offset:8192
ds_read_b64_tr_b16 v[166:167], v11 offset:10240
ds_read_b64_tr_b16 v[168:169], v12 offset:8192
ds_read_b64_tr_b16 v[170:171], v12 offset:10240
ds_read_b64_tr_b16 v[172:173], v13 offset:8192
ds_read_b64_tr_b16 v[174:175], v13 offset:10240
ds_read_b64_tr_b16 v[176:177], v10 offset:12288
ds_read_b64_tr_b16 v[178:179], v10 offset:14336
ds_read_b64_tr_b16 v[180:181], v11 offset:12288
ds_read_b64_tr_b16 v[182:183], v11 offset:14336
s_waitcnt lgkmcnt(10)
v_mfma_f32_32x32x16_bf16 a[0:15], v[160:163], v[144:147], a[0:15]
v_mfma_f32_32x32x16_bf16 a[16:31], v[160:163], v[152:155], a[16:31]
ds_read_b64_tr_b16 v[184:185], v12 offset:12288
ds_read_b64_tr_b16 v[186:187], v12 offset:14336
s_waitcnt lgkmcnt(10)
v_mfma_f32_32x32x16_bf16 a[32:47], v[164:167], v[144:147], a[32:47]
v_mfma_f32_32x32x16_bf16 a[48:63], v[164:167], v[152:155], a[48:63]
ds_read_b64_tr_b16 v[188:189], v13 offset:12288
ds_read_b64_tr_b16 v[190:191], v13 offset:14336
s_waitcnt lgkmcnt(10)
v_mfma_f32_32x32x16_bf16 a[64:79], v[168:171], v[144:147], a[64:79]
v_mfma_f32_32x32x16_bf16 a[80:95], v[168:171], v[152:155], a[80:95]
s_waitcnt lgkmcnt(8)
v_mfma_f32_32x32x16_bf16 a[96:111], v[172:175], v[144:147], a[96:111]
v_mfma_f32_32x32x16_bf16 a[112:127], v[172:175], v[152:155], a[112:127]
s_waitcnt lgkmcnt(6)
v_mfma_f32_32x32x16_bf16 a[0:15], v[176:179], v[148:151], a[0:15]
v_mfma_f32_32x32x16_bf16 a[16:31], v[176:179], v[156:159], a[16:31]
s_waitcnt lgkmcnt(4)
v_mfma_f32_32x32x16_bf16 a[32:47], v[180:183], v[148:151], a[32:47]
v_mfma_f32_32x32x16_bf16 a[48:63], v[180:183], v[156:159], a[48:63]
s_waitcnt lgkmcnt(2)
v_mfma_f32_32x32x16_bf16 a[64:79], v[184:187], v[148:151], a[64:79]
v_mfma_f32_32x32x16_bf16 a[80:95], v[184:187], v[156:159], a[80:95]
s_waitcnt lgkmcnt(0)
v_mfma_f32_32x32x16_bf16 a[96:111], v[188:191], v[148:151], a[96:111]
v_mfma_f32_32x32x16_bf16 a[112:127], v[188:191], v[156:159], a[112:127]
s_add_u32 m0, s32, 8192
s_add_u32 s55, s34, 0
buffer_load_dwordx4 v22, s[8:11], s55 offen offset:0 nt lds
buffer_load_dwordx4 v22, s[8:11], s55 offen offset:1024 nt lds
buffer_load_dwordx4 v22, s[8:11], s55 offen offset:2048 nt lds
buffer_load_dwordx4 v22, s[8:11], s55 offen offset:3072 nt lds
s_add_u32 m0, s32, 12288
s_add_u32 s55, s34, 4096
buffer_load_dwordx4 v22, s[8:11], s55 offen offset:0 nt lds
buffer_load_dwordx4 v22, s[8:11], s55 offen offset:1024 nt lds
buffer_load_dwordx4 v22, s[8:11], s55 offen offset:2048 nt lds
buffer_load_dwordx4 v22, s[8:11], s55 offen offset:3072 nt lds
s_add_u32 s34, s34, 8192
s_add_u32 s61, s58, s69
s_and_b32 s61, s61, 15
s_lshl_b32 s61, s61, 6
s_xor_b32 s60, s61, 32
v_xor_b32 v33, s61, v38
v_xor_b32 v34, s61, v39
v_xor_b32 v35, s60, v38
v_xor_b32 v36, s60, v39
ds_read_b128 v[224:227], v33
ds_read_b128 v[228:231], v34
ds_read_b128 v[232:235], v35
ds_read_b128 v[236:239], v36
s_add_u32 s58, s58, 1
s_waitcnt vmcnt(16)
s_waitcnt lgkmcnt(0)
ds_read_b64_tr_b16 v[160:161], v14 offset:16384
ds_read_b64_tr_b16 v[162:163], v14 offset:17408
ds_read_b64_tr_b16 v[164:165], v15 offset:16384
ds_read_b64_tr_b16 v[166:167], v15 offset:17408
ds_read_b64_tr_b16 v[168:169], v16 offset:16384
ds_read_b64_tr_b16 v[170:171], v16 offset:17408
ds_read_b64_tr_b16 v[172:173], v17 offset:16384
ds_read_b64_tr_b16 v[174:175], v17 offset:17408
ds_read_b64_tr_b16 v[176:177], v14 offset:20480
ds_read_b64_tr_b16 v[178:179], v14 offset:21504
ds_read_b64_tr_b16 v[180:181], v15 offset:20480
ds_read_b64_tr_b16 v[182:183], v15 offset:21504
s_waitcnt lgkmcnt(10)
v_mfma_f32_32x32x16_bf16 a[128:143], v[160:163], v[224:227], a[128:143]
v_mfma_f32_32x32x16_bf16 a[144:159], v[160:163], v[228:231], a[144:159]
ds_read_b64_tr_b16 v[184:185], v16 offset:20480
ds_read_b64_tr_b16 v[186:187], v16 offset:21504
s_waitcnt lgkmcnt(10)
v_mfma_f32_32x32x16_bf16 a[160:175], v[164:167], v[224:227], a[160:175]
v_mfma_f32_32x32x16_bf16 a[176:191], v[164:167], v[228:231], a[176:191]
ds_read_b64_tr_b16 v[188:189], v17 offset:20480
ds_read_b64_tr_b16 v[190:191], v17 offset:21504
s_waitcnt lgkmcnt(10)
v_mfma_f32_32x32x16_bf16 a[192:207], v[168:171], v[224:227], a[192:207]
v_mfma_f32_32x32x16_bf16 a[208:223], v[168:171], v[228:231], a[208:223]
s_waitcnt lgkmcnt(8)
v_mfma_f32_32x32x16_bf16 a[224:239], v[172:175], v[224:227], a[224:239]
v_mfma_f32_32x32x16_bf16 a[240:255], v[172:175], v[228:231], a[240:255]
s_waitcnt lgkmcnt(6)
v_mfma_f32_32x32x16_bf16 a[128:143], v[176:179], v[232:235], a[128:143]
v_mfma_f32_32x32x16_bf16 a[144:159], v[176:179], v[236:239], a[144:159]
s_waitcnt lgkmcnt(4)
v_mfma_f32_32x32x16_bf16 a[160:175], v[180:183], v[232:235], a[160:175]
v_mfma_f32_32x32x16_bf16 a[176:191], v[180:183], v[236:239], a[176:191]
s_waitcnt lgkmcnt(2)
v_mfma_f32_32x32x16_bf16 a[192:207], v[184:187], v[232:235], a[192:207]
v_mfma_f32_32x32x16_bf16 a[208:223], v[184:187], v[236:239], a[208:223]
s_waitcnt lgkmcnt(0)
v_mfma_f32_32x32x16_bf16 a[224:239], v[188:191], v[232:235], a[224:239]
v_mfma_f32_32x32x16_bf16 a[240:255], v[188:191], v[236:239], a[240:255]
s_add_u32 s57, s64, s69
s_and_b32 s57, s57, 15
s_lshr_b32 s56, s57, 2
s_lshl_b32 s56, s56, 18
s_and_b32 s57, s57, 3
s_lshl_b32 s57, s57, 15
s_add_u32 s56, s56, s57
s_add_u32 s56, s56, s66
s_add_u32 s64, s64, 1
s_add_u32 m0, s32, 16384
s_add_u32 s55, s56, 0
buffer_load_dwordx4 v24, s[16:19], s55 offen offset:0 lds
s_add_u32 s55, s56, 3072
buffer_load_dwordx4 v24, s[16:19], s55 offen offset:1024 lds
s_add_u32 s55, s56, 6144
buffer_load_dwordx4 v24, s[16:19], s55 offen offset:2048 lds
s_add_u32 s55, s56, 9216
buffer_load_dwordx4 v24, s[16:19], s55 offen offset:3072 lds
s_add_u32 m0, s32, 20480
s_add_u32 s55, s56, 16384
buffer_load_dwordx4 v24, s[16:19], s55 offen offset:0 lds
s_add_u32 s55, s56, 19456
buffer_load_dwordx4 v24, s[16:19], s55 offen offset:1024 lds
s_add_u32 s55, s56, 22528
buffer_load_dwordx4 v24, s[16:19], s55 offen offset:2048 lds
s_add_u32 s55, s56, 25600
buffer_load_dwordx4 v24, s[16:19], s55 offen offset:3072 lds
s_lshl_b32 s59, s29, 5
s_lshl_b32 s60, s28, 3
s_add_u32 s59, s59, s60
s_lshl_b32 s59, s59, 10
s_lshl_b32 s60, s31, 20
s_add_u32 s59, s59, s60
s_nop 7
s_nop 7
v_accvgpr_read_b32 v240, a128
v_accvgpr_read_b32 v241, a129
v_accvgpr_read_b32 v242, a130
v_accvgpr_read_b32 v243, a131
v_accvgpr_read_b32 v244, a132
v_accvgpr_read_b32 v245, a133
v_accvgpr_read_b32 v246, a134
v_accvgpr_read_b32 v247, a135
v_accvgpr_read_b32 v248, a136
v_accvgpr_read_b32 v249, a137
v_accvgpr_read_b32 v250, a138
v_accvgpr_read_b32 v251, a139
v_accvgpr_read_b32 v252, a140
v_accvgpr_read_b32 v253, a141
v_accvgpr_read_b32 v254, a142
v_accvgpr_read_b32 v255, a143
v_cvt_pk_bf16_f32 v48, v240, v241
v_cvt_pk_bf16_f32 v49, v242, v243
v_cvt_pk_bf16_f32 v50, v244, v245
v_cvt_pk_bf16_f32 v51, v246, v247
v_cvt_pk_bf16_f32 v56, v248, v249
v_cvt_pk_bf16_f32 v57, v250, v251
v_cvt_pk_bf16_f32 v58, v252, v253
v_cvt_pk_bf16_f32 v59, v254, v255
v_accvgpr_read_b32 v240, a144
v_accvgpr_read_b32 v241, a145
v_accvgpr_read_b32 v242, a146
v_accvgpr_read_b32 v243, a147
v_accvgpr_read_b32 v244, a148
v_accvgpr_read_b32 v245, a149
v_accvgpr_read_b32 v246, a150
v_accvgpr_read_b32 v247, a151
v_accvgpr_read_b32 v248, a152
v_accvgpr_read_b32 v249, a153
v_accvgpr_read_b32 v250, a154
v_accvgpr_read_b32 v251, a155
v_accvgpr_read_b32 v252, a156
v_accvgpr_read_b32 v253, a157
v_accvgpr_read_b32 v254, a158
v_accvgpr_read_b32 v255, a159
v_cvt_pk_bf16_f32 v52, v240, v241
v_cvt_pk_bf16_f32 v53, v242, v243
v_cvt_pk_bf16_f32 v54, v244, v245
v_cvt_pk_bf16_f32 v55, v246, v247
v_cvt_pk_bf16_f32 v60, v248, v249
v_cvt_pk_bf16_f32 v61, v250, v251
v_cvt_pk_bf16_f32 v62, v252, v253
v_cvt_pk_bf16_f32 v63, v254, v255
v_accvgpr_read_b32 v240, a160
v_accvgpr_read_b32 v241, a161
v_accvgpr_read_b32 v242, a162
v_accvgpr_read_b32 v243, a163
v_accvgpr_read_b32 v244, a164
v_accvgpr_read_b32 v245, a165
v_accvgpr_read_b32 v246, a166
v_accvgpr_read_b32 v247, a167
v_accvgpr_read_b32 v248, a168
v_accvgpr_read_b32 v249, a169
v_accvgpr_read_b32 v250, a170
v_accvgpr_read_b32 v251, a171
v_accvgpr_read_b32 v252, a172
v_accvgpr_read_b32 v253, a173
v_accvgpr_read_b32 v254, a174
v_accvgpr_read_b32 v255, a175
v_cvt_pk_bf16_f32 v64, v240, v241
v_cvt_pk_bf16_f32 v65, v242, v243
v_cvt_pk_bf16_f32 v66, v244, v245
v_cvt_pk_bf16_f32 v67, v246, v247
v_cvt_pk_bf16_f32 v72, v248, v249
v_cvt_pk_bf16_f32 v73, v250, v251
v_cvt_pk_bf16_f32 v74, v252, v253
v_cvt_pk_bf16_f32 v75, v254, v255
v_accvgpr_read_b32 v240, a176
v_accvgpr_read_b32 v241, a177
v_accvgpr_read_b32 v242, a178
v_accvgpr_read_b32 v243, a179
v_accvgpr_read_b32 v244, a180
v_accvgpr_read_b32 v245, a181
v_accvgpr_read_b32 v246, a182
v_accvgpr_read_b32 v247, a183
v_accvgpr_read_b32 v248, a184
v_accvgpr_read_b32 v249, a185
v_accvgpr_read_b32 v250, a186
v_accvgpr_read_b32 v251, a187
v_accvgpr_read_b32 v252, a188
v_accvgpr_read_b32 v253, a189
v_accvgpr_read_b32 v254, a190
v_accvgpr_read_b32 v255, a191
v_cvt_pk_bf16_f32 v68, v240, v241
v_cvt_pk_bf16_f32 v69, v242, v243
v_cvt_pk_bf16_f32 v70, v244, v245
v_cvt_pk_bf16_f32 v71, v246, v247
v_cvt_pk_bf16_f32 v76, v248, v249
v_cvt_pk_bf16_f32 v77, v250, v251
v_cvt_pk_bf16_f32 v78, v252, v253
v_cvt_pk_bf16_f32 v79, v254, v255
v_accvgpr_read_b32 v240, a192
v_accvgpr_read_b32 v241, a193
v_accvgpr_read_b32 v242, a194
v_accvgpr_read_b32 v243, a195
v_accvgpr_read_b32 v244, a196
v_accvgpr_read_b32 v245, a197
v_accvgpr_read_b32 v246, a198
v_accvgpr_read_b32 v247, a199
v_accvgpr_read_b32 v248, a200
v_accvgpr_read_b32 v249, a201
v_accvgpr_read_b32 v250, a202
v_accvgpr_read_b32 v251, a203
v_accvgpr_read_b32 v252, a204
v_accvgpr_read_b32 v253, a205
v_accvgpr_read_b32 v254, a206
v_accvgpr_read_b32 v255, a207
v_cvt_pk_bf16_f32 v80, v240, v241
v_cvt_pk_bf16_f32 v81, v242, v243
v_cvt_pk_bf16_f32 v82, v244, v245
v_cvt_pk_bf16_f32 v83, v246, v247
v_cvt_pk_bf16_f32 v88, v248, v249
v_cvt_pk_bf16_f32 v89, v250, v251
v_cvt_pk_bf16_f32 v90, v252, v253
v_cvt_pk_bf16_f32 v91, v254, v255
v_accvgpr_read_b32 v240, a208
v_accvgpr_read_b32 v241, a209
v_accvgpr_read_b32 v242, a210
v_accvgpr_read_b32 v243, a211
v_accvgpr_read_b32 v244, a212
v_accvgpr_read_b32 v245, a213
v_accvgpr_read_b32 v246, a214
v_accvgpr_read_b32 v247, a215
v_accvgpr_read_b32 v248, a216
v_accvgpr_read_b32 v249, a217
v_accvgpr_read_b32 v250, a218
v_accvgpr_read_b32 v251, a219
v_accvgpr_read_b32 v252, a220
v_accvgpr_read_b32 v253, a221
v_accvgpr_read_b32 v254, a222
v_accvgpr_read_b32 v255, a223
v_cvt_pk_bf16_f32 v84, v240, v241
v_cvt_pk_bf16_f32 v85, v242, v243
v_cvt_pk_bf16_f32 v86, v244, v245
v_cvt_pk_bf16_f32 v87, v246, v247
v_cvt_pk_bf16_f32 v92, v248, v249
v_cvt_pk_bf16_f32 v93, v250, v251
v_cvt_pk_bf16_f32 v94, v252, v253
v_cvt_pk_bf16_f32 v95, v254, v255
v_accvgpr_read_b32 v240, a224
v_accvgpr_read_b32 v241, a225
v_accvgpr_read_b32 v242, a226
v_accvgpr_read_b32 v243, a227
v_accvgpr_read_b32 v244, a228
v_accvgpr_read_b32 v245, a229
v_accvgpr_read_b32 v246, a230
v_accvgpr_read_b32 v247, a231
v_accvgpr_read_b32 v248, a232
v_accvgpr_read_b32 v249, a233
v_accvgpr_read_b32 v250, a234
v_accvgpr_read_b32 v251, a235
v_accvgpr_read_b32 v252, a236
v_accvgpr_read_b32 v253, a237
v_accvgpr_read_b32 v254, a238
v_accvgpr_read_b32 v255, a239
v_cvt_pk_bf16_f32 v96, v240, v241
v_cvt_pk_bf16_f32 v97, v242, v243
v_cvt_pk_bf16_f32 v98, v244, v245
v_cvt_pk_bf16_f32 v99, v246, v247
v_cvt_pk_bf16_f32 v104, v248, v249
v_cvt_pk_bf16_f32 v105, v250, v251
v_cvt_pk_bf16_f32 v106, v252, v253
v_cvt_pk_bf16_f32 v107, v254, v255
v_accvgpr_read_b32 v240, a240
v_accvgpr_read_b32 v241, a241
v_accvgpr_read_b32 v242, a242
v_accvgpr_read_b32 v243, a243
v_accvgpr_read_b32 v244, a244
v_accvgpr_read_b32 v245, a245
v_accvgpr_read_b32 v246, a246
v_accvgpr_read_b32 v247, a247
v_accvgpr_read_b32 v248, a248
v_accvgpr_read_b32 v249, a249
v_accvgpr_read_b32 v250, a250
v_accvgpr_read_b32 v251, a251
v_accvgpr_read_b32 v252, a252
v_accvgpr_read_b32 v253, a253
v_accvgpr_read_b32 v254, a254
v_accvgpr_read_b32 v255, a255
v_cvt_pk_bf16_f32 v100, v240, v241
v_cvt_pk_bf16_f32 v101, v242, v243
v_cvt_pk_bf16_f32 v102, v244, v245
v_cvt_pk_bf16_f32 v103, v246, v247
v_cvt_pk_bf16_f32 v108, v248, v249
v_cvt_pk_bf16_f32 v109, v250, v251
v_cvt_pk_bf16_f32 v110, v252, v253
v_cvt_pk_bf16_f32 v111, v254, v255
s_add_u32 s59, s31, 0
s_and_b32 s59, s59, 3
s_lshl_b32 s59, s59, 6
v_xor_b32 v14, s59, v10
s_add_u32 s59, s31, 1
s_and_b32 s59, s59, 3
s_lshl_b32 s59, s59, 6
v_xor_b32 v15, s59, v10
s_add_u32 s59, s31, 2
s_and_b32 s59, s59, 3
s_lshl_b32 s59, s59, 6
v_xor_b32 v16, s59, v10
s_add_u32 s59, s31, 3
s_and_b32 s59, s59, 3
s_lshl_b32 s59, s59, 6
v_xor_b32 v17, s59, v10
s_barrier
s_nop 7
s_nop 7
v_add_f32 v40, v40, v41
v_add_f32 v42, v42, v43
v_add_f32 v44, v44, v45
v_add_f32 v46, v46, v47
v_add_f32 v33, v40, v42
v_add_f32 v34, v44, v46
s_nop 1
v_permlane32_swap_b32 v33, v34
s_nop 1
v_add_f32 v33, v33, v34
v_rcp_f32 v33, v33
s_nop 1
v_mov_b32 v34, v33
s_nop 1
v_permlane32_swap_b32 v33, v34
s_nop 1
v_accvgpr_read_b32 v240, a0
v_accvgpr_read_b32 v241, a1
v_accvgpr_read_b32 v242, a2
v_accvgpr_read_b32 v243, a3
v_accvgpr_read_b32 v244, a4
v_accvgpr_read_b32 v245, a5
v_accvgpr_read_b32 v246, a6
v_accvgpr_read_b32 v247, a7
v_accvgpr_read_b32 v248, a8
v_accvgpr_read_b32 v249, a9
v_accvgpr_read_b32 v250, a10
v_accvgpr_read_b32 v251, a11
v_accvgpr_read_b32 v252, a12
v_accvgpr_read_b32 v253, a13
v_accvgpr_read_b32 v254, a14
v_accvgpr_read_b32 v255, a15
v_mul_f32 v240, v240, v33
v_mul_f32 v241, v241, v33
v_mul_f32 v242, v242, v33
v_mul_f32 v243, v243, v33
v_mul_f32 v244, v244, v33
v_mul_f32 v245, v245, v33
v_mul_f32 v246, v246, v33
v_mul_f32 v247, v247, v33
v_mul_f32 v248, v248, v33
v_mul_f32 v249, v249, v33
v_mul_f32 v250, v250, v33
v_mul_f32 v251, v251, v33
v_mul_f32 v252, v252, v33
v_mul_f32 v253, v253, v33
v_mul_f32 v254, v254, v33
v_mul_f32 v255, v255, v33
v_cvt_pk_bf16_f32 v160, v240, v241
v_cvt_pk_bf16_f32 v161, v242, v243
v_cvt_pk_bf16_f32 v162, v244, v245
v_cvt_pk_bf16_f32 v163, v246, v247
v_cvt_pk_bf16_f32 v164, v248, v249
v_cvt_pk_bf16_f32 v165, v250, v251
v_cvt_pk_bf16_f32 v166, v252, v253
v_cvt_pk_bf16_f32 v167, v254, v255
ds_write_b128 v28, v[160:163] offset:0
ds_write_b128 v28, v[164:167] offset:2048
v_accvgpr_read_b32 v240, a16
v_accvgpr_read_b32 v241, a17
v_accvgpr_read_b32 v242, a18
v_accvgpr_read_b32 v243, a19
v_accvgpr_read_b32 v244, a20
v_accvgpr_read_b32 v245, a21
v_accvgpr_read_b32 v246, a22
v_accvgpr_read_b32 v247, a23
v_accvgpr_read_b32 v248, a24
v_accvgpr_read_b32 v249, a25
v_accvgpr_read_b32 v250, a26
v_accvgpr_read_b32 v251, a27
v_accvgpr_read_b32 v252, a28
v_accvgpr_read_b32 v253, a29
v_accvgpr_read_b32 v254, a30
v_accvgpr_read_b32 v255, a31
v_mul_f32 v240, v240, v34
v_mul_f32 v241, v241, v34
v_mul_f32 v242, v242, v34
v_mul_f32 v243, v243, v34
v_mul_f32 v244, v244, v34
v_mul_f32 v245, v245, v34
v_mul_f32 v246, v246, v34
v_mul_f32 v247, v247, v34
v_mul_f32 v248, v248, v34
v_mul_f32 v249, v249, v34
v_mul_f32 v250, v250, v34
v_mul_f32 v251, v251, v34
v_mul_f32 v252, v252, v34
v_mul_f32 v253, v253, v34
v_mul_f32 v254, v254, v34
v_mul_f32 v255, v255, v34
v_cvt_pk_bf16_f32 v168, v240, v241
v_cvt_pk_bf16_f32 v169, v242, v243
v_cvt_pk_bf16_f32 v170, v244, v245
v_cvt_pk_bf16_f32 v171, v246, v247
v_cvt_pk_bf16_f32 v172, v248, v249
v_cvt_pk_bf16_f32 v173, v250, v251
v_cvt_pk_bf16_f32 v174, v252, v253
v_cvt_pk_bf16_f32 v175, v254, v255
ds_write_b128 v28, v[168:171] offset:1024
ds_write_b128 v28, v[172:175] offset:3072
v_accvgpr_read_b32 v240, a32
v_accvgpr_read_b32 v241, a33
v_accvgpr_read_b32 v242, a34
v_accvgpr_read_b32 v243, a35
v_accvgpr_read_b32 v244, a36
v_accvgpr_read_b32 v245, a37
v_accvgpr_read_b32 v246, a38
v_accvgpr_read_b32 v247, a39
v_accvgpr_read_b32 v248, a40
v_accvgpr_read_b32 v249, a41
v_accvgpr_read_b32 v250, a42
v_accvgpr_read_b32 v251, a43
v_accvgpr_read_b32 v252, a44
v_accvgpr_read_b32 v253, a45
v_accvgpr_read_b32 v254, a46
v_accvgpr_read_b32 v255, a47
v_mul_f32 v240, v240, v33
v_mul_f32 v241, v241, v33
v_mul_f32 v242, v242, v33
v_mul_f32 v243, v243, v33
v_mul_f32 v244, v244, v33
v_mul_f32 v245, v245, v33
v_mul_f32 v246, v246, v33
v_mul_f32 v247, v247, v33
v_mul_f32 v248, v248, v33
v_mul_f32 v249, v249, v33
v_mul_f32 v250, v250, v33
v_mul_f32 v251, v251, v33
v_mul_f32 v252, v252, v33
v_mul_f32 v253, v253, v33
v_mul_f32 v254, v254, v33
v_mul_f32 v255, v255, v33
v_cvt_pk_bf16_f32 v176, v240, v241
v_cvt_pk_bf16_f32 v177, v242, v243
v_cvt_pk_bf16_f32 v178, v244, v245
v_cvt_pk_bf16_f32 v179, v246, v247
v_cvt_pk_bf16_f32 v180, v248, v249
v_cvt_pk_bf16_f32 v181, v250, v251
v_cvt_pk_bf16_f32 v182, v252, v253
v_cvt_pk_bf16_f32 v183, v254, v255
ds_write_b128 v28, v[176:179] offset:4096
ds_write_b128 v28, v[180:183] offset:6144
v_accvgpr_read_b32 v240, a48
v_accvgpr_read_b32 v241, a49
v_accvgpr_read_b32 v242, a50
v_accvgpr_read_b32 v243, a51
v_accvgpr_read_b32 v244, a52
v_accvgpr_read_b32 v245, a53
v_accvgpr_read_b32 v246, a54
v_accvgpr_read_b32 v247, a55
v_accvgpr_read_b32 v248, a56
v_accvgpr_read_b32 v249, a57
v_accvgpr_read_b32 v250, a58
v_accvgpr_read_b32 v251, a59
v_accvgpr_read_b32 v252, a60
v_accvgpr_read_b32 v253, a61
v_accvgpr_read_b32 v254, a62
v_accvgpr_read_b32 v255, a63
v_mul_f32 v240, v240, v34
v_mul_f32 v241, v241, v34
v_mul_f32 v242, v242, v34
v_mul_f32 v243, v243, v34
v_mul_f32 v244, v244, v34
v_mul_f32 v245, v245, v34
v_mul_f32 v246, v246, v34
v_mul_f32 v247, v247, v34
v_mul_f32 v248, v248, v34
v_mul_f32 v249, v249, v34
v_mul_f32 v250, v250, v34
v_mul_f32 v251, v251, v34
v_mul_f32 v252, v252, v34
v_mul_f32 v253, v253, v34
v_mul_f32 v254, v254, v34
v_mul_f32 v255, v255, v34
v_cvt_pk_bf16_f32 v184, v240, v241
v_cvt_pk_bf16_f32 v185, v242, v243
v_cvt_pk_bf16_f32 v186, v244, v245
v_cvt_pk_bf16_f32 v187, v246, v247
v_cvt_pk_bf16_f32 v188, v248, v249
v_cvt_pk_bf16_f32 v189, v250, v251
v_cvt_pk_bf16_f32 v190, v252, v253
v_cvt_pk_bf16_f32 v191, v254, v255
ds_write_b128 v28, v[184:187] offset:5120
ds_write_b128 v28, v[188:191] offset:7168
s_waitcnt lgkmcnt(0)
v_accvgpr_read_b32 v240, a64
v_accvgpr_read_b32 v241, a65
v_accvgpr_read_b32 v242, a66
v_accvgpr_read_b32 v243, a67
v_accvgpr_read_b32 v244, a68
v_accvgpr_read_b32 v245, a69
v_accvgpr_read_b32 v246, a70
v_accvgpr_read_b32 v247, a71
v_accvgpr_read_b32 v248, a72
v_accvgpr_read_b32 v249, a73
v_accvgpr_read_b32 v250, a74
v_accvgpr_read_b32 v251, a75
v_accvgpr_read_b32 v252, a76
v_accvgpr_read_b32 v253, a77
v_accvgpr_read_b32 v254, a78
v_accvgpr_read_b32 v255, a79
v_mul_f32 v240, v240, v33
v_mul_f32 v241, v241, v33
v_mul_f32 v242, v242, v33
v_mul_f32 v243, v243, v33
v_mul_f32 v244, v244, v33
v_mul_f32 v245, v245, v33
v_mul_f32 v246, v246, v33
v_mul_f32 v247, v247, v33
v_mul_f32 v248, v248, v33
v_mul_f32 v249, v249, v33
v_mul_f32 v250, v250, v33
v_mul_f32 v251, v251, v33
v_mul_f32 v252, v252, v33
v_mul_f32 v253, v253, v33
v_mul_f32 v254, v254, v33
v_mul_f32 v255, v255, v33
v_cvt_pk_bf16_f32 v160, v240, v241
v_cvt_pk_bf16_f32 v161, v242, v243
v_cvt_pk_bf16_f32 v162, v244, v245
v_cvt_pk_bf16_f32 v163, v246, v247
v_cvt_pk_bf16_f32 v164, v248, v249
v_cvt_pk_bf16_f32 v165, v250, v251
v_cvt_pk_bf16_f32 v166, v252, v253
v_cvt_pk_bf16_f32 v167, v254, v255
ds_write_b128 v28, v[160:163] offset:8192
ds_write_b128 v28, v[164:167] offset:10240
v_accvgpr_read_b32 v240, a80
v_accvgpr_read_b32 v241, a81
v_accvgpr_read_b32 v242, a82
v_accvgpr_read_b32 v243, a83
v_accvgpr_read_b32 v244, a84
v_accvgpr_read_b32 v245, a85
v_accvgpr_read_b32 v246, a86
v_accvgpr_read_b32 v247, a87
v_accvgpr_read_b32 v248, a88
v_accvgpr_read_b32 v249, a89
v_accvgpr_read_b32 v250, a90
v_accvgpr_read_b32 v251, a91
v_accvgpr_read_b32 v252, a92
v_accvgpr_read_b32 v253, a93
v_accvgpr_read_b32 v254, a94
v_accvgpr_read_b32 v255, a95
v_mul_f32 v240, v240, v34
v_mul_f32 v241, v241, v34
v_mul_f32 v242, v242, v34
v_mul_f32 v243, v243, v34
v_mul_f32 v244, v244, v34
v_mul_f32 v245, v245, v34
v_mul_f32 v246, v246, v34
v_mul_f32 v247, v247, v34
v_mul_f32 v248, v248, v34
v_mul_f32 v249, v249, v34
v_mul_f32 v250, v250, v34
v_mul_f32 v251, v251, v34
v_mul_f32 v252, v252, v34
v_mul_f32 v253, v253, v34
v_mul_f32 v254, v254, v34
v_mul_f32 v255, v255, v34
v_cvt_pk_bf16_f32 v168, v240, v241
v_cvt_pk_bf16_f32 v169, v242, v243
v_cvt_pk_bf16_f32 v170, v244, v245
v_cvt_pk_bf16_f32 v171, v246, v247
v_cvt_pk_bf16_f32 v172, v248, v249
v_cvt_pk_bf16_f32 v173, v250, v251
v_cvt_pk_bf16_f32 v174, v252, v253
v_cvt_pk_bf16_f32 v175, v254, v255
ds_write_b128 v28, v[168:171] offset:9216
ds_write_b128 v28, v[172:175] offset:11264
v_accvgpr_read_b32 v240, a96
v_accvgpr_read_b32 v241, a97
v_accvgpr_read_b32 v242, a98
v_accvgpr_read_b32 v243, a99
v_accvgpr_read_b32 v244, a100
v_accvgpr_read_b32 v245, a101
v_accvgpr_read_b32 v246, a102
v_accvgpr_read_b32 v247, a103
v_accvgpr_read_b32 v248, a104
v_accvgpr_read_b32 v249, a105
v_accvgpr_read_b32 v250, a106
v_accvgpr_read_b32 v251, a107
v_accvgpr_read_b32 v252, a108
v_accvgpr_read_b32 v253, a109
v_accvgpr_read_b32 v254, a110
v_accvgpr_read_b32 v255, a111
v_mul_f32 v240, v240, v33
v_mul_f32 v241, v241, v33
v_mul_f32 v242, v242, v33
v_mul_f32 v243, v243, v33
v_mul_f32 v244, v244, v33
v_mul_f32 v245, v245, v33
v_mul_f32 v246, v246, v33
v_mul_f32 v247, v247, v33
v_mul_f32 v248, v248, v33
v_mul_f32 v249, v249, v33
v_mul_f32 v250, v250, v33
v_mul_f32 v251, v251, v33
v_mul_f32 v252, v252, v33
v_mul_f32 v253, v253, v33
v_mul_f32 v254, v254, v33
v_mul_f32 v255, v255, v33
v_cvt_pk_bf16_f32 v176, v240, v241
v_cvt_pk_bf16_f32 v177, v242, v243
v_cvt_pk_bf16_f32 v178, v244, v245
v_cvt_pk_bf16_f32 v179, v246, v247
v_cvt_pk_bf16_f32 v180, v248, v249
v_cvt_pk_bf16_f32 v181, v250, v251
v_cvt_pk_bf16_f32 v182, v252, v253
v_cvt_pk_bf16_f32 v183, v254, v255
ds_write_b128 v28, v[176:179] offset:12288
ds_write_b128 v28, v[180:183] offset:14336
v_accvgpr_read_b32 v240, a112
v_accvgpr_read_b32 v241, a113
v_accvgpr_read_b32 v242, a114
v_accvgpr_read_b32 v243, a115
v_accvgpr_read_b32 v244, a116
v_accvgpr_read_b32 v245, a117
v_accvgpr_read_b32 v246, a118
v_accvgpr_read_b32 v247, a119
v_accvgpr_read_b32 v248, a120
v_accvgpr_read_b32 v249, a121
v_accvgpr_read_b32 v250, a122
v_accvgpr_read_b32 v251, a123
v_accvgpr_read_b32 v252, a124
v_accvgpr_read_b32 v253, a125
v_accvgpr_read_b32 v254, a126
v_accvgpr_read_b32 v255, a127
v_mul_f32 v240, v240, v34
v_mul_f32 v241, v241, v34
v_mul_f32 v242, v242, v34
v_mul_f32 v243, v243, v34
v_mul_f32 v244, v244, v34
v_mul_f32 v245, v245, v34
v_mul_f32 v246, v246, v34
v_mul_f32 v247, v247, v34
v_mul_f32 v248, v248, v34
v_mul_f32 v249, v249, v34
v_mul_f32 v250, v250, v34
v_mul_f32 v251, v251, v34
v_mul_f32 v252, v252, v34
v_mul_f32 v253, v253, v34
v_mul_f32 v254, v254, v34
v_mul_f32 v255, v255, v34
v_cvt_pk_bf16_f32 v184, v240, v241
v_cvt_pk_bf16_f32 v185, v242, v243
v_cvt_pk_bf16_f32 v186, v244, v245
v_cvt_pk_bf16_f32 v187, v246, v247
v_cvt_pk_bf16_f32 v188, v248, v249
v_cvt_pk_bf16_f32 v189, v250, v251
v_cvt_pk_bf16_f32 v190, v252, v253
v_cvt_pk_bf16_f32 v191, v254, v255
ds_write_b128 v28, v[184:187] offset:13312
ds_write_b128 v28, v[188:191] offset:15360
s_waitcnt lgkmcnt(0)
s_barrier
s_waitcnt vmcnt(16)
ds_read_b128 v[192:195], v2 offset:0
ds_read_b128 v[196:199], v3 offset:0
ds_read_b128 v[200:203], v4 offset:0
ds_read_b128 v[204:207], v5 offset:0
ds_read_b128 v[208:211], v6 offset:0
ds_read_b128 v[212:215], v7 offset:0
ds_read_b128 v[216:219], v8 offset:0
ds_read_b128 v[220:223], v9 offset:0
s_waitcnt lgkmcnt(7)
v_mfma_f32_32x32x16_bf16 v[112:127], v[192:195], v[48:51], 0
v_mfma_f32_32x32x16_bf16 v[128:143], v[192:195], v[52:55], 0
s_waitcnt lgkmcnt(6)
v_mfma_f32_32x32x16_bf16 v[112:127], v[196:199], v[56:59], v[112:127]
v_mfma_f32_32x32x16_bf16 v[128:143], v[196:199], v[60:63], v[128:143]
s_waitcnt lgkmcnt(5)
v_mfma_f32_32x32x16_bf16 v[112:127], v[200:203], v[64:67], v[112:127]
v_mfma_f32_32x32x16_bf16 v[128:143], v[200:203], v[68:71], v[128:143]
s_waitcnt lgkmcnt(4)
v_mfma_f32_32x32x16_bf16 v[112:127], v[204:207], v[72:75], v[112:127]
v_mfma_f32_32x32x16_bf16 v[128:143], v[204:207], v[76:79], v[128:143]
s_waitcnt lgkmcnt(3)
v_mfma_f32_32x32x16_bf16 v[112:127], v[208:211], v[80:83], v[112:127]
v_mfma_f32_32x32x16_bf16 v[128:143], v[208:211], v[84:87], v[128:143]
s_waitcnt lgkmcnt(2)
v_mfma_f32_32x32x16_bf16 v[112:127], v[212:215], v[88:91], v[112:127]
v_mfma_f32_32x32x16_bf16 v[128:143], v[212:215], v[92:95], v[128:143]
s_waitcnt lgkmcnt(1)
v_mfma_f32_32x32x16_bf16 v[112:127], v[216:219], v[96:99], v[112:127]
v_mfma_f32_32x32x16_bf16 v[128:143], v[216:219], v[100:103], v[128:143]
s_waitcnt lgkmcnt(0)
v_mfma_f32_32x32x16_bf16 v[112:127], v[220:223], v[104:107], v[112:127]
v_mfma_f32_32x32x16_bf16 v[128:143], v[220:223], v[108:111], v[128:143]
s_add_u32 m0, s32, 0
s_add_u32 s55, s33, 0
buffer_load_dwordx4 v18, s[4:7], s55 offen offset:0 nt lds
buffer_load_dwordx4 v19, s[4:7], s55 offen offset:1024 nt lds
buffer_load_dwordx4 v20, s[4:7], s55 offen offset:2048 nt lds
buffer_load_dwordx4 v21, s[4:7], s55 offen offset:3072 nt lds
s_add_u32 m0, s32, 4096
s_add_u32 s55, s33, 4096
buffer_load_dwordx4 v18, s[4:7], s55 offen offset:0 nt lds
buffer_load_dwordx4 v19, s[4:7], s55 offen offset:1024 nt lds
buffer_load_dwordx4 v20, s[4:7], s55 offen offset:2048 nt lds
buffer_load_dwordx4 v21, s[4:7], s55 offen offset:3072 nt lds
s_add_u32 s33, s33, 8192
s_nop 7
s_nop 7
v_max3_f32 v33, v112, v113, v114
v_max3_f32 v34, v128, v129, v130
v_max3_f32 v33, v33, v115, v116
v_max3_f32 v34, v34, v131, v132
v_max3_f32 v33, v33, v117, v118
v_max3_f32 v34, v34, v133, v134
v_max3_f32 v33, v33, v119, v120
v_max3_f32 v34, v34, v135, v136
v_max3_f32 v33, v33, v121, v122
v_max3_f32 v34, v34, v137, v138
v_max3_f32 v33, v33, v123, v124
v_max3_f32 v34, v34, v139, v140
v_max3_f32 v33, v33, v125, v126
v_max3_f32 v34, v34, v141, v142
v_max_f32 v33, v33, v127
v_max_f32 v34, v34, v143
s_nop 1
v_permlane32_swap_b32 v33, v34
s_nop 1
v_max_f32 v35, v33, v34
v_mov_b32 v29, v35
v_add_f32 v30, s67, v35
v_mul_f32 v31, s62, v35
v_mul_f32 v32, s62, v35
v_mov_b32 v40, 0
v_mov_b32 v41, 0
v_mov_b32 v42, 0
v_mov_b32 v43, 0
v_mov_b32 v44, 0
v_mov_b32 v45, 0
v_mov_b32 v46, 0
v_mov_b32 v47, 0
v_permlane32_swap_b32 v31, v32
s_nop 1
v_fma_f32 v112, v112, s62, -v31
v_fma_f32 v128, v128, s62, -v32
v_fma_f32 v113, v113, s62, -v31
v_fma_f32 v129, v129, s62, -v32
v_fma_f32 v114, v114, s62, -v31
v_fma_f32 v130, v130, s62, -v32
v_fma_f32 v115, v115, s62, -v31
v_fma_f32 v131, v131, s62, -v32
v_fma_f32 v116, v116, s62, -v31
v_fma_f32 v132, v132, s62, -v32
v_fma_f32 v117, v117, s62, -v31
v_fma_f32 v133, v133, s62, -v32
v_fma_f32 v118, v118, s62, -v31
v_fma_f32 v134, v134, s62, -v32
v_fma_f32 v119, v119, s62, -v31
v_fma_f32 v135, v135, s62, -v32
v_fma_f32 v120, v120, s62, -v31
v_fma_f32 v136, v136, s62, -v32
v_fma_f32 v121, v121, s62, -v31
v_fma_f32 v137, v137, s62, -v32
v_fma_f32 v122, v122, s62, -v31
v_fma_f32 v138, v138, s62, -v32
v_fma_f32 v123, v123, s62, -v31
v_fma_f32 v139, v139, s62, -v32
v_fma_f32 v124, v124, s62, -v31
v_fma_f32 v140, v140, s62, -v32
v_fma_f32 v125, v125, s62, -v31
v_fma_f32 v141, v141, s62, -v32
v_fma_f32 v126, v126, s62, -v31
v_fma_f32 v142, v142, s62, -v32
v_fma_f32 v127, v127, s62, -v31
v_fma_f32 v143, v143, s62, -v32
v_exp_f32 v112, v112
v_exp_f32 v128, v128
v_exp_f32 v113, v113
v_exp_f32 v129, v129
v_exp_f32 v114, v114
v_exp_f32 v130, v130
v_exp_f32 v115, v115
v_exp_f32 v131, v131
v_exp_f32 v116, v116
v_exp_f32 v132, v132
v_exp_f32 v117, v117
v_exp_f32 v133, v133
v_exp_f32 v118, v118
v_exp_f32 v134, v134
v_exp_f32 v119, v119
v_exp_f32 v135, v135
v_exp_f32 v120, v120
v_exp_f32 v136, v136
v_exp_f32 v121, v121
v_exp_f32 v137, v137
v_exp_f32 v122, v122
v_exp_f32 v138, v138
v_exp_f32 v123, v123
v_exp_f32 v139, v139
v_exp_f32 v124, v124
v_exp_f32 v140, v140
v_exp_f32 v125, v125
v_exp_f32 v141, v141
v_exp_f32 v126, v126
v_exp_f32 v142, v142
v_exp_f32 v127, v127
v_exp_f32 v143, v143
s_nop 0
v_add_f32 v40, v40, v112
v_add_f32 v44, v44, v128
v_add_f32 v41, v41, v113
v_add_f32 v45, v45, v129
v_add_f32 v42, v42, v114
v_add_f32 v46, v46, v130
v_add_f32 v43, v43, v115
v_add_f32 v47, v47, v131
v_add_f32 v40, v40, v116
v_add_f32 v44, v44, v132
v_add_f32 v41, v41, v117
v_add_f32 v45, v45, v133
v_add_f32 v42, v42, v118
v_add_f32 v46, v46, v134
v_add_f32 v43, v43, v119
v_add_f32 v47, v47, v135
v_add_f32 v40, v40, v120
v_add_f32 v44, v44, v136
v_add_f32 v41, v41, v121
v_add_f32 v45, v45, v137
v_add_f32 v42, v42, v122
v_add_f32 v46, v46, v138
v_add_f32 v43, v43, v123
v_add_f32 v47, v47, v139
v_add_f32 v40, v40, v124
v_add_f32 v44, v44, v140
v_add_f32 v41, v41, v125
v_add_f32 v45, v45, v141
v_add_f32 v42, v42, v126
v_add_f32 v46, v46, v142
v_add_f32 v43, v43, v127
v_add_f32 v47, v47, v143
v_cvt_pk_bf16_f32 v144, v112, v113
v_cvt_pk_bf16_f32 v145, v114, v115
v_cvt_pk_bf16_f32 v146, v116, v117
v_cvt_pk_bf16_f32 v147, v118, v119
v_cvt_pk_bf16_f32 v148, v120, v121
v_cvt_pk_bf16_f32 v149, v122, v123
v_cvt_pk_bf16_f32 v150, v124, v125
v_cvt_pk_bf16_f32 v151, v126, v127
v_cvt_pk_bf16_f32 v152, v128, v129
v_cvt_pk_bf16_f32 v153, v130, v131
v_cvt_pk_bf16_f32 v154, v132, v133
v_cvt_pk_bf16_f32 v155, v134, v135
v_cvt_pk_bf16_f32 v156, v136, v137
v_cvt_pk_bf16_f32 v157, v138, v139
v_cvt_pk_bf16_f32 v158, v140, v141
v_cvt_pk_bf16_f32 v159, v142, v143
s_waitcnt vmcnt(16)
ds_read_b64_tr_b16 v[160:161], v10 offset:8192
ds_read_b64_tr_b16 v[162:163], v10 offset:10240
ds_read_b64_tr_b16 v[164:165], v11 offset:8192
ds_read_b64_tr_b16 v[166:167], v11 offset:10240
ds_read_b64_tr_b16 v[168:169], v12 offset:8192
ds_read_b64_tr_b16 v[170:171], v12 offset:10240
ds_read_b64_tr_b16 v[172:173], v13 offset:8192
ds_read_b64_tr_b16 v[174:175], v13 offset:10240
ds_read_b64_tr_b16 v[176:177], v10 offset:12288
ds_read_b64_tr_b16 v[178:179], v10 offset:14336
ds_read_b64_tr_b16 v[180:181], v11 offset:12288
ds_read_b64_tr_b16 v[182:183], v11 offset:14336
s_waitcnt lgkmcnt(10)
v_mfma_f32_32x32x16_bf16 a[0:15], v[160:163], v[144:147], 0
v_mfma_f32_32x32x16_bf16 a[16:31], v[160:163], v[152:155], 0
ds_read_b64_tr_b16 v[184:185], v12 offset:12288
ds_read_b64_tr_b16 v[186:187], v12 offset:14336
s_waitcnt lgkmcnt(10)
v_mfma_f32_32x32x16_bf16 a[32:47], v[164:167], v[144:147], 0
v_mfma_f32_32x32x16_bf16 a[48:63], v[164:167], v[152:155], 0
ds_read_b64_tr_b16 v[188:189], v13 offset:12288
ds_read_b64_tr_b16 v[190:191], v13 offset:14336
s_waitcnt lgkmcnt(10)
v_mfma_f32_32x32x16_bf16 a[64:79], v[168:171], v[144:147], 0
v_mfma_f32_32x32x16_bf16 a[80:95], v[168:171], v[152:155], 0
s_waitcnt lgkmcnt(8)
v_mfma_f32_32x32x16_bf16 a[96:111], v[172:175], v[144:147], 0
v_mfma_f32_32x32x16_bf16 a[112:127], v[172:175], v[152:155], 0
s_waitcnt lgkmcnt(6)
v_mfma_f32_32x32x16_bf16 a[0:15], v[176:179], v[148:151], a[0:15]
v_mfma_f32_32x32x16_bf16 a[16:31], v[176:179], v[156:159], a[16:31]
s_waitcnt lgkmcnt(4)
v_mfma_f32_32x32x16_bf16 a[32:47], v[180:183], v[148:151], a[32:47]
v_mfma_f32_32x32x16_bf16 a[48:63], v[180:183], v[156:159], a[48:63]
s_waitcnt lgkmcnt(2)
v_mfma_f32_32x32x16_bf16 a[64:79], v[184:187], v[148:151], a[64:79]
v_mfma_f32_32x32x16_bf16 a[80:95], v[184:187], v[156:159], a[80:95]
s_waitcnt lgkmcnt(0)
v_mfma_f32_32x32x16_bf16 a[96:111], v[188:191], v[148:151], a[96:111]
v_mfma_f32_32x32x16_bf16 a[112:127], v[188:191], v[156:159], a[112:127]
s_add_u32 m0, s32, 8192
s_add_u32 s55, s34, 0
buffer_load_dwordx4 v22, s[8:11], s55 offen offset:0 nt lds
buffer_load_dwordx4 v22, s[8:11], s55 offen offset:1024 nt lds
buffer_load_dwordx4 v22, s[8:11], s55 offen offset:2048 nt lds
buffer_load_dwordx4 v22, s[8:11], s55 offen offset:3072 nt lds
s_add_u32 m0, s32, 12288
s_add_u32 s55, s34, 4096
buffer_load_dwordx4 v22, s[8:11], s55 offen offset:0 nt lds
buffer_load_dwordx4 v22, s[8:11], s55 offen offset:1024 nt lds
buffer_load_dwordx4 v22, s[8:11], s55 offen offset:2048 nt lds
buffer_load_dwordx4 v22, s[8:11], s55 offen offset:3072 nt lds
s_add_u32 s34, s34, 8192
s_add_u32 s61, s65, s69
s_and_b32 s61, s61, 15
s_lshr_b32 s60, s61, 2
s_mul_i32 s60, s60, 40960
s_and_b32 s61, s61, 3
s_lshl_b32 s61, s61, 12
s_add_u32 s60, s60, s61
v_add_u32 v27, s60, v26
s_add_u32 s65, s65, 1
ds_read_b128 v[224:227], v27 offset:24576
ds_read_b128 v[228:231], v27 offset:25600
ds_read_b128 v[232:235], v27 offset:26624
ds_read_b128 v[236:239], v27 offset:27648
s_waitcnt vmcnt(16)
s_waitcnt lgkmcnt(0)
ds_read_b64_tr_b16 v[160:161], v14 offset:16384
ds_read_b64_tr_b16 v[162:163], v14 offset:18432
ds_read_b64_tr_b16 v[164:165], v15 offset:16384
ds_read_b64_tr_b16 v[166:167], v15 offset:18432
ds_read_b64_tr_b16 v[168:169], v16 offset:16384
ds_read_b64_tr_b16 v[170:171], v16 offset:18432
ds_read_b64_tr_b16 v[172:173], v17 offset:16384
ds_read_b64_tr_b16 v[174:175], v17 offset:18432
ds_read_b64_tr_b16 v[176:177], v14 offset:20480
ds_read_b64_tr_b16 v[178:179], v14 offset:22528
ds_read_b64_tr_b16 v[180:181], v15 offset:20480
ds_read_b64_tr_b16 v[182:183], v15 offset:22528
s_waitcnt lgkmcnt(10)
v_mfma_f32_32x32x16_bf16 a[128:143], v[160:163], v[224:227], 0
v_mfma_f32_32x32x16_bf16 a[144:159], v[160:163], v[228:231], 0
ds_read_b64_tr_b16 v[184:185], v16 offset:20480
ds_read_b64_tr_b16 v[186:187], v16 offset:22528
s_waitcnt lgkmcnt(10)
v_mfma_f32_32x32x16_bf16 a[160:175], v[164:167], v[224:227], 0
v_mfma_f32_32x32x16_bf16 a[176:191], v[164:167], v[228:231], 0
ds_read_b64_tr_b16 v[188:189], v17 offset:20480
ds_read_b64_tr_b16 v[190:191], v17 offset:22528
s_waitcnt lgkmcnt(10)
v_mfma_f32_32x32x16_bf16 a[192:207], v[168:171], v[224:227], 0
v_mfma_f32_32x32x16_bf16 a[208:223], v[168:171], v[228:231], 0
s_waitcnt lgkmcnt(8)
v_mfma_f32_32x32x16_bf16 a[224:239], v[172:175], v[224:227], 0
v_mfma_f32_32x32x16_bf16 a[240:255], v[172:175], v[228:231], 0
s_waitcnt lgkmcnt(6)
v_mfma_f32_32x32x16_bf16 a[128:143], v[176:179], v[232:235], a[128:143]
v_mfma_f32_32x32x16_bf16 a[144:159], v[176:179], v[236:239], a[144:159]
s_waitcnt lgkmcnt(4)
v_mfma_f32_32x32x16_bf16 a[160:175], v[180:183], v[232:235], a[160:175]
v_mfma_f32_32x32x16_bf16 a[176:191], v[180:183], v[236:239], a[176:191]
s_waitcnt lgkmcnt(2)
v_mfma_f32_32x32x16_bf16 a[192:207], v[184:187], v[232:235], a[192:207]
v_mfma_f32_32x32x16_bf16 a[208:223], v[184:187], v[236:239], a[208:223]
s_waitcnt lgkmcnt(0)
v_mfma_f32_32x32x16_bf16 a[224:239], v[188:191], v[232:235], a[224:239]
v_mfma_f32_32x32x16_bf16 a[240:255], v[188:191], v[236:239], a[240:255]
s_add_u32 s57, s64, s69
s_and_b32 s57, s57, 15
s_lshr_b32 s56, s57, 2
s_lshl_b32 s56, s56, 18
s_and_b32 s57, s57, 3
s_lshl_b32 s57, s57, 15
s_add_u32 s56, s56, s57
s_add_u32 s56, s56, s66
s_add_u32 s64, s64, 1
s_add_u32 m0, s32, 16384
s_add_u32 s55, s56, 0
buffer_load_dwordx4 v24, s[16:19], s55 offen offset:0 lds
s_add_u32 s55, s56, 3072
buffer_load_dwordx4 v24, s[16:19], s55 offen offset:1024 lds
s_add_u32 s55, s56, 6144
buffer_load_dwordx4 v24, s[16:19], s55 offen offset:2048 lds
s_add_u32 s55, s56, 9216
buffer_load_dwordx4 v24, s[16:19], s55 offen offset:3072 lds
s_add_u32 m0, s32, 20480
s_add_u32 s55, s56, 16384
buffer_load_dwordx4 v24, s[16:19], s55 offen offset:0 lds
s_add_u32 s55, s56, 19456
buffer_load_dwordx4 v24, s[16:19], s55 offen offset:1024 lds
s_add_u32 s55, s56, 22528
buffer_load_dwordx4 v24, s[16:19], s55 offen offset:2048 lds
s_add_u32 s55, s56, 25600
buffer_load_dwordx4 v24, s[16:19], s55 offen offset:3072 lds
s_mov_b32 s63, 14
.p2align 3
L_loop11:
s_waitcnt vmcnt(16)
ds_read_b128 v[192:195], v2 offset:0
ds_read_b128 v[196:199], v3 offset:0
ds_read_b128 v[200:203], v4 offset:0
ds_read_b128 v[204:207], v5 offset:0
ds_read_b128 v[208:211], v6 offset:0
ds_read_b128 v[212:215], v7 offset:0
ds_read_b128 v[216:219], v8 offset:0
ds_read_b128 v[220:223], v9 offset:0
s_waitcnt lgkmcnt(7)
v_mfma_f32_32x32x16_bf16 v[112:127], v[192:195], v[48:51], 0
v_mfma_f32_32x32x16_bf16 v[128:143], v[192:195], v[52:55], 0
s_waitcnt lgkmcnt(6)
v_mfma_f32_32x32x16_bf16 v[112:127], v[196:199], v[56:59], v[112:127]
v_mfma_f32_32x32x16_bf16 v[128:143], v[196:199], v[60:63], v[128:143]
s_waitcnt lgkmcnt(5)
v_mfma_f32_32x32x16_bf16 v[112:127], v[200:203], v[64:67], v[112:127]
v_mfma_f32_32x32x16_bf16 v[128:143], v[200:203], v[68:71], v[128:143]
s_waitcnt lgkmcnt(4)
v_mfma_f32_32x32x16_bf16 v[112:127], v[204:207], v[72:75], v[112:127]
v_mfma_f32_32x32x16_bf16 v[128:143], v[204:207], v[76:79], v[128:143]
s_waitcnt lgkmcnt(3)
v_mfma_f32_32x32x16_bf16 v[112:127], v[208:211], v[80:83], v[112:127]
v_mfma_f32_32x32x16_bf16 v[128:143], v[208:211], v[84:87], v[128:143]
s_waitcnt lgkmcnt(2)
v_mfma_f32_32x32x16_bf16 v[112:127], v[212:215], v[88:91], v[112:127]
v_mfma_f32_32x32x16_bf16 v[128:143], v[212:215], v[92:95], v[128:143]
s_waitcnt lgkmcnt(1)
v_mfma_f32_32x32x16_bf16 v[112:127], v[216:219], v[96:99], v[112:127]
v_mfma_f32_32x32x16_bf16 v[128:143], v[216:219], v[100:103], v[128:143]
s_waitcnt lgkmcnt(0)
v_mfma_f32_32x32x16_bf16 v[112:127], v[220:223], v[104:107], v[112:127]
v_mfma_f32_32x32x16_bf16 v[128:143], v[220:223], v[108:111], v[128:143]
s_add_u32 m0, s32, 0
s_add_u32 s55, s33, 0
buffer_load_dwordx4 v18, s[4:7], s55 offen offset:0 nt lds
buffer_load_dwordx4 v19, s[4:7], s55 offen offset:1024 nt lds
buffer_load_dwordx4 v20, s[4:7], s55 offen offset:2048 nt lds
buffer_load_dwordx4 v21, s[4:7], s55 offen offset:3072 nt lds
s_add_u32 m0, s32, 4096
s_add_u32 s55, s33, 4096
buffer_load_dwordx4 v18, s[4:7], s55 offen offset:0 nt lds
buffer_load_dwordx4 v19, s[4:7], s55 offen offset:1024 nt lds
buffer_load_dwordx4 v20, s[4:7], s55 offen offset:2048 nt lds
buffer_load_dwordx4 v21, s[4:7], s55 offen offset:3072 nt lds
s_add_u32 s33, s33, 8192
s_nop 7
s_nop 7
v_max3_f32 v33, v112, v113, v114
v_max3_f32 v34, v128, v129, v130
v_max3_f32 v33, v33, v115, v116
v_max3_f32 v34, v34, v131, v132
v_max3_f32 v33, v33, v117, v118
v_max3_f32 v34, v34, v133, v134
v_max3_f32 v33, v33, v119, v120
v_max3_f32 v34, v34, v135, v136
v_max3_f32 v33, v33, v121, v122
v_max3_f32 v34, v34, v137, v138
v_max3_f32 v33, v33, v123, v124
v_max3_f32 v34, v34, v139, v140
v_max3_f32 v33, v33, v125, v126
v_max3_f32 v34, v34, v141, v142
v_max_f32 v33, v33, v127
v_max_f32 v34, v34, v143
s_nop 1
v_permlane32_swap_b32 v33, v34
s_nop 1
v_max_f32 v35, v33, v34
v_cmp_gt_f32 vcc, v35, v30
s_nop 4
s_cbranch_vccnz L_rare_l11
L_back_l11:
v_fma_f32 v112, v112, s62, -v31
v_fma_f32 v128, v128, s62, -v32
v_fma_f32 v113, v113, s62, -v31
v_fma_f32 v129, v129, s62, -v32
v_fma_f32 v114, v114, s62, -v31
v_fma_f32 v130, v130, s62, -v32
v_fma_f32 v115, v115, s62, -v31
v_fma_f32 v131, v131, s62, -v32
v_fma_f32 v116, v116, s62, -v31
v_fma_f32 v132, v132, s62, -v32
v_fma_f32 v117, v117, s62, -v31
v_fma_f32 v133, v133, s62, -v32
v_fma_f32 v118, v118, s62, -v31
v_fma_f32 v134, v134, s62, -v32
v_fma_f32 v119, v119, s62, -v31
v_fma_f32 v135, v135, s62, -v32
v_fma_f32 v120, v120, s62, -v31
v_fma_f32 v136, v136, s62, -v32
v_fma_f32 v121, v121, s62, -v31
v_fma_f32 v137, v137, s62, -v32
v_fma_f32 v122, v122, s62, -v31
v_fma_f32 v138, v138, s62, -v32
v_fma_f32 v123, v123, s62, -v31
v_fma_f32 v139, v139, s62, -v32
v_fma_f32 v124, v124, s62, -v31
v_fma_f32 v140, v140, s62, -v32
v_fma_f32 v125, v125, s62, -v31
v_fma_f32 v141, v141, s62, -v32
v_fma_f32 v126, v126, s62, -v31
v_fma_f32 v142, v142, s62, -v32
v_fma_f32 v127, v127, s62, -v31
v_fma_f32 v143, v143, s62, -v32
v_exp_f32 v112, v112
v_exp_f32 v128, v128
v_exp_f32 v113, v113
v_exp_f32 v129, v129
v_exp_f32 v114, v114
v_exp_f32 v130, v130
v_exp_f32 v115, v115
v_exp_f32 v131, v131
v_exp_f32 v116, v116
v_exp_f32 v132, v132
v_exp_f32 v117, v117
v_exp_f32 v133, v133
v_exp_f32 v118, v118
v_exp_f32 v134, v134
v_exp_f32 v119, v119
v_exp_f32 v135, v135
v_exp_f32 v120, v120
v_exp_f32 v136, v136
v_exp_f32 v121, v121
v_exp_f32 v137, v137
v_exp_f32 v122, v122
v_exp_f32 v138, v138
v_exp_f32 v123, v123
v_exp_f32 v139, v139
v_exp_f32 v124, v124
v_exp_f32 v140, v140
v_exp_f32 v125, v125
v_exp_f32 v141, v141
v_exp_f32 v126, v126
v_exp_f32 v142, v142
v_exp_f32 v127, v127
v_exp_f32 v143, v143
s_nop 0
v_add_f32 v40, v40, v112
v_add_f32 v44, v44, v128
v_add_f32 v41, v41, v113
v_add_f32 v45, v45, v129
v_add_f32 v42, v42, v114
v_add_f32 v46, v46, v130
v_add_f32 v43, v43, v115
v_add_f32 v47, v47, v131
v_add_f32 v40, v40, v116
v_add_f32 v44, v44, v132
v_add_f32 v41, v41, v117
v_add_f32 v45, v45, v133
v_add_f32 v42, v42, v118
v_add_f32 v46, v46, v134
v_add_f32 v43, v43, v119
v_add_f32 v47, v47, v135
v_add_f32 v40, v40, v120
v_add_f32 v44, v44, v136
v_add_f32 v41, v41, v121
v_add_f32 v45, v45, v137
v_add_f32 v42, v42, v122
v_add_f32 v46, v46, v138
v_add_f32 v43, v43, v123
v_add_f32 v47, v47, v139
v_add_f32 v40, v40, v124
v_add_f32 v44, v44, v140
v_add_f32 v41, v41, v125
v_add_f32 v45, v45, v141
v_add_f32 v42, v42, v126
v_add_f32 v46, v46, v142
v_add_f32 v43, v43, v127
v_add_f32 v47, v47, v143
v_cvt_pk_bf16_f32 v144, v112, v113
v_cvt_pk_bf16_f32 v145, v114, v115
v_cvt_pk_bf16_f32 v146, v116, v117
v_cvt_pk_bf16_f32 v147, v118, v119
v_cvt_pk_bf16_f32 v148, v120, v121
v_cvt_pk_bf16_f32 v149, v122, v123
v_cvt_pk_bf16_f32 v150, v124, v125
v_cvt_pk_bf16_f32 v151, v126, v127
v_cvt_pk_bf16_f32 v152, v128, v129
v_cvt_pk_bf16_f32 v153, v130, v131
v_cvt_pk_bf16_f32 v154, v132, v133
v_cvt_pk_bf16_f32 v155, v134, v135
v_cvt_pk_bf16_f32 v156, v136, v137
v_cvt_pk_bf16_f32 v157, v138, v139
v_cvt_pk_bf16_f32 v158, v140, v141
v_cvt_pk_bf16_f32 v159, v142, v143
s_waitcnt vmcnt(16)
ds_read_b64_tr_b16 v[160:161], v10 offset:8192
ds_read_b64_tr_b16 v[162:163], v10 offset:10240
ds_read_b64_tr_b16 v[164:165], v11 offset:8192
ds_read_b64_tr_b16 v[166:167], v11 offset:10240
ds_read_b64_tr_b16 v[168:169], v12 offset:8192
ds_read_b64_tr_b16 v[170:171], v12 offset:10240
ds_read_b64_tr_b16 v[172:173], v13 offset:8192
ds_read_b64_tr_b16 v[174:175], v13 offset:10240
ds_read_b64_tr_b16 v[176:177], v10 offset:12288
ds_read_b64_tr_b16 v[178:179], v10 offset:14336
ds_read_b64_tr_b16 v[180:181], v11 offset:12288
ds_read_b64_tr_b16 v[182:183], v11 offset:14336
s_waitcnt lgkmcnt(10)
v_mfma_f32_32x32x16_bf16 a[0:15], v[160:163], v[144:147], a[0:15]
v_mfma_f32_32x32x16_bf16 a[16:31], v[160:163], v[152:155], a[16:31]
ds_read_b64_tr_b16 v[184:185], v12 offset:12288
ds_read_b64_tr_b16 v[186:187], v12 offset:14336
s_waitcnt lgkmcnt(10)
v_mfma_f32_32x32x16_bf16 a[32:47], v[164:167], v[144:147], a[32:47]
v_mfma_f32_32x32x16_bf16 a[48:63], v[164:167], v[152:155], a[48:63]
ds_read_b64_tr_b16 v[188:189], v13 offset:12288
ds_read_b64_tr_b16 v[190:191], v13 offset:14336
s_waitcnt lgkmcnt(10)
v_mfma_f32_32x32x16_bf16 a[64:79], v[168:171], v[144:147], a[64:79]
v_mfma_f32_32x32x16_bf16 a[80:95], v[168:171], v[152:155], a[80:95]
s_waitcnt lgkmcnt(8)
v_mfma_f32_32x32x16_bf16 a[96:111], v[172:175], v[144:147], a[96:111]
v_mfma_f32_32x32x16_bf16 a[112:127], v[172:175], v[152:155], a[112:127]
s_waitcnt lgkmcnt(6)
v_mfma_f32_32x32x16_bf16 a[0:15], v[176:179], v[148:151], a[0:15]
v_mfma_f32_32x32x16_bf16 a[16:31], v[176:179], v[156:159], a[16:31]
s_waitcnt lgkmcnt(4)
v_mfma_f32_32x32x16_bf16 a[32:47], v[180:183], v[148:151], a[32:47]
v_mfma_f32_32x32x16_bf16 a[48:63], v[180:183], v[156:159], a[48:63]
s_waitcnt lgkmcnt(2)
v_mfma_f32_32x32x16_bf16 a[64:79], v[184:187], v[148:151], a[64:79]
v_mfma_f32_32x32x16_bf16 a[80:95], v[184:187], v[156:159], a[80:95]
s_waitcnt lgkmcnt(0)
v_mfma_f32_32x32x16_bf16 a[96:111], v[188:191], v[148:151], a[96:111]
v_mfma_f32_32x32x16_bf16 a[112:127], v[188:191], v[156:159], a[112:127]
s_add_u32 m0, s32, 8192
s_add_u32 s55, s34, 0
buffer_load_dwordx4 v22, s[8:11], s55 offen offset:0 nt lds
buffer_load_dwordx4 v22, s[8:11], s55 offen offset:1024 nt lds
buffer_load_dwordx4 v22, s[8:11], s55 offen offset:2048 nt lds
buffer_load_dwordx4 v22, s[8:11], s55 offen offset:3072 nt lds
s_add_u32 m0, s32, 12288
s_add_u32 s55, s34, 4096
buffer_load_dwordx4 v22, s[8:11], s55 offen offset:0 nt lds
buffer_load_dwordx4 v22, s[8:11], s55 offen offset:1024 nt lds
buffer_load_dwordx4 v22, s[8:11], s55 offen offset:2048 nt lds
buffer_load_dwordx4 v22, s[8:11], s55 offen offset:3072 nt lds
s_add_u32 s34, s34, 8192
s_add_u32 s61, s65, s69
s_and_b32 s61, s61, 15
s_lshr_b32 s60, s61, 2
s_mul_i32 s60, s60, 40960
s_and_b32 s61, s61, 3
s_lshl_b32 s61, s61, 12
s_add_u32 s60, s60, s61
v_add_u32 v27, s60, v26
s_add_u32 s65, s65, 1
ds_read_b128 v[224:227], v27 offset:24576
ds_read_b128 v[228:231], v27 offset:25600
ds_read_b128 v[232:235], v27 offset:26624
ds_read_b128 v[236:239], v27 offset:27648
s_waitcnt vmcnt(16)
s_waitcnt lgkmcnt(0)
ds_read_b64_tr_b16 v[160:161], v14 offset:16384
ds_read_b64_tr_b16 v[162:163], v14 offset:18432
ds_read_b64_tr_b16 v[164:165], v15 offset:16384
ds_read_b64_tr_b16 v[166:167], v15 offset:18432
ds_read_b64_tr_b16 v[168:169], v16 offset:16384
ds_read_b64_tr_b16 v[170:171], v16 offset:18432
ds_read_b64_tr_b16 v[172:173], v17 offset:16384
ds_read_b64_tr_b16 v[174:175], v17 offset:18432
ds_read_b64_tr_b16 v[176:177], v14 offset:20480
ds_read_b64_tr_b16 v[178:179], v14 offset:22528
ds_read_b64_tr_b16 v[180:181], v15 offset:20480
ds_read_b64_tr_b16 v[182:183], v15 offset:22528
s_waitcnt lgkmcnt(10)
v_mfma_f32_32x32x16_bf16 a[128:143], v[160:163], v[224:227], a[128:143]
v_mfma_f32_32x32x16_bf16 a[144:159], v[160:163], v[228:231], a[144:159]
ds_read_b64_tr_b16 v[184:185], v16 offset:20480
ds_read_b64_tr_b16 v[186:187], v16 offset:22528
s_waitcnt lgkmcnt(10)
v_mfma_f32_32x32x16_bf16 a[160:175], v[164:167], v[224:227], a[160:175]
v_mfma_f32_32x32x16_bf16 a[176:191], v[164:167], v[228:231], a[176:191]
ds_read_b64_tr_b16 v[188:189], v17 offset:20480
ds_read_b64_tr_b16 v[190:191], v17 offset:22528
s_waitcnt lgkmcnt(10)
v_mfma_f32_32x32x16_bf16 a[192:207], v[168:171], v[224:227], a[192:207]
v_mfma_f32_32x32x16_bf16 a[208:223], v[168:171], v[228:231], a[208:223]
s_waitcnt lgkmcnt(8)
v_mfma_f32_32x32x16_bf16 a[224:239], v[172:175], v[224:227], a[224:239]
v_mfma_f32_32x32x16_bf16 a[240:255], v[172:175], v[228:231], a[240:255]
s_waitcnt lgkmcnt(6)
v_mfma_f32_32x32x16_bf16 a[128:143], v[176:179], v[232:235], a[128:143]
v_mfma_f32_32x32x16_bf16 a[144:159], v[176:179], v[236:239], a[144:159]
s_waitcnt lgkmcnt(4)
v_mfma_f32_32x32x16_bf16 a[160:175], v[180:183], v[232:235], a[160:175]
v_mfma_f32_32x32x16_bf16 a[176:191], v[180:183], v[236:239], a[176:191]
s_waitcnt lgkmcnt(2)
v_mfma_f32_32x32x16_bf16 a[192:207], v[184:187], v[232:235], a[192:207]
v_mfma_f32_32x32x16_bf16 a[208:223], v[184:187], v[236:239], a[208:223]
s_waitcnt lgkmcnt(0)
v_mfma_f32_32x32x16_bf16 a[224:239], v[188:191], v[232:235], a[224:239]
v_mfma_f32_32x32x16_bf16 a[240:255], v[188:191], v[236:239], a[240:255]
s_add_u32 s57, s64, s69
s_and_b32 s57, s57, 15
s_lshr_b32 s56, s57, 2
s_lshl_b32 s56, s56, 18
s_and_b32 s57, s57, 3
s_lshl_b32 s57, s57, 15
s_add_u32 s56, s56, s57
s_add_u32 s56, s56, s66
s_add_u32 s64, s64, 1
s_add_u32 m0, s32, 16384
s_add_u32 s55, s56, 0
buffer_load_dwordx4 v24, s[16:19], s55 offen offset:0 lds
s_add_u32 s55, s56, 3072
buffer_load_dwordx4 v24, s[16:19], s55 offen offset:1024 lds
s_add_u32 s55, s56, 6144
buffer_load_dwordx4 v24, s[16:19], s55 offen offset:2048 lds
s_add_u32 s55, s56, 9216
buffer_load_dwordx4 v24, s[16:19], s55 offen offset:3072 lds
s_add_u32 m0, s32, 20480
s_add_u32 s55, s56, 16384
buffer_load_dwordx4 v24, s[16:19], s55 offen offset:0 lds
s_add_u32 s55, s56, 19456
buffer_load_dwordx4 v24, s[16:19], s55 offen offset:1024 lds
s_add_u32 s55, s56, 22528
buffer_load_dwordx4 v24, s[16:19], s55 offen offset:2048 lds
s_add_u32 s55, s56, 25600
buffer_load_dwordx4 v24, s[16:19], s55 offen offset:3072 lds
s_sub_u32 s63, s63, 1
s_cmp_lg_u32 s63, 0
s_cbranch_scc1 L_loop11
s_waitcnt vmcnt(16)
ds_read_b128 v[192:195], v2 offset:0
ds_read_b128 v[196:199], v3 offset:0
ds_read_b128 v[200:203], v4 offset:0
ds_read_b128 v[204:207], v5 offset:0
ds_read_b128 v[208:211], v6 offset:0
ds_read_b128 v[212:215], v7 offset:0
ds_read_b128 v[216:219], v8 offset:0
ds_read_b128 v[220:223], v9 offset:0
s_waitcnt lgkmcnt(7)
v_mfma_f32_32x32x16_bf16 v[112:127], v[192:195], v[48:51], 0
v_mfma_f32_32x32x16_bf16 v[128:143], v[192:195], v[52:55], 0
s_waitcnt lgkmcnt(6)
v_mfma_f32_32x32x16_bf16 v[112:127], v[196:199], v[56:59], v[112:127]
v_mfma_f32_32x32x16_bf16 v[128:143], v[196:199], v[60:63], v[128:143]
s_waitcnt lgkmcnt(5)
v_mfma_f32_32x32x16_bf16 v[112:127], v[200:203], v[64:67], v[112:127]
v_mfma_f32_32x32x16_bf16 v[128:143], v[200:203], v[68:71], v[128:143]
s_waitcnt lgkmcnt(4)
v_mfma_f32_32x32x16_bf16 v[112:127], v[204:207], v[72:75], v[112:127]
v_mfma_f32_32x32x16_bf16 v[128:143], v[204:207], v[76:79], v[128:143]
s_waitcnt lgkmcnt(3)
v_mfma_f32_32x32x16_bf16 v[112:127], v[208:211], v[80:83], v[112:127]
v_mfma_f32_32x32x16_bf16 v[128:143], v[208:211], v[84:87], v[128:143]
s_waitcnt lgkmcnt(2)
v_mfma_f32_32x32x16_bf16 v[112:127], v[212:215], v[88:91], v[112:127]
v_mfma_f32_32x32x16_bf16 v[128:143], v[212:215], v[92:95], v[128:143]
s_waitcnt lgkmcnt(1)
v_mfma_f32_32x32x16_bf16 v[112:127], v[216:219], v[96:99], v[112:127]
v_mfma_f32_32x32x16_bf16 v[128:143], v[216:219], v[100:103], v[128:143]
s_waitcnt lgkmcnt(0)
v_mfma_f32_32x32x16_bf16 v[112:127], v[220:223], v[104:107], v[112:127]
v_mfma_f32_32x32x16_bf16 v[128:143], v[220:223], v[108:111], v[128:143]
s_add_u32 s66, s66, 131072
s_mov_b32 s64, 0
s_add_u32 s57, s64, s69
s_and_b32 s57, s57, 15
s_lshr_b32 s56, s57, 2
s_lshl_b32 s56, s56, 18
s_and_b32 s57, s57, 3
s_lshl_b32 s57, s57, 15
s_add_u32 s56, s56, s57
s_add_u32 s56, s56, s66
s_add_u32 s64, s64, 1
s_add_u32 m0, s32, 0
s_add_u32 s55, s56, 0
buffer_load_dwordx4 v24, s[16:19], s55 offen offset:0 lds
s_add_u32 s55, s56, 3072
buffer_load_dwordx4 v24, s[16:19], s55 offen offset:1024 lds
s_add_u32 s55, s56, 6144
buffer_load_dwordx4 v24, s[16:19], s55 offen offset:2048 lds
s_add_u32 s55, s56, 9216
buffer_load_dwordx4 v24, s[16:19], s55 offen offset:3072 lds
s_add_u32 m0, s32, 4096
s_add_u32 s55, s56, 16384
buffer_load_dwordx4 v24, s[16:19], s55 offen offset:0 lds
s_add_u32 s55, s56, 19456
buffer_load_dwordx4 v24, s[16:19], s55 offen offset:1024 lds
s_add_u32 s55, s56, 22528
buffer_load_dwordx4 v24, s[16:19], s55 offen offset:2048 lds
s_add_u32 s55, s56, 25600
buffer_load_dwordx4 v24, s[16:19], s55 offen offset:3072 lds
s_nop 7
s_nop 7
v_max3_f32 v33, v112, v113, v114
v_max3_f32 v34, v128, v129, v130
v_max3_f32 v33, v33, v115, v116
v_max3_f32 v34, v34, v131, v132
v_max3_f32 v33, v33, v117, v118
v_max3_f32 v34, v34, v133, v134
v_max3_f32 v33, v33, v119, v120
v_max3_f32 v34, v34, v135, v136
v_max3_f32 v33, v33, v121, v122
v_max3_f32 v34, v34, v137, v138
v_max3_f32 v33, v33, v123, v124
v_max3_f32 v34, v34, v139, v140
v_max3_f32 v33, v33, v125, v126
v_max3_f32 v34, v34, v141, v142
v_max_f32 v33, v33, v127
v_max_f32 v34, v34, v143
s_nop 1
v_permlane32_swap_b32 v33, v34
s_nop 1
v_max_f32 v35, v33, v34
v_cmp_gt_f32 vcc, v35, v30
s_nop 4
s_cbranch_vccnz L_rare_l12
L_back_l12:
v_fma_f32 v112, v112, s62, -v31
v_fma_f32 v128, v128, s62, -v32
v_fma_f32 v113, v113, s62, -v31
v_fma_f32 v129, v129, s62, -v32
v_fma_f32 v114, v114, s62, -v31
v_fma_f32 v130, v130, s62, -v32
v_fma_f32 v115, v115, s62, -v31
v_fma_f32 v131, v131, s62, -v32
v_fma_f32 v116, v116, s62, -v31
v_fma_f32 v132, v132, s62, -v32
v_fma_f32 v117, v117, s62, -v31
v_fma_f32 v133, v133, s62, -v32
v_fma_f32 v118, v118, s62, -v31
v_fma_f32 v134, v134, s62, -v32
v_fma_f32 v119, v119, s62, -v31
v_fma_f32 v135, v135, s62, -v32
v_fma_f32 v120, v120, s62, -v31
v_fma_f32 v136, v136, s62, -v32
v_fma_f32 v121, v121, s62, -v31
v_fma_f32 v137, v137, s62, -v32
v_fma_f32 v122, v122, s62, -v31
v_fma_f32 v138, v138, s62, -v32
v_fma_f32 v123, v123, s62, -v31
v_fma_f32 v139, v139, s62, -v32
v_fma_f32 v124, v124, s62, -v31
v_fma_f32 v140, v140, s62, -v32
v_fma_f32 v125, v125, s62, -v31
v_fma_f32 v141, v141, s62, -v32
v_fma_f32 v126, v126, s62, -v31
v_fma_f32 v142, v142, s62, -v32
v_fma_f32 v127, v127, s62, -v31
v_fma_f32 v143, v143, s62, -v32
v_exp_f32 v112, v112
v_exp_f32 v128, v128
v_exp_f32 v113, v113
v_exp_f32 v129, v129
v_exp_f32 v114, v114
v_exp_f32 v130, v130
v_exp_f32 v115, v115
v_exp_f32 v131, v131
v_exp_f32 v116, v116
v_exp_f32 v132, v132
v_exp_f32 v117, v117
v_exp_f32 v133, v133
v_exp_f32 v118, v118
v_exp_f32 v134, v134
v_exp_f32 v119, v119
v_exp_f32 v135, v135
v_exp_f32 v120, v120
v_exp_f32 v136, v136
v_exp_f32 v121, v121
v_exp_f32 v137, v137
v_exp_f32 v122, v122
v_exp_f32 v138, v138
v_exp_f32 v123, v123
v_exp_f32 v139, v139
v_exp_f32 v124, v124
v_exp_f32 v140, v140
v_exp_f32 v125, v125
v_exp_f32 v141, v141
v_exp_f32 v126, v126
v_exp_f32 v142, v142
v_exp_f32 v127, v127
v_exp_f32 v143, v143
s_nop 0
v_add_f32 v40, v40, v112
v_add_f32 v44, v44, v128
v_add_f32 v41, v41, v113
v_add_f32 v45, v45, v129
v_add_f32 v42, v42, v114
v_add_f32 v46, v46, v130
v_add_f32 v43, v43, v115
v_add_f32 v47, v47, v131
v_add_f32 v40, v40, v116
v_add_f32 v44, v44, v132
v_add_f32 v41, v41, v117
v_add_f32 v45, v45, v133
v_add_f32 v42, v42, v118
v_add_f32 v46, v46, v134
v_add_f32 v43, v43, v119
v_add_f32 v47, v47, v135
v_add_f32 v40, v40, v120
v_add_f32 v44, v44, v136
v_add_f32 v41, v41, v121
v_add_f32 v45, v45, v137
v_add_f32 v42, v42, v122
v_add_f32 v46, v46, v138
v_add_f32 v43, v43, v123
v_add_f32 v47, v47, v139
v_add_f32 v40, v40, v124
v_add_f32 v44, v44, v140
v_add_f32 v41, v41, v125
v_add_f32 v45, v45, v141
v_add_f32 v42, v42, v126
v_add_f32 v46, v46, v142
v_add_f32 v43, v43, v127
v_add_f32 v47, v47, v143
v_cvt_pk_bf16_f32 v144, v112, v113
v_cvt_pk_bf16_f32 v145, v114, v115
v_cvt_pk_bf16_f32 v146, v116, v117
v_cvt_pk_bf16_f32 v147, v118, v119
v_cvt_pk_bf16_f32 v148, v120, v121
v_cvt_pk_bf16_f32 v149, v122, v123
v_cvt_pk_bf16_f32 v150, v124, v125
v_cvt_pk_bf16_f32 v151, v126, v127
v_cvt_pk_bf16_f32 v152, v128, v129
v_cvt_pk_bf16_f32 v153, v130, v131
v_cvt_pk_bf16_f32 v154, v132, v133
v_cvt_pk_bf16_f32 v155, v134, v135
v_cvt_pk_bf16_f32 v156, v136, v137
v_cvt_pk_bf16_f32 v157, v138, v139
v_cvt_pk_bf16_f32 v158, v140, v141
v_cvt_pk_bf16_f32 v159, v142, v143
s_waitcnt vmcnt(16)
ds_read_b64_tr_b16 v[160:161], v10 offset:8192
ds_read_b64_tr_b16 v[162:163], v10 offset:10240
ds_read_b64_tr_b16 v[164:165], v11 offset:8192
ds_read_b64_tr_b16 v[166:167], v11 offset:10240
ds_read_b64_tr_b16 v[168:169], v12 offset:8192
ds_read_b64_tr_b16 v[170:171], v12 offset:10240
ds_read_b64_tr_b16 v[172:173], v13 offset:8192
ds_read_b64_tr_b16 v[174:175], v13 offset:10240
ds_read_b64_tr_b16 v[176:177], v10 offset:12288
ds_read_b64_tr_b16 v[178:179], v10 offset:14336
ds_read_b64_tr_b16 v[180:181], v11 offset:12288
ds_read_b64_tr_b16 v[182:183], v11 offset:14336
s_waitcnt lgkmcnt(10)
v_mfma_f32_32x32x16_bf16 a[0:15], v[160:163], v[144:147], a[0:15]
v_mfma_f32_32x32x16_bf16 a[16:31], v[160:163], v[152:155], a[16:31]
ds_read_b64_tr_b16 v[184:185], v12 offset:12288
ds_read_b64_tr_b16 v[186:187], v12 offset:14336
s_waitcnt lgkmcnt(10)
v_mfma_f32_32x32x16_bf16 a[32:47], v[164:167], v[144:147], a[32:47]
v_mfma_f32_32x32x16_bf16 a[48:63], v[164:167], v[152:155], a[48:63]
ds_read_b64_tr_b16 v[188:189], v13 offset:12288
ds_read_b64_tr_b16 v[190:191], v13 offset:14336
s_waitcnt lgkmcnt(10)
v_mfma_f32_32x32x16_bf16 a[64:79], v[168:171], v[144:147], a[64:79]
v_mfma_f32_32x32x16_bf16 a[80:95], v[168:171], v[152:155], a[80:95]
s_waitcnt lgkmcnt(8)
v_mfma_f32_32x32x16_bf16 a[96:111], v[172:175], v[144:147], a[96:111]
v_mfma_f32_32x32x16_bf16 a[112:127], v[172:175], v[152:155], a[112:127]
s_waitcnt lgkmcnt(6)
v_mfma_f32_32x32x16_bf16 a[0:15], v[176:179], v[148:151], a[0:15]
v_mfma_f32_32x32x16_bf16 a[16:31], v[176:179], v[156:159], a[16:31]
s_waitcnt lgkmcnt(4)
v_mfma_f32_32x32x16_bf16 a[32:47], v[180:183], v[148:151], a[32:47]
v_mfma_f32_32x32x16_bf16 a[48:63], v[180:183], v[156:159], a[48:63]
s_waitcnt lgkmcnt(2)
v_mfma_f32_32x32x16_bf16 a[64:79], v[184:187], v[148:151], a[64:79]
v_mfma_f32_32x32x16_bf16 a[80:95], v[184:187], v[156:159], a[80:95]
s_waitcnt lgkmcnt(0)
v_mfma_f32_32x32x16_bf16 a[96:111], v[188:191], v[148:151], a[96:111]
v_mfma_f32_32x32x16_bf16 a[112:127], v[188:191], v[156:159], a[112:127]
s_add_u32 s57, s64, s69
s_and_b32 s57, s57, 15
s_lshr_b32 s56, s57, 2
s_lshl_b32 s56, s56, 18
s_and_b32 s57, s57, 3
s_lshl_b32 s57, s57, 15
s_add_u32 s56, s56, s57
s_add_u32 s56, s56, s66
s_add_u32 s64, s64, 1
s_add_u32 m0, s32, 8192
s_add_u32 s55, s56, 0
buffer_load_dwordx4 v24, s[16:19], s55 offen offset:0 lds
s_add_u32 s55, s56, 3072
buffer_load_dwordx4 v24, s[16:19], s55 offen offset:1024 lds
s_add_u32 s55, s56, 6144
buffer_load_dwordx4 v24, s[16:19], s55 offen offset:2048 lds
s_add_u32 s55, s56, 9216
buffer_load_dwordx4 v24, s[16:19], s55 offen offset:3072 lds
s_add_u32 m0, s32, 12288
s_add_u32 s55, s56, 16384
buffer_load_dwordx4 v24, s[16:19], s55 offen offset:0 lds
s_add_u32 s55, s56, 19456
buffer_load_dwordx4 v24, s[16:19], s55 offen offset:1024 lds
s_add_u32 s55, s56, 22528
buffer_load_dwordx4 v24, s[16:19], s55 offen offset:2048 lds
s_add_u32 s55, s56, 25600
buffer_load_dwordx4 v24, s[16:19], s55 offen offset:3072 lds
s_add_u32 s61, s65, s69
s_and_b32 s61, s61, 15
s_lshr_b32 s60, s61, 2
s_mul_i32 s60, s60, 40960
s_and_b32 s61, s61, 3
s_lshl_b32 s61, s61, 12
s_add_u32 s60, s60, s61
v_add_u32 v27, s60, v26
s_add_u32 s65, s65, 1
ds_read_b128 v[224:227], v27 offset:24576
ds_read_b128 v[228:231], v27 offset:25600
ds_read_b128 v[232:235], v27 offset:26624
ds_read_b128 v[236:239], v27 offset:27648
s_waitcnt vmcnt(16)
s_waitcnt lgkmcnt(0)
ds_read_b64_tr_b16 v[160:161], v14 offset:16384
ds_read_b64_tr_b16 v[162:163], v14 offset:18432
ds_read_b64_tr_b16 v[164:165], v15 offset:16384
ds_read_b64_tr_b16 v[166:167], v15 offset:18432
ds_read_b64_tr_b16 v[168:169], v16 offset:16384
ds_read_b64_tr_b16 v[170:171], v16 offset:18432
ds_read_b64_tr_b16 v[172:173], v17 offset:16384
ds_read_b64_tr_b16 v[174:175], v17 offset:18432
ds_read_b64_tr_b16 v[176:177], v14 offset:20480
ds_read_b64_tr_b16 v[178:179], v14 offset:22528
ds_read_b64_tr_b16 v[180:181], v15 offset:20480
ds_read_b64_tr_b16 v[182:183], v15 offset:22528
s_waitcnt lgkmcnt(10)
v_mfma_f32_32x32x16_bf16 a[128:143], v[160:163], v[224:227], a[128:143]
v_mfma_f32_32x32x16_bf16 a[144:159], v[160:163], v[228:231], a[144:159]
ds_read_b64_tr_b16 v[184:185], v16 offset:20480
ds_read_b64_tr_b16 v[186:187], v16 offset:22528
s_waitcnt lgkmcnt(10)
v_mfma_f32_32x32x16_bf16 a[160:175], v[164:167], v[224:227], a[160:175]
v_mfma_f32_32x32x16_bf16 a[176:191], v[164:167], v[228:231], a[176:191]
ds_read_b64_tr_b16 v[188:189], v17 offset:20480
ds_read_b64_tr_b16 v[190:191], v17 offset:22528
s_waitcnt lgkmcnt(10)
v_mfma_f32_32x32x16_bf16 a[192:207], v[168:171], v[224:227], a[192:207]
v_mfma_f32_32x32x16_bf16 a[208:223], v[168:171], v[228:231], a[208:223]
s_waitcnt lgkmcnt(8)
v_mfma_f32_32x32x16_bf16 a[224:239], v[172:175], v[224:227], a[224:239]
v_mfma_f32_32x32x16_bf16 a[240:255], v[172:175], v[228:231], a[240:255]
s_waitcnt lgkmcnt(6)
v_mfma_f32_32x32x16_bf16 a[128:143], v[176:179], v[232:235], a[128:143]
v_mfma_f32_32x32x16_bf16 a[144:159], v[176:179], v[236:239], a[144:159]
s_waitcnt lgkmcnt(4)
v_mfma_f32_32x32x16_bf16 a[160:175], v[180:183], v[232:235], a[160:175]
v_mfma_f32_32x32x16_bf16 a[176:191], v[180:183], v[236:239], a[176:191]
s_waitcnt lgkmcnt(2)
v_mfma_f32_32x32x16_bf16 a[192:207], v[184:187], v[232:235], a[192:207]
v_mfma_f32_32x32x16_bf16 a[208:223], v[184:187], v[236:239], a[208:223]
s_waitcnt lgkmcnt(0)
v_mfma_f32_32x32x16_bf16 a[224:239], v[188:191], v[232:235], a[224:239]
v_mfma_f32_32x32x16_bf16 a[240:255], v[188:191], v[236:239], a[240:255]
s_add_u32 s57, s64, s69
s_and_b32 s57, s57, 15
s_lshr_b32 s56, s57, 2
s_lshl_b32 s56, s56, 18
s_and_b32 s57, s57, 3
s_lshl_b32 s57, s57, 15
s_add_u32 s56, s56, s57
s_add_u32 s56, s56, s66
s_add_u32 s64, s64, 1
s_add_u32 m0, s32, 16384
s_add_u32 s55, s56, 0
buffer_load_dwordx4 v24, s[16:19], s55 offen offset:0 lds
s_add_u32 s55, s56, 3072
buffer_load_dwordx4 v24, s[16:19], s55 offen offset:1024 lds
s_add_u32 s55, s56, 6144
buffer_load_dwordx4 v24, s[16:19], s55 offen offset:2048 lds
s_add_u32 s55, s56, 9216
buffer_load_dwordx4 v24, s[16:19], s55 offen offset:3072 lds
s_add_u32 m0, s32, 20480
s_add_u32 s55, s56, 16384
buffer_load_dwordx4 v24, s[16:19], s55 offen offset:0 lds
s_add_u32 s55, s56, 19456
buffer_load_dwordx4 v24, s[16:19], s55 offen offset:1024 lds
s_add_u32 s55, s56, 22528
buffer_load_dwordx4 v24, s[16:19], s55 offen offset:2048 lds
s_add_u32 s55, s56, 25600
buffer_load_dwordx4 v24, s[16:19], s55 offen offset:3072 lds
s_barrier
s_nop 7
s_nop 7
v_add_f32 v40, v40, v41
v_add_f32 v42, v42, v43
v_add_f32 v44, v44, v45
v_add_f32 v46, v46, v47
v_add_f32 v33, v40, v42
v_add_f32 v34, v44, v46
s_nop 1
v_permlane32_swap_b32 v33, v34
s_nop 1
v_add_f32 v33, v33, v34
v_rcp_f32 v33, v33
s_nop 1
v_mov_b32 v34, v33
s_nop 1
v_permlane32_swap_b32 v33, v34
s_nop 1
v_accvgpr_read_b32 v240, a0
v_accvgpr_read_b32 v241, a1
v_accvgpr_read_b32 v242, a2
v_accvgpr_read_b32 v243, a3
v_accvgpr_read_b32 v244, a4
v_accvgpr_read_b32 v245, a5
v_accvgpr_read_b32 v246, a6
v_accvgpr_read_b32 v247, a7
v_accvgpr_read_b32 v248, a8
v_accvgpr_read_b32 v249, a9
v_accvgpr_read_b32 v250, a10
v_accvgpr_read_b32 v251, a11
v_accvgpr_read_b32 v252, a12
v_accvgpr_read_b32 v253, a13
v_accvgpr_read_b32 v254, a14
v_accvgpr_read_b32 v255, a15
v_mul_f32 v240, v240, v33
v_mul_f32 v241, v241, v33
v_mul_f32 v242, v242, v33
v_mul_f32 v243, v243, v33
v_mul_f32 v244, v244, v33
v_mul_f32 v245, v245, v33
v_mul_f32 v246, v246, v33
v_mul_f32 v247, v247, v33
v_mul_f32 v248, v248, v33
v_mul_f32 v249, v249, v33
v_mul_f32 v250, v250, v33
v_mul_f32 v251, v251, v33
v_mul_f32 v252, v252, v33
v_mul_f32 v253, v253, v33
v_mul_f32 v254, v254, v33
v_mul_f32 v255, v255, v33
v_cvt_pk_bf16_f32 v160, v240, v241
v_cvt_pk_bf16_f32 v161, v242, v243
v_cvt_pk_bf16_f32 v162, v244, v245
v_cvt_pk_bf16_f32 v163, v246, v247
v_cvt_pk_bf16_f32 v164, v248, v249
v_cvt_pk_bf16_f32 v165, v250, v251
v_cvt_pk_bf16_f32 v166, v252, v253
v_cvt_pk_bf16_f32 v167, v254, v255
ds_write_b128 v28, v[160:163] offset:0
ds_write_b128 v28, v[164:167] offset:2048
v_accvgpr_read_b32 v240, a16
v_accvgpr_read_b32 v241, a17
v_accvgpr_read_b32 v242, a18
v_accvgpr_read_b32 v243, a19
v_accvgpr_read_b32 v244, a20
v_accvgpr_read_b32 v245, a21
v_accvgpr_read_b32 v246, a22
v_accvgpr_read_b32 v247, a23
v_accvgpr_read_b32 v248, a24
v_accvgpr_read_b32 v249, a25
v_accvgpr_read_b32 v250, a26
v_accvgpr_read_b32 v251, a27
v_accvgpr_read_b32 v252, a28
v_accvgpr_read_b32 v253, a29
v_accvgpr_read_b32 v254, a30
v_accvgpr_read_b32 v255, a31
v_mul_f32 v240, v240, v34
v_mul_f32 v241, v241, v34
v_mul_f32 v242, v242, v34
v_mul_f32 v243, v243, v34
v_mul_f32 v244, v244, v34
v_mul_f32 v245, v245, v34
v_mul_f32 v246, v246, v34
v_mul_f32 v247, v247, v34
v_mul_f32 v248, v248, v34
v_mul_f32 v249, v249, v34
v_mul_f32 v250, v250, v34
v_mul_f32 v251, v251, v34
v_mul_f32 v252, v252, v34
v_mul_f32 v253, v253, v34
v_mul_f32 v254, v254, v34
v_mul_f32 v255, v255, v34
v_cvt_pk_bf16_f32 v168, v240, v241
v_cvt_pk_bf16_f32 v169, v242, v243
v_cvt_pk_bf16_f32 v170, v244, v245
v_cvt_pk_bf16_f32 v171, v246, v247
v_cvt_pk_bf16_f32 v172, v248, v249
v_cvt_pk_bf16_f32 v173, v250, v251
v_cvt_pk_bf16_f32 v174, v252, v253
v_cvt_pk_bf16_f32 v175, v254, v255
ds_write_b128 v28, v[168:171] offset:1024
ds_write_b128 v28, v[172:175] offset:3072
v_accvgpr_read_b32 v240, a32
v_accvgpr_read_b32 v241, a33
v_accvgpr_read_b32 v242, a34
v_accvgpr_read_b32 v243, a35
v_accvgpr_read_b32 v244, a36
v_accvgpr_read_b32 v245, a37
v_accvgpr_read_b32 v246, a38
v_accvgpr_read_b32 v247, a39
v_accvgpr_read_b32 v248, a40
v_accvgpr_read_b32 v249, a41
v_accvgpr_read_b32 v250, a42
v_accvgpr_read_b32 v251, a43
v_accvgpr_read_b32 v252, a44
v_accvgpr_read_b32 v253, a45
v_accvgpr_read_b32 v254, a46
v_accvgpr_read_b32 v255, a47
v_mul_f32 v240, v240, v33
v_mul_f32 v241, v241, v33
v_mul_f32 v242, v242, v33
v_mul_f32 v243, v243, v33
v_mul_f32 v244, v244, v33
v_mul_f32 v245, v245, v33
v_mul_f32 v246, v246, v33
v_mul_f32 v247, v247, v33
v_mul_f32 v248, v248, v33
v_mul_f32 v249, v249, v33
v_mul_f32 v250, v250, v33
v_mul_f32 v251, v251, v33
v_mul_f32 v252, v252, v33
v_mul_f32 v253, v253, v33
v_mul_f32 v254, v254, v33
v_mul_f32 v255, v255, v33
v_cvt_pk_bf16_f32 v176, v240, v241
v_cvt_pk_bf16_f32 v177, v242, v243
v_cvt_pk_bf16_f32 v178, v244, v245
v_cvt_pk_bf16_f32 v179, v246, v247
v_cvt_pk_bf16_f32 v180, v248, v249
v_cvt_pk_bf16_f32 v181, v250, v251
v_cvt_pk_bf16_f32 v182, v252, v253
v_cvt_pk_bf16_f32 v183, v254, v255
ds_write_b128 v28, v[176:179] offset:4096
ds_write_b128 v28, v[180:183] offset:6144
v_accvgpr_read_b32 v240, a48
v_accvgpr_read_b32 v241, a49
v_accvgpr_read_b32 v242, a50
v_accvgpr_read_b32 v243, a51
v_accvgpr_read_b32 v244, a52
v_accvgpr_read_b32 v245, a53
v_accvgpr_read_b32 v246, a54
v_accvgpr_read_b32 v247, a55
v_accvgpr_read_b32 v248, a56
v_accvgpr_read_b32 v249, a57
v_accvgpr_read_b32 v250, a58
v_accvgpr_read_b32 v251, a59
v_accvgpr_read_b32 v252, a60
v_accvgpr_read_b32 v253, a61
v_accvgpr_read_b32 v254, a62
v_accvgpr_read_b32 v255, a63
v_mul_f32 v240, v240, v34
v_mul_f32 v241, v241, v34
v_mul_f32 v242, v242, v34
v_mul_f32 v243, v243, v34
v_mul_f32 v244, v244, v34
v_mul_f32 v245, v245, v34
v_mul_f32 v246, v246, v34
v_mul_f32 v247, v247, v34
v_mul_f32 v248, v248, v34
v_mul_f32 v249, v249, v34
v_mul_f32 v250, v250, v34
v_mul_f32 v251, v251, v34
v_mul_f32 v252, v252, v34
v_mul_f32 v253, v253, v34
v_mul_f32 v254, v254, v34
v_mul_f32 v255, v255, v34
v_cvt_pk_bf16_f32 v184, v240, v241
v_cvt_pk_bf16_f32 v185, v242, v243
v_cvt_pk_bf16_f32 v186, v244, v245
v_cvt_pk_bf16_f32 v187, v246, v247
v_cvt_pk_bf16_f32 v188, v248, v249
v_cvt_pk_bf16_f32 v189, v250, v251
v_cvt_pk_bf16_f32 v190, v252, v253
v_cvt_pk_bf16_f32 v191, v254, v255
ds_write_b128 v28, v[184:187] offset:5120
ds_write_b128 v28, v[188:191] offset:7168
s_waitcnt lgkmcnt(0)
v_accvgpr_read_b32 v240, a64
v_accvgpr_read_b32 v241, a65
v_accvgpr_read_b32 v242, a66
v_accvgpr_read_b32 v243, a67
v_accvgpr_read_b32 v244, a68
v_accvgpr_read_b32 v245, a69
v_accvgpr_read_b32 v246, a70
v_accvgpr_read_b32 v247, a71
v_accvgpr_read_b32 v248, a72
v_accvgpr_read_b32 v249, a73
v_accvgpr_read_b32 v250, a74
v_accvgpr_read_b32 v251, a75
v_accvgpr_read_b32 v252, a76
v_accvgpr_read_b32 v253, a77
v_accvgpr_read_b32 v254, a78
v_accvgpr_read_b32 v255, a79
v_mul_f32 v240, v240, v33
v_mul_f32 v241, v241, v33
v_mul_f32 v242, v242, v33
v_mul_f32 v243, v243, v33
v_mul_f32 v244, v244, v33
v_mul_f32 v245, v245, v33
v_mul_f32 v246, v246, v33
v_mul_f32 v247, v247, v33
v_mul_f32 v248, v248, v33
v_mul_f32 v249, v249, v33
v_mul_f32 v250, v250, v33
v_mul_f32 v251, v251, v33
v_mul_f32 v252, v252, v33
v_mul_f32 v253, v253, v33
v_mul_f32 v254, v254, v33
v_mul_f32 v255, v255, v33
v_cvt_pk_bf16_f32 v160, v240, v241
v_cvt_pk_bf16_f32 v161, v242, v243
v_cvt_pk_bf16_f32 v162, v244, v245
v_cvt_pk_bf16_f32 v163, v246, v247
v_cvt_pk_bf16_f32 v164, v248, v249
v_cvt_pk_bf16_f32 v165, v250, v251
v_cvt_pk_bf16_f32 v166, v252, v253
v_cvt_pk_bf16_f32 v167, v254, v255
ds_write_b128 v28, v[160:163] offset:8192
ds_write_b128 v28, v[164:167] offset:10240
v_accvgpr_read_b32 v240, a80
v_accvgpr_read_b32 v241, a81
v_accvgpr_read_b32 v242, a82
v_accvgpr_read_b32 v243, a83
v_accvgpr_read_b32 v244, a84
v_accvgpr_read_b32 v245, a85
v_accvgpr_read_b32 v246, a86
v_accvgpr_read_b32 v247, a87
v_accvgpr_read_b32 v248, a88
v_accvgpr_read_b32 v249, a89
v_accvgpr_read_b32 v250, a90
v_accvgpr_read_b32 v251, a91
v_accvgpr_read_b32 v252, a92
v_accvgpr_read_b32 v253, a93
v_accvgpr_read_b32 v254, a94
v_accvgpr_read_b32 v255, a95
v_mul_f32 v240, v240, v34
v_mul_f32 v241, v241, v34
v_mul_f32 v242, v242, v34
v_mul_f32 v243, v243, v34
v_mul_f32 v244, v244, v34
v_mul_f32 v245, v245, v34
v_mul_f32 v246, v246, v34
v_mul_f32 v247, v247, v34
v_mul_f32 v248, v248, v34
v_mul_f32 v249, v249, v34
v_mul_f32 v250, v250, v34
v_mul_f32 v251, v251, v34
v_mul_f32 v252, v252, v34
v_mul_f32 v253, v253, v34
v_mul_f32 v254, v254, v34
v_mul_f32 v255, v255, v34
v_cvt_pk_bf16_f32 v168, v240, v241
v_cvt_pk_bf16_f32 v169, v242, v243
v_cvt_pk_bf16_f32 v170, v244, v245
v_cvt_pk_bf16_f32 v171, v246, v247
v_cvt_pk_bf16_f32 v172, v248, v249
v_cvt_pk_bf16_f32 v173, v250, v251
v_cvt_pk_bf16_f32 v174, v252, v253
v_cvt_pk_bf16_f32 v175, v254, v255
ds_write_b128 v28, v[168:171] offset:9216
ds_write_b128 v28, v[172:175] offset:11264
v_accvgpr_read_b32 v240, a96
v_accvgpr_read_b32 v241, a97
v_accvgpr_read_b32 v242, a98
v_accvgpr_read_b32 v243, a99
v_accvgpr_read_b32 v244, a100
v_accvgpr_read_b32 v245, a101
v_accvgpr_read_b32 v246, a102
v_accvgpr_read_b32 v247, a103
v_accvgpr_read_b32 v248, a104
v_accvgpr_read_b32 v249, a105
v_accvgpr_read_b32 v250, a106
v_accvgpr_read_b32 v251, a107
v_accvgpr_read_b32 v252, a108
v_accvgpr_read_b32 v253, a109
v_accvgpr_read_b32 v254, a110
v_accvgpr_read_b32 v255, a111
v_mul_f32 v240, v240, v33
v_mul_f32 v241, v241, v33
v_mul_f32 v242, v242, v33
v_mul_f32 v243, v243, v33
v_mul_f32 v244, v244, v33
v_mul_f32 v245, v245, v33
v_mul_f32 v246, v246, v33
v_mul_f32 v247, v247, v33
v_mul_f32 v248, v248, v33
v_mul_f32 v249, v249, v33
v_mul_f32 v250, v250, v33
v_mul_f32 v251, v251, v33
v_mul_f32 v252, v252, v33
v_mul_f32 v253, v253, v33
v_mul_f32 v254, v254, v33
v_mul_f32 v255, v255, v33
v_cvt_pk_bf16_f32 v176, v240, v241
v_cvt_pk_bf16_f32 v177, v242, v243
v_cvt_pk_bf16_f32 v178, v244, v245
v_cvt_pk_bf16_f32 v179, v246, v247
v_cvt_pk_bf16_f32 v180, v248, v249
v_cvt_pk_bf16_f32 v181, v250, v251
v_cvt_pk_bf16_f32 v182, v252, v253
v_cvt_pk_bf16_f32 v183, v254, v255
ds_write_b128 v28, v[176:179] offset:12288
ds_write_b128 v28, v[180:183] offset:14336
v_accvgpr_read_b32 v240, a112
v_accvgpr_read_b32 v241, a113
v_accvgpr_read_b32 v242, a114
v_accvgpr_read_b32 v243, a115
v_accvgpr_read_b32 v244, a116
v_accvgpr_read_b32 v245, a117
v_accvgpr_read_b32 v246, a118
v_accvgpr_read_b32 v247, a119
v_accvgpr_read_b32 v248, a120
v_accvgpr_read_b32 v249, a121
v_accvgpr_read_b32 v250, a122
v_accvgpr_read_b32 v251, a123
v_accvgpr_read_b32 v252, a124
v_accvgpr_read_b32 v253, a125
v_accvgpr_read_b32 v254, a126
v_accvgpr_read_b32 v255, a127
v_mul_f32 v240, v240, v34
v_mul_f32 v241, v241, v34
v_mul_f32 v242, v242, v34
v_mul_f32 v243, v243, v34
v_mul_f32 v244, v244, v34
v_mul_f32 v245, v245, v34
v_mul_f32 v246, v246, v34
v_mul_f32 v247, v247, v34
v_mul_f32 v248, v248, v34
v_mul_f32 v249, v249, v34
v_mul_f32 v250, v250, v34
v_mul_f32 v251, v251, v34
v_mul_f32 v252, v252, v34
v_mul_f32 v253, v253, v34
v_mul_f32 v254, v254, v34
v_mul_f32 v255, v255, v34
v_cvt_pk_bf16_f32 v184, v240, v241
v_cvt_pk_bf16_f32 v185, v242, v243
v_cvt_pk_bf16_f32 v186, v244, v245
v_cvt_pk_bf16_f32 v187, v246, v247
v_cvt_pk_bf16_f32 v188, v248, v249
v_cvt_pk_bf16_f32 v189, v250, v251
v_cvt_pk_bf16_f32 v190, v252, v253
v_cvt_pk_bf16_f32 v191, v254, v255
ds_write_b128 v28, v[184:187] offset:13312
ds_write_b128 v28, v[188:191] offset:15360
s_waitcnt lgkmcnt(0)
s_barrier
s_mov_b32 s65, 0
s_add_u32 s61, s65, s69
s_and_b32 s61, s61, 15
s_lshr_b32 s60, s61, 2
s_mul_i32 s60, s60, 40960
s_and_b32 s61, s61, 3
s_lshl_b32 s61, s61, 12
s_add_u32 s60, s60, s61
v_add_u32 v27, s60, v26
s_add_u32 s65, s65, 1
ds_read_b128 v[224:227], v27 offset:24576
ds_read_b128 v[228:231], v27 offset:25600
ds_read_b128 v[232:235], v27 offset:26624
ds_read_b128 v[236:239], v27 offset:27648
s_waitcnt vmcnt(16)
ds_read_b64_tr_b16 v[160:161], v14 offset:0
ds_read_b64_tr_b16 v[162:163], v14 offset:2048
ds_read_b64_tr_b16 v[164:165], v15 offset:0
ds_read_b64_tr_b16 v[166:167], v15 offset:2048
ds_read_b64_tr_b16 v[168:169], v16 offset:0
ds_read_b64_tr_b16 v[170:171], v16 offset:2048
ds_read_b64_tr_b16 v[172:173], v17 offset:0
ds_read_b64_tr_b16 v[174:175], v17 offset:2048
ds_read_b64_tr_b16 v[176:177], v14 offset:4096
ds_read_b64_tr_b16 v[178:179], v14 offset:6144
s_waitcnt lgkmcnt(8)
v_mfma_f32_32x32x16_bf16 a[128:143], v[160:163], v[224:227], a[128:143]
ds_read_b64_tr_b16 v[180:181], v15 offset:4096
ds_read_b64_tr_b16 v[182:183], v15 offset:6144
ds_read_b64_tr_b16 v[184:185], v16 offset:4096
ds_read_b64_tr_b16 v[186:187], v16 offset:6144
v_mfma_f32_32x32x16_bf16 a[144:159], v[160:163], v[228:231], a[144:159]
s_waitcnt lgkmcnt(10)
v_mfma_f32_32x32x16_bf16 a[160:175], v[164:167], v[224:227], a[160:175]
ds_read_b64_tr_b16 v[188:189], v17 offset:4096
ds_read_b64_tr_b16 v[190:191], v17 offset:6144
v_mfma_f32_32x32x16_bf16 a[176:191], v[164:167], v[228:231], a[176:191]
s_waitcnt lgkmcnt(10)
v_mfma_f32_32x32x16_bf16 a[192:207], v[168:171], v[224:227], a[192:207]
v_mfma_f32_32x32x16_bf16 a[208:223], v[168:171], v[228:231], a[208:223]
s_waitcnt lgkmcnt(8)
v_mfma_f32_32x32x16_bf16 a[224:239], v[172:175], v[224:227], a[224:239]
s_add_u32 s61, s65, s69
s_and_b32 s61, s61, 15
s_lshr_b32 s60, s61, 2
s_mul_i32 s60, s60, 40960
s_and_b32 s61, s61, 3
s_lshl_b32 s61, s61, 12
s_add_u32 s60, s60, s61
v_add_u32 v27, s60, v26
s_add_u32 s65, s65, 1
ds_read_b128 v[144:147], v27 offset:24576
ds_read_b128 v[148:151], v27 offset:25600
ds_read_b128 v[152:155], v27 offset:26624
ds_read_b128 v[156:159], v27 offset:27648
s_waitcnt vmcnt(8)
ds_read_b64_tr_b16 v[192:193], v14 offset:8192
ds_read_b64_tr_b16 v[194:195], v14 offset:10240
v_mfma_f32_32x32x16_bf16 a[240:255], v[172:175], v[228:231], a[240:255]
s_waitcnt lgkmcnt(12)
v_mfma_f32_32x32x16_bf16 a[128:143], v[176:179], v[232:235], a[128:143]
ds_read_b64_tr_b16 v[196:197], v15 offset:8192
ds_read_b64_tr_b16 v[198:199], v15 offset:10240
v_mfma_f32_32x32x16_bf16 a[144:159], v[176:179], v[236:239], a[144:159]
s_waitcnt lgkmcnt(12)
v_mfma_f32_32x32x16_bf16 a[160:175], v[180:183], v[232:235], a[160:175]
ds_read_b64_tr_b16 v[200:201], v16 offset:8192
ds_read_b64_tr_b16 v[202:203], v16 offset:10240
v_mfma_f32_32x32x16_bf16 a[176:191], v[180:183], v[236:239], a[176:191]
s_waitcnt lgkmcnt(12)
v_mfma_f32_32x32x16_bf16 a[192:207], v[184:187], v[232:235], a[192:207]
ds_read_b64_tr_b16 v[204:205], v17 offset:8192
ds_read_b64_tr_b16 v[206:207], v17 offset:10240
v_mfma_f32_32x32x16_bf16 a[208:223], v[184:187], v[236:239], a[208:223]
s_waitcnt lgkmcnt(12)
v_mfma_f32_32x32x16_bf16 a[224:239], v[188:191], v[232:235], a[224:239]
ds_read_b64_tr_b16 v[208:209], v14 offset:12288
ds_read_b64_tr_b16 v[210:211], v14 offset:14336
v_mfma_f32_32x32x16_bf16 a[240:255], v[188:191], v[236:239], a[240:255]
s_add_u32 s57, s64, s69
s_and_b32 s57, s57, 15
s_lshr_b32 s56, s57, 2
s_lshl_b32 s56, s56, 18
s_and_b32 s57, s57, 3
s_lshl_b32 s57, s57, 15
s_add_u32 s56, s56, s57
s_add_u32 s56, s56, s66
s_add_u32 s64, s64, 1
s_add_u32 m0, s32, 0
s_add_u32 s55, s56, 0
buffer_load_dwordx4 v24, s[16:19], s55 offen offset:0 lds
s_waitcnt lgkmcnt(8)
v_mfma_f32_32x32x16_bf16 a[128:143], v[192:195], v[144:147], a[128:143]
ds_read_b64_tr_b16 v[212:213], v15 offset:12288
ds_read_b64_tr_b16 v[214:215], v15 offset:14336
ds_read_b64_tr_b16 v[216:217], v16 offset:12288
ds_read_b64_tr_b16 v[218:219], v16 offset:14336
v_mfma_f32_32x32x16_bf16 a[144:159], v[192:195], v[148:151], a[144:159]
s_add_u32 s55, s56, 3072
buffer_load_dwordx4 v24, s[16:19], s55 offen offset:1024 lds
s_waitcnt lgkmcnt(10)
v_mfma_f32_32x32x16_bf16 a[160:175], v[196:199], v[144:147], a[160:175]
ds_read_b64_tr_b16 v[220:221], v17 offset:12288
ds_read_b64_tr_b16 v[222:223], v17 offset:14336
v_mfma_f32_32x32x16_bf16 a[176:191], v[196:199], v[148:151], a[176:191]
s_add_u32 s55, s56, 6144
buffer_load_dwordx4 v24, s[16:19], s55 offen offset:2048 lds
s_waitcnt lgkmcnt(10)
v_mfma_f32_32x32x16_bf16 a[192:207], v[200:203], v[144:147], a[192:207]
v_mfma_f32_32x32x16_bf16 a[208:223], v[200:203], v[148:151], a[208:223]
s_add_u32 s55, s56, 9216
buffer_load_dwordx4 v24, s[16:19], s55 offen offset:3072 lds
s_waitcnt lgkmcnt(8)
v_mfma_f32_32x32x16_bf16 a[224:239], v[204:207], v[144:147], a[224:239]
s_add_u32 s61, s65, s69
s_and_b32 s61, s61, 15
s_lshr_b32 s60, s61, 2
s_mul_i32 s60, s60, 40960
s_and_b32 s61, s61, 3
s_lshl_b32 s61, s61, 12
s_add_u32 s60, s60, s61
v_add_u32 v27, s60, v26
s_add_u32 s65, s65, 1
ds_read_b128 v[224:227], v27 offset:24576
ds_read_b128 v[228:231], v27 offset:25600
ds_read_b128 v[232:235], v27 offset:26624
ds_read_b128 v[236:239], v27 offset:27648
s_waitcnt vmcnt(4)
ds_read_b64_tr_b16 v[160:161], v14 offset:16384
ds_read_b64_tr_b16 v[162:163], v14 offset:18432
v_mfma_f32_32x32x16_bf16 a[240:255], v[204:207], v[148:151], a[240:255]
s_add_u32 m0, s32, 4096
s_add_u32 s55, s56, 16384
buffer_load_dwordx4 v24, s[16:19], s55 offen offset:0 lds
s_waitcnt lgkmcnt(12)
v_mfma_f32_32x32x16_bf16 a[128:143], v[208:211], v[152:155], a[128:143]
ds_read_b64_tr_b16 v[164:165], v15 offset:16384
ds_read_b64_tr_b16 v[166:167], v15 offset:18432
v_mfma_f32_32x32x16_bf16 a[144:159], v[208:211], v[156:159], a[144:159]
s_add_u32 s55, s56, 19456
buffer_load_dwordx4 v24, s[16:19], s55 offen offset:1024 lds
s_waitcnt lgkmcnt(12)
v_mfma_f32_32x32x16_bf16 a[160:175], v[212:215], v[152:155], a[160:175]
ds_read_b64_tr_b16 v[168:169], v16 offset:16384
ds_read_b64_tr_b16 v[170:171], v16 offset:18432
v_mfma_f32_32x32x16_bf16 a[176:191], v[212:215], v[156:159], a[176:191]
s_add_u32 s55, s56, 22528
buffer_load_dwordx4 v24, s[16:19], s55 offen offset:2048 lds
s_waitcnt lgkmcnt(12)
v_mfma_f32_32x32x16_bf16 a[192:207], v[216:219], v[152:155], a[192:207]
ds_read_b64_tr_b16 v[172:173], v17 offset:16384
ds_read_b64_tr_b16 v[174:175], v17 offset:18432
v_mfma_f32_32x32x16_bf16 a[208:223], v[216:219], v[156:159], a[208:223]
s_add_u32 s55, s56, 25600
buffer_load_dwordx4 v24, s[16:19], s55 offen offset:3072 lds
s_waitcnt lgkmcnt(12)
v_mfma_f32_32x32x16_bf16 a[224:239], v[220:223], v[152:155], a[224:239]
ds_read_b64_tr_b16 v[176:177], v14 offset:20480
ds_read_b64_tr_b16 v[178:179], v14 offset:22528
v_mfma_f32_32x32x16_bf16 a[240:255], v[220:223], v[156:159], a[240:255]
s_add_u32 s57, s64, s69
s_and_b32 s57, s57, 15
s_lshr_b32 s56, s57, 2
s_lshl_b32 s56, s56, 18
s_and_b32 s57, s57, 3
s_lshl_b32 s57, s57, 15
s_add_u32 s56, s56, s57
s_add_u32 s56, s56, s66
s_add_u32 s64, s64, 1
s_add_u32 m0, s32, 8192
s_add_u32 s55, s56, 0
buffer_load_dwordx4 v24, s[16:19], s55 offen offset:0 lds
s_waitcnt lgkmcnt(8)
v_mfma_f32_32x32x16_bf16 a[128:143], v[160:163], v[224:227], a[128:143]
ds_read_b64_tr_b16 v[180:181], v15 offset:20480
ds_read_b64_tr_b16 v[182:183], v15 offset:22528
ds_read_b64_tr_b16 v[184:185], v16 offset:20480
ds_read_b64_tr_b16 v[186:187], v16 offset:22528
v_mfma_f32_32x32x16_bf16 a[144:159], v[160:163], v[228:231], a[144:159]
s_add_u32 s55, s56, 3072
buffer_load_dwordx4 v24, s[16:19], s55 offen offset:1024 lds
s_waitcnt lgkmcnt(10)
v_mfma_f32_32x32x16_bf16 a[160:175], v[164:167], v[224:227], a[160:175]
ds_read_b64_tr_b16 v[188:189], v17 offset:20480
ds_read_b64_tr_b16 v[190:191], v17 offset:22528
v_mfma_f32_32x32x16_bf16 a[176:191], v[164:167], v[228:231], a[176:191]
s_add_u32 s55, s56, 6144
buffer_load_dwordx4 v24, s[16:19], s55 offen offset:2048 lds
s_waitcnt lgkmcnt(10)
v_mfma_f32_32x32x16_bf16 a[192:207], v[168:171], v[224:227], a[192:207]
v_mfma_f32_32x32x16_bf16 a[208:223], v[168:171], v[228:231], a[208:223]
s_add_u32 s55, s56, 9216
buffer_load_dwordx4 v24, s[16:19], s55 offen offset:3072 lds
s_waitcnt lgkmcnt(8)
v_mfma_f32_32x32x16_bf16 a[224:239], v[172:175], v[224:227], a[224:239]
s_add_u32 s61, s65, s69
s_and_b32 s61, s61, 15
s_lshr_b32 s60, s61, 2
s_mul_i32 s60, s60, 40960
s_and_b32 s61, s61, 3
s_lshl_b32 s61, s61, 12
s_add_u32 s60, s60, s61
v_add_u32 v27, s60, v26
s_add_u32 s65, s65, 1
ds_read_b128 v[144:147], v27 offset:24576
ds_read_b128 v[148:151], v27 offset:25600
ds_read_b128 v[152:155], v27 offset:26624
ds_read_b128 v[156:159], v27 offset:27648
s_waitcnt vmcnt(4)
ds_read_b64_tr_b16 v[192:193], v14 offset:0
ds_read_b64_tr_b16 v[194:195], v14 offset:2048
v_mfma_f32_32x32x16_bf16 a[240:255], v[172:175], v[228:231], a[240:255]
s_add_u32 m0, s32, 12288
s_add_u32 s55, s56, 16384
buffer_load_dwordx4 v24, s[16:19], s55 offen offset:0 lds
s_waitcnt lgkmcnt(12)
v_mfma_f32_32x32x16_bf16 a[128:143], v[176:179], v[232:235], a[128:143]
ds_read_b64_tr_b16 v[196:197], v15 offset:0
ds_read_b64_tr_b16 v[198:199], v15 offset:2048
v_mfma_f32_32x32x16_bf16 a[144:159], v[176:179], v[236:239], a[144:159]
s_add_u32 s55, s56, 19456
buffer_load_dwordx4 v24, s[16:19], s55 offen offset:1024 lds
s_waitcnt lgkmcnt(12)
v_mfma_f32_32x32x16_bf16 a[160:175], v[180:183], v[232:235], a[160:175]
ds_read_b64_tr_b16 v[200:201], v16 offset:0
ds_read_b64_tr_b16 v[202:203], v16 offset:2048
v_mfma_f32_32x32x16_bf16 a[176:191], v[180:183], v[236:239], a[176:191]
s_add_u32 s55, s56, 22528
buffer_load_dwordx4 v24, s[16:19], s55 offen offset:2048 lds
s_waitcnt lgkmcnt(12)
v_mfma_f32_32x32x16_bf16 a[192:207], v[184:187], v[232:235], a[192:207]
ds_read_b64_tr_b16 v[204:205], v17 offset:0
ds_read_b64_tr_b16 v[206:207], v17 offset:2048
v_mfma_f32_32x32x16_bf16 a[208:223], v[184:187], v[236:239], a[208:223]
s_add_u32 s55, s56, 25600
buffer_load_dwordx4 v24, s[16:19], s55 offen offset:3072 lds
s_waitcnt lgkmcnt(12)
v_mfma_f32_32x32x16_bf16 a[224:239], v[188:191], v[232:235], a[224:239]
ds_read_b64_tr_b16 v[208:209], v14 offset:4096
ds_read_b64_tr_b16 v[210:211], v14 offset:6144
v_mfma_f32_32x32x16_bf16 a[240:255], v[188:191], v[236:239], a[240:255]
s_add_u32 s57, s64, s69
s_and_b32 s57, s57, 15
s_lshr_b32 s56, s57, 2
s_lshl_b32 s56, s56, 18
s_and_b32 s57, s57, 3
s_lshl_b32 s57, s57, 15
s_add_u32 s56, s56, s57
s_add_u32 s56, s56, s66
s_add_u32 s64, s64, 1
s_add_u32 m0, s32, 16384
s_add_u32 s55, s56, 0
buffer_load_dwordx4 v24, s[16:19], s55 offen offset:0 lds
s_waitcnt lgkmcnt(8)
v_mfma_f32_32x32x16_bf16 a[128:143], v[192:195], v[144:147], a[128:143]
ds_read_b64_tr_b16 v[212:213], v15 offset:4096
ds_read_b64_tr_b16 v[214:215], v15 offset:6144
ds_read_b64_tr_b16 v[216:217], v16 offset:4096
ds_read_b64_tr_b16 v[218:219], v16 offset:6144
v_mfma_f32_32x32x16_bf16 a[144:159], v[192:195], v[148:151], a[144:159]
s_add_u32 s55, s56, 3072
buffer_load_dwordx4 v24, s[16:19], s55 offen offset:1024 lds
s_waitcnt lgkmcnt(10)
v_mfma_f32_32x32x16_bf16 a[160:175], v[196:199], v[144:147], a[160:175]
ds_read_b64_tr_b16 v[220:221], v17 offset:4096
ds_read_b64_tr_b16 v[222:223], v17 offset:6144
v_mfma_f32_32x32x16_bf16 a[176:191], v[196:199], v[148:151], a[176:191]
s_add_u32 s55, s56, 6144
buffer_load_dwordx4 v24, s[16:19], s55 offen offset:2048 lds
s_waitcnt lgkmcnt(10)
v_mfma_f32_32x32x16_bf16 a[192:207], v[200:203], v[144:147], a[192:207]
v_mfma_f32_32x32x16_bf16 a[208:223], v[200:203], v[148:151], a[208:223]
s_add_u32 s55, s56, 9216
buffer_load_dwordx4 v24, s[16:19], s55 offen offset:3072 lds
s_waitcnt lgkmcnt(8)
v_mfma_f32_32x32x16_bf16 a[224:239], v[204:207], v[144:147], a[224:239]
s_add_u32 s61, s65, s69
s_and_b32 s61, s61, 15
s_lshr_b32 s60, s61, 2
s_mul_i32 s60, s60, 40960
s_and_b32 s61, s61, 3
s_lshl_b32 s61, s61, 12
s_add_u32 s60, s60, s61
v_add_u32 v27, s60, v26
s_add_u32 s65, s65, 1
ds_read_b128 v[224:227], v27 offset:24576
ds_read_b128 v[228:231], v27 offset:25600
ds_read_b128 v[232:235], v27 offset:26624
ds_read_b128 v[236:239], v27 offset:27648
s_waitcnt vmcnt(4)
ds_read_b64_tr_b16 v[160:161], v14 offset:8192
ds_read_b64_tr_b16 v[162:163], v14 offset:10240
v_mfma_f32_32x32x16_bf16 a[240:255], v[204:207], v[148:151], a[240:255]
s_add_u32 m0, s32, 20480
s_add_u32 s55, s56, 16384
buffer_load_dwordx4 v24, s[16:19], s55 offen offset:0 lds
s_waitcnt lgkmcnt(12)
v_mfma_f32_32x32x16_bf16 a[128:143], v[208:211], v[152:155], a[128:143]
ds_read_b64_tr_b16 v[164:165], v15 offset:8192
ds_read_b64_tr_b16 v[166:167], v15 offset:10240
v_mfma_f32_32x32x16_bf16 a[144:159], v[208:211], v[156:159], a[144:159]
s_add_u32 s55, s56, 19456
buffer_load_dwordx4 v24, s[16:19], s55 offen offset:1024 lds
s_waitcnt lgkmcnt(12)
v_mfma_f32_32x32x16_bf16 a[160:175], v[212:215], v[152:155], a[160:175]
ds_read_b64_tr_b16 v[168:169], v16 offset:8192
ds_read_b64_tr_b16 v[170:171], v16 offset:10240
v_mfma_f32_32x32x16_bf16 a[176:191], v[212:215], v[156:159], a[176:191]
s_add_u32 s55, s56, 22528
buffer_load_dwordx4 v24, s[16:19], s55 offen offset:2048 lds
s_waitcnt lgkmcnt(12)
v_mfma_f32_32x32x16_bf16 a[192:207], v[216:219], v[152:155], a[192:207]
ds_read_b64_tr_b16 v[172:173], v17 offset:8192
ds_read_b64_tr_b16 v[174:175], v17 offset:10240
v_mfma_f32_32x32x16_bf16 a[208:223], v[216:219], v[156:159], a[208:223]
s_add_u32 s55, s56, 25600
buffer_load_dwordx4 v24, s[16:19], s55 offen offset:3072 lds
s_waitcnt lgkmcnt(12)
v_mfma_f32_32x32x16_bf16 a[224:239], v[220:223], v[152:155], a[224:239]
ds_read_b64_tr_b16 v[176:177], v14 offset:12288
ds_read_b64_tr_b16 v[178:179], v14 offset:14336
v_mfma_f32_32x32x16_bf16 a[240:255], v[220:223], v[156:159], a[240:255]
s_add_u32 s57, s64, s69
s_and_b32 s57, s57, 15
s_lshr_b32 s56, s57, 2
s_lshl_b32 s56, s56, 18
s_and_b32 s57, s57, 3
s_lshl_b32 s57, s57, 15
s_add_u32 s56, s56, s57
s_add_u32 s56, s56, s66
s_add_u32 s64, s64, 1
s_add_u32 m0, s32, 0
s_add_u32 s55, s56, 0
buffer_load_dwordx4 v24, s[16:19], s55 offen offset:0 lds
s_waitcnt lgkmcnt(8)
v_mfma_f32_32x32x16_bf16 a[128:143], v[160:163], v[224:227], a[128:143]
ds_read_b64_tr_b16 v[180:181], v15 offset:12288
ds_read_b64_tr_b16 v[182:183], v15 offset:14336
ds_read_b64_tr_b16 v[184:185], v16 offset:12288
ds_read_b64_tr_b16 v[186:187], v16 offset:14336
v_mfma_f32_32x32x16_bf16 a[144:159], v[160:163], v[228:231], a[144:159]
s_add_u32 s55, s56, 3072
buffer_load_dwordx4 v24, s[16:19], s55 offen offset:1024 lds
s_waitcnt lgkmcnt(10)
v_mfma_f32_32x32x16_bf16 a[160:175], v[164:167], v[224:227], a[160:175]
ds_read_b64_tr_b16 v[188:189], v17 offset:12288
ds_read_b64_tr_b16 v[190:191], v17 offset:14336
v_mfma_f32_32x32x16_bf16 a[176:191], v[164:167], v[228:231], a[176:191]
s_add_u32 s55, s56, 6144
buffer_load_dwordx4 v24, s[16:19], s55 offen offset:2048 lds
s_waitcnt lgkmcnt(10)
v_mfma_f32_32x32x16_bf16 a[192:207], v[168:171], v[224:227], a[192:207]
v_mfma_f32_32x32x16_bf16 a[208:223], v[168:171], v[228:231], a[208:223]
s_add_u32 s55, s56, 9216
buffer_load_dwordx4 v24, s[16:19], s55 offen offset:3072 lds
s_waitcnt lgkmcnt(8)
v_mfma_f32_32x32x16_bf16 a[224:239], v[172:175], v[224:227], a[224:239]
s_add_u32 s61, s65, s69
s_and_b32 s61, s61, 15
s_lshr_b32 s60, s61, 2
s_mul_i32 s60, s60, 40960
s_and_b32 s61, s61, 3
s_lshl_b32 s61, s61, 12
s_add_u32 s60, s60, s61
v_add_u32 v27, s60, v26
s_add_u32 s65, s65, 1
ds_read_b128 v[144:147], v27 offset:24576
ds_read_b128 v[148:151], v27 offset:25600
ds_read_b128 v[152:155], v27 offset:26624
ds_read_b128 v[156:159], v27 offset:27648
s_waitcnt vmcnt(4)
ds_read_b64_tr_b16 v[192:193], v14 offset:16384
ds_read_b64_tr_b16 v[194:195], v14 offset:18432
v_mfma_f32_32x32x16_bf16 a[240:255], v[172:175], v[228:231], a[240:255]
s_add_u32 m0, s32, 4096
s_add_u32 s55, s56, 16384
buffer_load_dwordx4 v24, s[16:19], s55 offen offset:0 lds
s_waitcnt lgkmcnt(12)
v_mfma_f32_32x32x16_bf16 a[128:143], v[176:179], v[232:235], a[128:143]
ds_read_b64_tr_b16 v[196:197], v15 offset:16384
ds_read_b64_tr_b16 v[198:199], v15 offset:18432
v_mfma_f32_32x32x16_bf16 a[144:159], v[176:179], v[236:239], a[144:159]
s_add_u32 s55, s56, 19456
buffer_load_dwordx4 v24, s[16:19], s55 offen offset:1024 lds
s_waitcnt lgkmcnt(12)
v_mfma_f32_32x32x16_bf16 a[160:175], v[180:183], v[232:235], a[160:175]
ds_read_b64_tr_b16 v[200:201], v16 offset:16384
ds_read_b64_tr_b16 v[202:203], v16 offset:18432
v_mfma_f32_32x32x16_bf16 a[176:191], v[180:183], v[236:239], a[176:191]
s_add_u32 s55, s56, 22528
buffer_load_dwordx4 v24, s[16:19], s55 offen offset:2048 lds
s_waitcnt lgkmcnt(12)
v_mfma_f32_32x32x16_bf16 a[192:207], v[184:187], v[232:235], a[192:207]
ds_read_b64_tr_b16 v[204:205], v17 offset:16384
ds_read_b64_tr_b16 v[206:207], v17 offset:18432
v_mfma_f32_32x32x16_bf16 a[208:223], v[184:187], v[236:239], a[208:223]
s_add_u32 s55, s56, 25600
buffer_load_dwordx4 v24, s[16:19], s55 offen offset:3072 lds
s_waitcnt lgkmcnt(12)
v_mfma_f32_32x32x16_bf16 a[224:239], v[188:191], v[232:235], a[224:239]
ds_read_b64_tr_b16 v[208:209], v14 offset:20480
ds_read_b64_tr_b16 v[210:211], v14 offset:22528
v_mfma_f32_32x32x16_bf16 a[240:255], v[188:191], v[236:239], a[240:255]
s_add_u32 s57, s64, s69
s_and_b32 s57, s57, 15
s_lshr_b32 s56, s57, 2
s_lshl_b32 s56, s56, 18
s_and_b32 s57, s57, 3
s_lshl_b32 s57, s57, 15
s_add_u32 s56, s56, s57
s_add_u32 s56, s56, s66
s_add_u32 s64, s64, 1
s_add_u32 m0, s32, 8192
s_add_u32 s55, s56, 0
buffer_load_dwordx4 v24, s[16:19], s55 offen offset:0 lds
s_waitcnt lgkmcnt(8)
v_mfma_f32_32x32x16_bf16 a[128:143], v[192:195], v[144:147], a[128:143]
ds_read_b64_tr_b16 v[212:213], v15 offset:20480
ds_read_b64_tr_b16 v[214:215], v15 offset:22528
ds_read_b64_tr_b16 v[216:217], v16 offset:20480
ds_read_b64_tr_b16 v[218:219], v16 offset:22528
v_mfma_f32_32x32x16_bf16 a[144:159], v[192:195], v[148:151], a[144:159]
s_add_u32 s55, s56, 3072
buffer_load_dwordx4 v24, s[16:19], s55 offen offset:1024 lds
s_waitcnt lgkmcnt(10)
v_mfma_f32_32x32x16_bf16 a[160:175], v[196:199], v[144:147], a[160:175]
ds_read_b64_tr_b16 v[220:221], v17 offset:20480
ds_read_b64_tr_b16 v[222:223], v17 offset:22528
v_mfma_f32_32x32x16_bf16 a[176:191], v[196:199], v[148:151], a[176:191]
s_add_u32 s55, s56, 6144
buffer_load_dwordx4 v24, s[16:19], s55 offen offset:2048 lds
s_waitcnt lgkmcnt(10)
v_mfma_f32_32x32x16_bf16 a[192:207], v[200:203], v[144:147], a[192:207]
v_mfma_f32_32x32x16_bf16 a[208:223], v[200:203], v[148:151], a[208:223]
s_add_u32 s55, s56, 9216
buffer_load_dwordx4 v24, s[16:19], s55 offen offset:3072 lds
s_waitcnt lgkmcnt(8)
v_mfma_f32_32x32x16_bf16 a[224:239], v[204:207], v[144:147], a[224:239]
s_add_u32 s61, s65, s69
s_and_b32 s61, s61, 15
s_lshr_b32 s60, s61, 2
s_mul_i32 s60, s60, 40960
s_and_b32 s61, s61, 3
s_lshl_b32 s61, s61, 12
s_add_u32 s60, s60, s61
v_add_u32 v27, s60, v26
s_add_u32 s65, s65, 1
ds_read_b128 v[224:227], v27 offset:24576
ds_read_b128 v[228:231], v27 offset:25600
ds_read_b128 v[232:235], v27 offset:26624
ds_read_b128 v[236:239], v27 offset:27648
s_waitcnt vmcnt(4)
ds_read_b64_tr_b16 v[160:161], v14 offset:0
ds_read_b64_tr_b16 v[162:163], v14 offset:2048
v_mfma_f32_32x32x16_bf16 a[240:255], v[204:207], v[148:151], a[240:255]
s_add_u32 m0, s32, 12288
s_add_u32 s55, s56, 16384
buffer_load_dwordx4 v24, s[16:19], s55 offen offset:0 lds
s_waitcnt lgkmcnt(12)
v_mfma_f32_32x32x16_bf16 a[128:143], v[208:211], v[152:155], a[128:143]
ds_read_b64_tr_b16 v[164:165], v15 offset:0
ds_read_b64_tr_b16 v[166:167], v15 offset:2048
v_mfma_f32_32x32x16_bf16 a[144:159], v[208:211], v[156:159], a[144:159]
s_add_u32 s55, s56, 19456
buffer_load_dwordx4 v24, s[16:19], s55 offen offset:1024 lds
s_waitcnt lgkmcnt(12)
v_mfma_f32_32x32x16_bf16 a[160:175], v[212:215], v[152:155], a[160:175]
ds_read_b64_tr_b16 v[168:169], v16 offset:0
ds_read_b64_tr_b16 v[170:171], v16 offset:2048
v_mfma_f32_32x32x16_bf16 a[176:191], v[212:215], v[156:159], a[176:191]
s_add_u32 s55, s56, 22528
buffer_load_dwordx4 v24, s[16:19], s55 offen offset:2048 lds
s_waitcnt lgkmcnt(12)
v_mfma_f32_32x32x16_bf16 a[192:207], v[216:219], v[152:155], a[192:207]
ds_read_b64_tr_b16 v[172:173], v17 offset:0
ds_read_b64_tr_b16 v[174:175], v17 offset:2048
v_mfma_f32_32x32x16_bf16 a[208:223], v[216:219], v[156:159], a[208:223]
s_add_u32 s55, s56, 25600
buffer_load_dwordx4 v24, s[16:19], s55 offen offset:3072 lds
s_waitcnt lgkmcnt(12)
v_mfma_f32_32x32x16_bf16 a[224:239], v[220:223], v[152:155], a[224:239]
ds_read_b64_tr_b16 v[176:177], v14 offset:4096
ds_read_b64_tr_b16 v[178:179], v14 offset:6144
v_mfma_f32_32x32x16_bf16 a[240:255], v[220:223], v[156:159], a[240:255]
s_add_u32 s57, s64, s69
s_and_b32 s57, s57, 15
s_lshr_b32 s56, s57, 2
s_lshl_b32 s56, s56, 18
s_and_b32 s57, s57, 3
s_lshl_b32 s57, s57, 15
s_add_u32 s56, s56, s57
s_add_u32 s56, s56, s66
s_add_u32 s64, s64, 1
s_add_u32 m0, s32, 16384
s_add_u32 s55, s56, 0
buffer_load_dwordx4 v24, s[16:19], s55 offen offset:0 lds
s_waitcnt lgkmcnt(8)
v_mfma_f32_32x32x16_bf16 a[128:143], v[160:163], v[224:227], a[128:143]
ds_read_b64_tr_b16 v[180:181], v15 offset:4096
ds_read_b64_tr_b16 v[182:183], v15 offset:6144
ds_read_b64_tr_b16 v[184:185], v16 offset:4096
ds_read_b64_tr_b16 v[186:187], v16 offset:6144
v_mfma_f32_32x32x16_bf16 a[144:159], v[160:163], v[228:231], a[144:159]
s_add_u32 s55, s56, 3072
buffer_load_dwordx4 v24, s[16:19], s55 offen offset:1024 lds
s_waitcnt lgkmcnt(10)
v_mfma_f32_32x32x16_bf16 a[160:175], v[164:167], v[224:227], a[160:175]
ds_read_b64_tr_b16 v[188:189], v17 offset:4096
ds_read_b64_tr_b16 v[190:191], v17 offset:6144
v_mfma_f32_32x32x16_bf16 a[176:191], v[164:167], v[228:231], a[176:191]
s_add_u32 s55, s56, 6144
buffer_load_dwordx4 v24, s[16:19], s55 offen offset:2048 lds
s_waitcnt lgkmcnt(10)
v_mfma_f32_32x32x16_bf16 a[192:207], v[168:171], v[224:227], a[192:207]
v_mfma_f32_32x32x16_bf16 a[208:223], v[168:171], v[228:231], a[208:223]
s_add_u32 s55, s56, 9216
buffer_load_dwordx4 v24, s[16:19], s55 offen offset:3072 lds
s_waitcnt lgkmcnt(8)
v_mfma_f32_32x32x16_bf16 a[224:239], v[172:175], v[224:227], a[224:239]
s_add_u32 s61, s65, s69
s_and_b32 s61, s61, 15
s_lshr_b32 s60, s61, 2
s_mul_i32 s60, s60, 40960
s_and_b32 s61, s61, 3
s_lshl_b32 s61, s61, 12
s_add_u32 s60, s60, s61
v_add_u32 v27, s60, v26
s_add_u32 s65, s65, 1
ds_read_b128 v[144:147], v27 offset:24576
ds_read_b128 v[148:151], v27 offset:25600
ds_read_b128 v[152:155], v27 offset:26624
ds_read_b128 v[156:159], v27 offset:27648
s_waitcnt vmcnt(4)
ds_read_b64_tr_b16 v[192:193], v14 offset:8192
ds_read_b64_tr_b16 v[194:195], v14 offset:10240
v_mfma_f32_32x32x16_bf16 a[240:255], v[172:175], v[228:231], a[240:255]
s_add_u32 m0, s32, 20480
s_add_u32 s55, s56, 16384
buffer_load_dwordx4 v24, s[16:19], s55 offen offset:0 lds
s_waitcnt lgkmcnt(12)
v_mfma_f32_32x32x16_bf16 a[128:143], v[176:179], v[232:235], a[128:143]
ds_read_b64_tr_b16 v[196:197], v15 offset:8192
ds_read_b64_tr_b16 v[198:199], v15 offset:10240
v_mfma_f32_32x32x16_bf16 a[144:159], v[176:179], v[236:239], a[144:159]
s_add_u32 s55, s56, 19456
buffer_load_dwordx4 v24, s[16:19], s55 offen offset:1024 lds
s_waitcnt lgkmcnt(12)
v_mfma_f32_32x32x16_bf16 a[160:175], v[180:183], v[232:235], a[160:175]
ds_read_b64_tr_b16 v[200:201], v16 offset:8192
ds_read_b64_tr_b16 v[202:203], v16 offset:10240
v_mfma_f32_32x32x16_bf16 a[176:191], v[180:183], v[236:239], a[176:191]
s_add_u32 s55, s56, 22528
buffer_load_dwordx4 v24, s[16:19], s55 offen offset:2048 lds
s_waitcnt lgkmcnt(12)
v_mfma_f32_32x32x16_bf16 a[192:207], v[184:187], v[232:235], a[192:207]
ds_read_b64_tr_b16 v[204:205], v17 offset:8192
ds_read_b64_tr_b16 v[206:207], v17 offset:10240
v_mfma_f32_32x32x16_bf16 a[208:223], v[184:187], v[236:239], a[208:223]
s_add_u32 s55, s56, 25600
buffer_load_dwordx4 v24, s[16:19], s55 offen offset:3072 lds
s_waitcnt lgkmcnt(12)
v_mfma_f32_32x32x16_bf16 a[224:239], v[188:191], v[232:235], a[224:239]
ds_read_b64_tr_b16 v[208:209], v14 offset:12288
ds_read_b64_tr_b16 v[210:211], v14 offset:14336
v_mfma_f32_32x32x16_bf16 a[240:255], v[188:191], v[236:239], a[240:255]
s_add_u32 s57, s64, s69
s_and_b32 s57, s57, 15
s_lshr_b32 s56, s57, 2
s_lshl_b32 s56, s56, 18
s_and_b32 s57, s57, 3
s_lshl_b32 s57, s57, 15
s_add_u32 s56, s56, s57
s_add_u32 s56, s56, s66
s_add_u32 s64, s64, 1
s_add_u32 m0, s32, 0
s_add_u32 s55, s56, 0
buffer_load_dwordx4 v24, s[16:19], s55 offen offset:0 lds
s_waitcnt lgkmcnt(8)
v_mfma_f32_32x32x16_bf16 a[128:143], v[192:195], v[144:147], a[128:143]
ds_read_b64_tr_b16 v[212:213], v15 offset:12288
ds_read_b64_tr_b16 v[214:215], v15 offset:14336
ds_read_b64_tr_b16 v[216:217], v16 offset:12288
ds_read_b64_tr_b16 v[218:219], v16 offset:14336
v_mfma_f32_32x32x16_bf16 a[144:159], v[192:195], v[148:151], a[144:159]
s_add_u32 s55, s56, 3072
buffer_load_dwordx4 v24, s[16:19], s55 offen offset:1024 lds
s_waitcnt lgkmcnt(10)
v_mfma_f32_32x32x16_bf16 a[160:175], v[196:199], v[144:147], a[160:175]
ds_read_b64_tr_b16 v[220:221], v17 offset:12288
ds_read_b64_tr_b16 v[222:223], v17 offset:14336
v_mfma_f32_32x32x16_bf16 a[176:191], v[196:199], v[148:151], a[176:191]
s_add_u32 s55, s56, 6144
buffer_load_dwordx4 v24, s[16:19], s55 offen offset:2048 lds
s_waitcnt lgkmcnt(10)
v_mfma_f32_32x32x16_bf16 a[192:207], v[200:203], v[144:147], a[192:207]
v_mfma_f32_32x32x16_bf16 a[208:223], v[200:203], v[148:151], a[208:223]
s_add_u32 s55, s56, 9216
buffer_load_dwordx4 v24, s[16:19], s55 offen offset:3072 lds
s_waitcnt lgkmcnt(8)
v_mfma_f32_32x32x16_bf16 a[224:239], v[204:207], v[144:147], a[224:239]
s_add_u32 s61, s65, s69
s_and_b32 s61, s61, 15
s_lshr_b32 s60, s61, 2
s_mul_i32 s60, s60, 40960
s_and_b32 s61, s61, 3
s_lshl_b32 s61, s61, 12
s_add_u32 s60, s60, s61
v_add_u32 v27, s60, v26
s_add_u32 s65, s65, 1
ds_read_b128 v[224:227], v27 offset:24576
ds_read_b128 v[228:231], v27 offset:25600
ds_read_b128 v[232:235], v27 offset:26624
ds_read_b128 v[236:239], v27 offset:27648
s_waitcnt vmcnt(4)
ds_read_b64_tr_b16 v[160:161], v14 offset:16384
ds_read_b64_tr_b16 v[162:163], v14 offset:18432
v_mfma_f32_32x32x16_bf16 a[240:255], v[204:207], v[148:151], a[240:255]
s_add_u32 m0, s32, 4096
s_add_u32 s55, s56, 16384
buffer_load_dwordx4 v24, s[16:19], s55 offen offset:0 lds
s_waitcnt lgkmcnt(12)
v_mfma_f32_32x32x16_bf16 a[128:143], v[208:211], v[152:155], a[128:143]
ds_read_b64_tr_b16 v[164:165], v15 offset:16384
ds_read_b64_tr_b16 v[166:167], v15 offset:18432
v_mfma_f32_32x32x16_bf16 a[144:159], v[208:211], v[156:159], a[144:159]
s_add_u32 s55, s56, 19456
buffer_load_dwordx4 v24, s[16:19], s55 offen offset:1024 lds
s_waitcnt lgkmcnt(12)
v_mfma_f32_32x32x16_bf16 a[160:175], v[212:215], v[152:155], a[160:175]
ds_read_b64_tr_b16 v[168:169], v16 offset:16384
ds_read_b64_tr_b16 v[170:171], v16 offset:18432
v_mfma_f32_32x32x16_bf16 a[176:191], v[212:215], v[156:159], a[176:191]
s_add_u32 s55, s56, 22528
buffer_load_dwordx4 v24, s[16:19], s55 offen offset:2048 lds
s_waitcnt lgkmcnt(12)
v_mfma_f32_32x32x16_bf16 a[192:207], v[216:219], v[152:155], a[192:207]
ds_read_b64_tr_b16 v[172:173], v17 offset:16384
ds_read_b64_tr_b16 v[174:175], v17 offset:18432
v_mfma_f32_32x32x16_bf16 a[208:223], v[216:219], v[156:159], a[208:223]
s_add_u32 s55, s56, 25600
buffer_load_dwordx4 v24, s[16:19], s55 offen offset:3072 lds
s_waitcnt lgkmcnt(12)
v_mfma_f32_32x32x16_bf16 a[224:239], v[220:223], v[152:155], a[224:239]
ds_read_b64_tr_b16 v[176:177], v14 offset:20480
ds_read_b64_tr_b16 v[178:179], v14 offset:22528
v_mfma_f32_32x32x16_bf16 a[240:255], v[220:223], v[156:159], a[240:255]
s_add_u32 s57, s64, s69
s_and_b32 s57, s57, 15
s_lshr_b32 s56, s57, 2
s_lshl_b32 s56, s56, 18
s_and_b32 s57, s57, 3
s_lshl_b32 s57, s57, 15
s_add_u32 s56, s56, s57
s_add_u32 s56, s56, s66
s_add_u32 s64, s64, 1
s_add_u32 m0, s32, 8192
s_add_u32 s55, s56, 0
buffer_load_dwordx4 v24, s[16:19], s55 offen offset:0 lds
s_waitcnt lgkmcnt(8)
v_mfma_f32_32x32x16_bf16 a[128:143], v[160:163], v[224:227], a[128:143]
ds_read_b64_tr_b16 v[180:181], v15 offset:20480
ds_read_b64_tr_b16 v[182:183], v15 offset:22528
ds_read_b64_tr_b16 v[184:185], v16 offset:20480
ds_read_b64_tr_b16 v[186:187], v16 offset:22528
v_mfma_f32_32x32x16_bf16 a[144:159], v[160:163], v[228:231], a[144:159]
s_add_u32 s55, s56, 3072
buffer_load_dwordx4 v24, s[16:19], s55 offen offset:1024 lds
s_waitcnt lgkmcnt(10)
v_mfma_f32_32x32x16_bf16 a[160:175], v[164:167], v[224:227], a[160:175]
ds_read_b64_tr_b16 v[188:189], v17 offset:20480
ds_read_b64_tr_b16 v[190:191], v17 offset:22528
v_mfma_f32_32x32x16_bf16 a[176:191], v[164:167], v[228:231], a[176:191]
s_add_u32 s55, s56, 6144
buffer_load_dwordx4 v24, s[16:19], s55 offen offset:2048 lds
s_waitcnt lgkmcnt(10)
v_mfma_f32_32x32x16_bf16 a[192:207], v[168:171], v[224:227], a[192:207]
v_mfma_f32_32x32x16_bf16 a[208:223], v[168:171], v[228:231], a[208:223]
s_add_u32 s55, s56, 9216
buffer_load_dwordx4 v24, s[16:19], s55 offen offset:3072 lds
s_waitcnt lgkmcnt(8)
v_mfma_f32_32x32x16_bf16 a[224:239], v[172:175], v[224:227], a[224:239]
s_add_u32 s61, s65, s69
s_and_b32 s61, s61, 15
s_lshr_b32 s60, s61, 2
s_mul_i32 s60, s60, 40960
s_and_b32 s61, s61, 3
s_lshl_b32 s61, s61, 12
s_add_u32 s60, s60, s61
v_add_u32 v27, s60, v26
s_add_u32 s65, s65, 1
ds_read_b128 v[144:147], v27 offset:24576
ds_read_b128 v[148:151], v27 offset:25600
ds_read_b128 v[152:155], v27 offset:26624
ds_read_b128 v[156:159], v27 offset:27648
s_waitcnt vmcnt(4)
ds_read_b64_tr_b16 v[192:193], v14 offset:0
ds_read_b64_tr_b16 v[194:195], v14 offset:2048
v_mfma_f32_32x32x16_bf16 a[240:255], v[172:175], v[228:231], a[240:255]
s_add_u32 m0, s32, 12288
s_add_u32 s55, s56, 16384
buffer_load_dwordx4 v24, s[16:19], s55 offen offset:0 lds
s_waitcnt lgkmcnt(12)
v_mfma_f32_32x32x16_bf16 a[128:143], v[176:179], v[232:235], a[128:143]
ds_read_b64_tr_b16 v[196:197], v15 offset:0
ds_read_b64_tr_b16 v[198:199], v15 offset:2048
v_mfma_f32_32x32x16_bf16 a[144:159], v[176:179], v[236:239], a[144:159]
s_add_u32 s55, s56, 19456
buffer_load_dwordx4 v24, s[16:19], s55 offen offset:1024 lds
s_waitcnt lgkmcnt(12)
v_mfma_f32_32x32x16_bf16 a[160:175], v[180:183], v[232:235], a[160:175]
ds_read_b64_tr_b16 v[200:201], v16 offset:0
ds_read_b64_tr_b16 v[202:203], v16 offset:2048
v_mfma_f32_32x32x16_bf16 a[176:191], v[180:183], v[236:239], a[176:191]
s_add_u32 s55, s56, 22528
buffer_load_dwordx4 v24, s[16:19], s55 offen offset:2048 lds
s_waitcnt lgkmcnt(12)
v_mfma_f32_32x32x16_bf16 a[192:207], v[184:187], v[232:235], a[192:207]
ds_read_b64_tr_b16 v[204:205], v17 offset:0
ds_read_b64_tr_b16 v[206:207], v17 offset:2048
v_mfma_f32_32x32x16_bf16 a[208:223], v[184:187], v[236:239], a[208:223]
s_add_u32 s55, s56, 25600
buffer_load_dwordx4 v24, s[16:19], s55 offen offset:3072 lds
s_waitcnt lgkmcnt(12)
v_mfma_f32_32x32x16_bf16 a[224:239], v[188:191], v[232:235], a[224:239]
ds_read_b64_tr_b16 v[208:209], v14 offset:4096
ds_read_b64_tr_b16 v[210:211], v14 offset:6144
v_mfma_f32_32x32x16_bf16 a[240:255], v[188:191], v[236:239], a[240:255]
s_add_u32 s57, s64, s69
s_and_b32 s57, s57, 15
s_lshr_b32 s56, s57, 2
s_lshl_b32 s56, s56, 18
s_and_b32 s57, s57, 3
s_lshl_b32 s57, s57, 15
s_add_u32 s56, s56, s57
s_add_u32 s56, s56, s66
s_add_u32 s64, s64, 1
s_add_u32 m0, s32, 16384
s_add_u32 s55, s56, 0
buffer_load_dwordx4 v24, s[16:19], s55 offen offset:0 lds
s_waitcnt lgkmcnt(8)
v_mfma_f32_32x32x16_bf16 a[128:143], v[192:195], v[144:147], a[128:143]
ds_read_b64_tr_b16 v[212:213], v15 offset:4096
ds_read_b64_tr_b16 v[214:215], v15 offset:6144
ds_read_b64_tr_b16 v[216:217], v16 offset:4096
ds_read_b64_tr_b16 v[218:219], v16 offset:6144
v_mfma_f32_32x32x16_bf16 a[144:159], v[192:195], v[148:151], a[144:159]
s_add_u32 s55, s56, 3072
buffer_load_dwordx4 v24, s[16:19], s55 offen offset:1024 lds
s_waitcnt lgkmcnt(10)
v_mfma_f32_32x32x16_bf16 a[160:175], v[196:199], v[144:147], a[160:175]
ds_read_b64_tr_b16 v[220:221], v17 offset:4096
ds_read_b64_tr_b16 v[222:223], v17 offset:6144
v_mfma_f32_32x32x16_bf16 a[176:191], v[196:199], v[148:151], a[176:191]
s_add_u32 s55, s56, 6144
buffer_load_dwordx4 v24, s[16:19], s55 offen offset:2048 lds
s_waitcnt lgkmcnt(10)
v_mfma_f32_32x32x16_bf16 a[192:207], v[200:203], v[144:147], a[192:207]
v_mfma_f32_32x32x16_bf16 a[208:223], v[200:203], v[148:151], a[208:223]
s_add_u32 s55, s56, 9216
buffer_load_dwordx4 v24, s[16:19], s55 offen offset:3072 lds
s_waitcnt lgkmcnt(8)
v_mfma_f32_32x32x16_bf16 a[224:239], v[204:207], v[144:147], a[224:239]
s_add_u32 s61, s65, s69
s_and_b32 s61, s61, 15
s_lshr_b32 s60, s61, 2
s_mul_i32 s60, s60, 40960
s_and_b32 s61, s61, 3
s_lshl_b32 s61, s61, 12
s_add_u32 s60, s60, s61
v_add_u32 v27, s60, v26
s_add_u32 s65, s65, 1
ds_read_b128 v[224:227], v27 offset:24576
ds_read_b128 v[228:231], v27 offset:25600
ds_read_b128 v[232:235], v27 offset:26624
ds_read_b128 v[236:239], v27 offset:27648
s_waitcnt vmcnt(4)
ds_read_b64_tr_b16 v[160:161], v14 offset:8192
ds_read_b64_tr_b16 v[162:163], v14 offset:10240
v_mfma_f32_32x32x16_bf16 a[240:255], v[204:207], v[148:151], a[240:255]
s_add_u32 m0, s32, 20480
s_add_u32 s55, s56, 16384
buffer_load_dwordx4 v24, s[16:19], s55 offen offset:0 lds
s_waitcnt lgkmcnt(12)
v_mfma_f32_32x32x16_bf16 a[128:143], v[208:211], v[152:155], a[128:143]
ds_read_b64_tr_b16 v[164:165], v15 offset:8192
ds_read_b64_tr_b16 v[166:167], v15 offset:10240
v_mfma_f32_32x32x16_bf16 a[144:159], v[208:211], v[156:159], a[144:159]
s_add_u32 s55, s56, 19456
buffer_load_dwordx4 v24, s[16:19], s55 offen offset:1024 lds
s_waitcnt lgkmcnt(12)
v_mfma_f32_32x32x16_bf16 a[160:175], v[212:215], v[152:155], a[160:175]
ds_read_b64_tr_b16 v[168:169], v16 offset:8192
ds_read_b64_tr_b16 v[170:171], v16 offset:10240
v_mfma_f32_32x32x16_bf16 a[176:191], v[212:215], v[156:159], a[176:191]
s_add_u32 s55, s56, 22528
buffer_load_dwordx4 v24, s[16:19], s55 offen offset:2048 lds
s_waitcnt lgkmcnt(12)
v_mfma_f32_32x32x16_bf16 a[192:207], v[216:219], v[152:155], a[192:207]
ds_read_b64_tr_b16 v[172:173], v17 offset:8192
ds_read_b64_tr_b16 v[174:175], v17 offset:10240
v_mfma_f32_32x32x16_bf16 a[208:223], v[216:219], v[156:159], a[208:223]
s_add_u32 s55, s56, 25600
buffer_load_dwordx4 v24, s[16:19], s55 offen offset:3072 lds
s_waitcnt lgkmcnt(12)
v_mfma_f32_32x32x16_bf16 a[224:239], v[220:223], v[152:155], a[224:239]
ds_read_b64_tr_b16 v[176:177], v14 offset:12288
ds_read_b64_tr_b16 v[178:179], v14 offset:14336
v_mfma_f32_32x32x16_bf16 a[240:255], v[220:223], v[156:159], a[240:255]
s_add_u32 s57, s64, s69
s_and_b32 s57, s57, 15
s_lshr_b32 s56, s57, 2
s_lshl_b32 s56, s56, 18
s_and_b32 s57, s57, 3
s_lshl_b32 s57, s57, 15
s_add_u32 s56, s56, s57
s_add_u32 s56, s56, s66
s_add_u32 s64, s64, 1
s_add_u32 m0, s32, 0
s_add_u32 s55, s56, 0
buffer_load_dwordx4 v24, s[16:19], s55 offen offset:0 lds
s_waitcnt lgkmcnt(8)
v_mfma_f32_32x32x16_bf16 a[128:143], v[160:163], v[224:227], a[128:143]
ds_read_b64_tr_b16 v[180:181], v15 offset:12288
ds_read_b64_tr_b16 v[182:183], v15 offset:14336
ds_read_b64_tr_b16 v[184:185], v16 offset:12288
ds_read_b64_tr_b16 v[186:187], v16 offset:14336
v_mfma_f32_32x32x16_bf16 a[144:159], v[160:163], v[228:231], a[144:159]
s_add_u32 s55, s56, 3072
buffer_load_dwordx4 v24, s[16:19], s55 offen offset:1024 lds
s_waitcnt lgkmcnt(10)
v_mfma_f32_32x32x16_bf16 a[160:175], v[164:167], v[224:227], a[160:175]
ds_read_b64_tr_b16 v[188:189], v17 offset:12288
ds_read_b64_tr_b16 v[190:191], v17 offset:14336
v_mfma_f32_32x32x16_bf16 a[176:191], v[164:167], v[228:231], a[176:191]
s_add_u32 s55, s56, 6144
buffer_load_dwordx4 v24, s[16:19], s55 offen offset:2048 lds
s_waitcnt lgkmcnt(10)
v_mfma_f32_32x32x16_bf16 a[192:207], v[168:171], v[224:227], a[192:207]
v_mfma_f32_32x32x16_bf16 a[208:223], v[168:171], v[228:231], a[208:223]
s_add_u32 s55, s56, 9216
buffer_load_dwordx4 v24, s[16:19], s55 offen offset:3072 lds
s_waitcnt lgkmcnt(8)
v_mfma_f32_32x32x16_bf16 a[224:239], v[172:175], v[224:227], a[224:239]
s_add_u32 s61, s65, s69
s_and_b32 s61, s61, 15
s_lshr_b32 s60, s61, 2
s_mul_i32 s60, s60, 40960
s_and_b32 s61, s61, 3
s_lshl_b32 s61, s61, 12
s_add_u32 s60, s60, s61
v_add_u32 v27, s60, v26
s_add_u32 s65, s65, 1
ds_read_b128 v[144:147], v27 offset:24576
ds_read_b128 v[148:151], v27 offset:25600
ds_read_b128 v[152:155], v27 offset:26624
ds_read_b128 v[156:159], v27 offset:27648
s_waitcnt vmcnt(4)
ds_read_b64_tr_b16 v[192:193], v14 offset:16384
ds_read_b64_tr_b16 v[194:195], v14 offset:18432
v_mfma_f32_32x32x16_bf16 a[240:255], v[172:175], v[228:231], a[240:255]
s_add_u32 m0, s32, 4096
s_add_u32 s55, s56, 16384
buffer_load_dwordx4 v24, s[16:19], s55 offen offset:0 lds
s_waitcnt lgkmcnt(12)
v_mfma_f32_32x32x16_bf16 a[128:143], v[176:179], v[232:235], a[128:143]
ds_read_b64_tr_b16 v[196:197], v15 offset:16384
ds_read_b64_tr_b16 v[198:199], v15 offset:18432
v_mfma_f32_32x32x16_bf16 a[144:159], v[176:179], v[236:239], a[144:159]
s_add_u32 s55, s56, 19456
buffer_load_dwordx4 v24, s[16:19], s55 offen offset:1024 lds
s_waitcnt lgkmcnt(12)
v_mfma_f32_32x32x16_bf16 a[160:175], v[180:183], v[232:235], a[160:175]
ds_read_b64_tr_b16 v[200:201], v16 offset:16384
ds_read_b64_tr_b16 v[202:203], v16 offset:18432
v_mfma_f32_32x32x16_bf16 a[176:191], v[180:183], v[236:239], a[176:191]
s_add_u32 s55, s56, 22528
buffer_load_dwordx4 v24, s[16:19], s55 offen offset:2048 lds
s_waitcnt lgkmcnt(12)
v_mfma_f32_32x32x16_bf16 a[192:207], v[184:187], v[232:235], a[192:207]
ds_read_b64_tr_b16 v[204:205], v17 offset:16384
ds_read_b64_tr_b16 v[206:207], v17 offset:18432
v_mfma_f32_32x32x16_bf16 a[208:223], v[184:187], v[236:239], a[208:223]
s_add_u32 s55, s56, 25600
buffer_load_dwordx4 v24, s[16:19], s55 offen offset:3072 lds
s_waitcnt lgkmcnt(12)
v_mfma_f32_32x32x16_bf16 a[224:239], v[188:191], v[232:235], a[224:239]
ds_read_b64_tr_b16 v[208:209], v14 offset:20480
ds_read_b64_tr_b16 v[210:211], v14 offset:22528
v_mfma_f32_32x32x16_bf16 a[240:255], v[188:191], v[236:239], a[240:255]
s_add_u32 s57, s64, s69
s_and_b32 s57, s57, 15
s_lshr_b32 s56, s57, 2
s_lshl_b32 s56, s56, 18
s_and_b32 s57, s57, 3
s_lshl_b32 s57, s57, 15
s_add_u32 s56, s56, s57
s_add_u32 s56, s56, s66
s_add_u32 s64, s64, 1
s_add_u32 m0, s32, 8192
s_add_u32 s55, s56, 0
buffer_load_dwordx4 v24, s[16:19], s55 offen offset:0 lds
s_waitcnt lgkmcnt(8)
v_mfma_f32_32x32x16_bf16 a[128:143], v[192:195], v[144:147], a[128:143]
ds_read_b64_tr_b16 v[212:213], v15 offset:20480
ds_read_b64_tr_b16 v[214:215], v15 offset:22528
ds_read_b64_tr_b16 v[216:217], v16 offset:20480
ds_read_b64_tr_b16 v[218:219], v16 offset:22528
v_mfma_f32_32x32x16_bf16 a[144:159], v[192:195], v[148:151], a[144:159]
s_add_u32 s55, s56, 3072
buffer_load_dwordx4 v24, s[16:19], s55 offen offset:1024 lds
s_waitcnt lgkmcnt(10)
v_mfma_f32_32x32x16_bf16 a[160:175], v[196:199], v[144:147], a[160:175]
ds_read_b64_tr_b16 v[220:221], v17 offset:20480
ds_read_b64_tr_b16 v[222:223], v17 offset:22528
v_mfma_f32_32x32x16_bf16 a[176:191], v[196:199], v[148:151], a[176:191]
s_add_u32 s55, s56, 6144
buffer_load_dwordx4 v24, s[16:19], s55 offen offset:2048 lds
s_waitcnt lgkmcnt(10)
v_mfma_f32_32x32x16_bf16 a[192:207], v[200:203], v[144:147], a[192:207]
v_mfma_f32_32x32x16_bf16 a[208:223], v[200:203], v[148:151], a[208:223]
s_add_u32 s55, s56, 9216
buffer_load_dwordx4 v24, s[16:19], s55 offen offset:3072 lds
s_waitcnt lgkmcnt(8)
v_mfma_f32_32x32x16_bf16 a[224:239], v[204:207], v[144:147], a[224:239]
s_add_u32 s61, s65, s69
s_and_b32 s61, s61, 15
s_lshr_b32 s60, s61, 2
s_mul_i32 s60, s60, 40960
s_and_b32 s61, s61, 3
s_lshl_b32 s61, s61, 12
s_add_u32 s60, s60, s61
v_add_u32 v27, s60, v26
s_add_u32 s65, s65, 1
ds_read_b128 v[224:227], v27 offset:24576
ds_read_b128 v[228:231], v27 offset:25600
ds_read_b128 v[232:235], v27 offset:26624
ds_read_b128 v[236:239], v27 offset:27648
s_waitcnt vmcnt(4)
ds_read_b64_tr_b16 v[160:161], v14 offset:0
ds_read_b64_tr_b16 v[162:163], v14 offset:2048
v_mfma_f32_32x32x16_bf16 a[240:255], v[204:207], v[148:151], a[240:255]
s_add_u32 m0, s32, 12288
s_add_u32 s55, s56, 16384
buffer_load_dwordx4 v24, s[16:19], s55 offen offset:0 lds
s_waitcnt lgkmcnt(12)
v_mfma_f32_32x32x16_bf16 a[128:143], v[208:211], v[152:155], a[128:143]
ds_read_b64_tr_b16 v[164:165], v15 offset:0
ds_read_b64_tr_b16 v[166:167], v15 offset:2048
v_mfma_f32_32x32x16_bf16 a[144:159], v[208:211], v[156:159], a[144:159]
s_add_u32 s55, s56, 19456
buffer_load_dwordx4 v24, s[16:19], s55 offen offset:1024 lds
s_waitcnt lgkmcnt(12)
v_mfma_f32_32x32x16_bf16 a[160:175], v[212:215], v[152:155], a[160:175]
ds_read_b64_tr_b16 v[168:169], v16 offset:0
ds_read_b64_tr_b16 v[170:171], v16 offset:2048
v_mfma_f32_32x32x16_bf16 a[176:191], v[212:215], v[156:159], a[176:191]
s_add_u32 s55, s56, 22528
buffer_load_dwordx4 v24, s[16:19], s55 offen offset:2048 lds
s_waitcnt lgkmcnt(12)
v_mfma_f32_32x32x16_bf16 a[192:207], v[216:219], v[152:155], a[192:207]
ds_read_b64_tr_b16 v[172:173], v17 offset:0
ds_read_b64_tr_b16 v[174:175], v17 offset:2048
v_mfma_f32_32x32x16_bf16 a[208:223], v[216:219], v[156:159], a[208:223]
s_add_u32 s55, s56, 25600
buffer_load_dwordx4 v24, s[16:19], s55 offen offset:3072 lds
s_waitcnt lgkmcnt(12)
v_mfma_f32_32x32x16_bf16 a[224:239], v[220:223], v[152:155], a[224:239]
ds_read_b64_tr_b16 v[176:177], v14 offset:4096
ds_read_b64_tr_b16 v[178:179], v14 offset:6144
v_mfma_f32_32x32x16_bf16 a[240:255], v[220:223], v[156:159], a[240:255]
s_add_u32 s57, s64, s69
s_and_b32 s57, s57, 15
s_lshr_b32 s56, s57, 2
s_lshl_b32 s56, s56, 18
s_and_b32 s57, s57, 3
s_lshl_b32 s57, s57, 15
s_add_u32 s56, s56, s57
s_add_u32 s56, s56, s66
s_add_u32 s64, s64, 1
s_add_u32 m0, s32, 16384
s_add_u32 s55, s56, 0
buffer_load_dwordx4 v24, s[16:19], s55 offen offset:0 lds
s_waitcnt lgkmcnt(8)
v_mfma_f32_32x32x16_bf16 a[128:143], v[160:163], v[224:227], a[128:143]
ds_read_b64_tr_b16 v[180:181], v15 offset:4096
ds_read_b64_tr_b16 v[182:183], v15 offset:6144
ds_read_b64_tr_b16 v[184:185], v16 offset:4096
ds_read_b64_tr_b16 v[186:187], v16 offset:6144
v_mfma_f32_32x32x16_bf16 a[144:159], v[160:163], v[228:231], a[144:159]
s_add_u32 s55, s56, 3072
buffer_load_dwordx4 v24, s[16:19], s55 offen offset:1024 lds
s_waitcnt lgkmcnt(10)
v_mfma_f32_32x32x16_bf16 a[160:175], v[164:167], v[224:227], a[160:175]
ds_read_b64_tr_b16 v[188:189], v17 offset:4096
ds_read_b64_tr_b16 v[190:191], v17 offset:6144
v_mfma_f32_32x32x16_bf16 a[176:191], v[164:167], v[228:231], a[176:191]
s_add_u32 s55, s56, 6144
buffer_load_dwordx4 v24, s[16:19], s55 offen offset:2048 lds
s_waitcnt lgkmcnt(10)
v_mfma_f32_32x32x16_bf16 a[192:207], v[168:171], v[224:227], a[192:207]
v_mfma_f32_32x32x16_bf16 a[208:223], v[168:171], v[228:231], a[208:223]
s_add_u32 s55, s56, 9216
buffer_load_dwordx4 v24, s[16:19], s55 offen offset:3072 lds
s_waitcnt lgkmcnt(8)
v_mfma_f32_32x32x16_bf16 a[224:239], v[172:175], v[224:227], a[224:239]
s_add_u32 s61, s65, s69
s_and_b32 s61, s61, 15
s_lshr_b32 s60, s61, 2
s_mul_i32 s60, s60, 40960
s_and_b32 s61, s61, 3
s_lshl_b32 s61, s61, 12
s_add_u32 s60, s60, s61
v_add_u32 v27, s60, v26
s_add_u32 s65, s65, 1
ds_read_b128 v[144:147], v27 offset:24576
ds_read_b128 v[148:151], v27 offset:25600
ds_read_b128 v[152:155], v27 offset:26624
ds_read_b128 v[156:159], v27 offset:27648
s_waitcnt vmcnt(4)
ds_read_b64_tr_b16 v[192:193], v14 offset:8192
ds_read_b64_tr_b16 v[194:195], v14 offset:10240
v_mfma_f32_32x32x16_bf16 a[240:255], v[172:175], v[228:231], a[240:255]
s_add_u32 m0, s32, 20480
s_add_u32 s55, s56, 16384
buffer_load_dwordx4 v24, s[16:19], s55 offen offset:0 lds
s_waitcnt lgkmcnt(12)
v_mfma_f32_32x32x16_bf16 a[128:143], v[176:179], v[232:235], a[128:143]
ds_read_b64_tr_b16 v[196:197], v15 offset:8192
ds_read_b64_tr_b16 v[198:199], v15 offset:10240
v_mfma_f32_32x32x16_bf16 a[144:159], v[176:179], v[236:239], a[144:159]
s_add_u32 s55, s56, 19456
buffer_load_dwordx4 v24, s[16:19], s55 offen offset:1024 lds
s_waitcnt lgkmcnt(12)
v_mfma_f32_32x32x16_bf16 a[160:175], v[180:183], v[232:235], a[160:175]
ds_read_b64_tr_b16 v[200:201], v16 offset:8192
ds_read_b64_tr_b16 v[202:203], v16 offset:10240
v_mfma_f32_32x32x16_bf16 a[176:191], v[180:183], v[236:239], a[176:191]
s_add_u32 s55, s56, 22528
buffer_load_dwordx4 v24, s[16:19], s55 offen offset:2048 lds
s_waitcnt lgkmcnt(12)
v_mfma_f32_32x32x16_bf16 a[192:207], v[184:187], v[232:235], a[192:207]
ds_read_b64_tr_b16 v[204:205], v17 offset:8192
ds_read_b64_tr_b16 v[206:207], v17 offset:10240
v_mfma_f32_32x32x16_bf16 a[208:223], v[184:187], v[236:239], a[208:223]
s_add_u32 s55, s56, 25600
buffer_load_dwordx4 v24, s[16:19], s55 offen offset:3072 lds
s_waitcnt lgkmcnt(12)
v_mfma_f32_32x32x16_bf16 a[224:239], v[188:191], v[232:235], a[224:239]
ds_read_b64_tr_b16 v[208:209], v14 offset:12288
ds_read_b64_tr_b16 v[210:211], v14 offset:14336
v_mfma_f32_32x32x16_bf16 a[240:255], v[188:191], v[236:239], a[240:255]
s_add_u32 s57, s64, s69
s_and_b32 s57, s57, 15
s_lshr_b32 s56, s57, 2
s_lshl_b32 s56, s56, 18
s_and_b32 s57, s57, 3
s_lshl_b32 s57, s57, 15
s_add_u32 s56, s56, s57
s_add_u32 s56, s56, s66
s_add_u32 s64, s64, 1
s_add_u32 m0, s32, 0
s_add_u32 s55, s56, 0
buffer_load_dwordx4 v24, s[16:19], s55 offen offset:0 lds
s_waitcnt lgkmcnt(8)
v_mfma_f32_32x32x16_bf16 a[128:143], v[192:195], v[144:147], a[128:143]
ds_read_b64_tr_b16 v[212:213], v15 offset:12288
ds_read_b64_tr_b16 v[214:215], v15 offset:14336
ds_read_b64_tr_b16 v[216:217], v16 offset:12288
ds_read_b64_tr_b16 v[218:219], v16 offset:14336
v_mfma_f32_32x32x16_bf16 a[144:159], v[192:195], v[148:151], a[144:159]
s_add_u32 s55, s56, 3072
buffer_load_dwordx4 v24, s[16:19], s55 offen offset:1024 lds
s_waitcnt lgkmcnt(10)
v_mfma_f32_32x32x16_bf16 a[160:175], v[196:199], v[144:147], a[160:175]
ds_read_b64_tr_b16 v[220:221], v17 offset:12288
ds_read_b64_tr_b16 v[222:223], v17 offset:14336
v_mfma_f32_32x32x16_bf16 a[176:191], v[196:199], v[148:151], a[176:191]
s_add_u32 s55, s56, 6144
buffer_load_dwordx4 v24, s[16:19], s55 offen offset:2048 lds
s_waitcnt lgkmcnt(10)
v_mfma_f32_32x32x16_bf16 a[192:207], v[200:203], v[144:147], a[192:207]
v_mfma_f32_32x32x16_bf16 a[208:223], v[200:203], v[148:151], a[208:223]
s_add_u32 s55, s56, 9216
buffer_load_dwordx4 v24, s[16:19], s55 offen offset:3072 lds
s_waitcnt lgkmcnt(8)
v_mfma_f32_32x32x16_bf16 a[224:239], v[204:207], v[144:147], a[224:239]
s_add_u32 s61, s65, s69
s_and_b32 s61, s61, 15
s_lshr_b32 s60, s61, 2
s_mul_i32 s60, s60, 40960
s_and_b32 s61, s61, 3
s_lshl_b32 s61, s61, 12
s_add_u32 s60, s60, s61
v_add_u32 v27, s60, v26
s_add_u32 s65, s65, 1
ds_read_b128 v[224:227], v27 offset:24576
ds_read_b128 v[228:231], v27 offset:25600
ds_read_b128 v[232:235], v27 offset:26624
ds_read_b128 v[236:239], v27 offset:27648
s_waitcnt vmcnt(4)
ds_read_b64_tr_b16 v[160:161], v14 offset:16384
ds_read_b64_tr_b16 v[162:163], v14 offset:18432
v_mfma_f32_32x32x16_bf16 a[240:255], v[204:207], v[148:151], a[240:255]
s_add_u32 m0, s32, 4096
s_add_u32 s55, s56, 16384
buffer_load_dwordx4 v24, s[16:19], s55 offen offset:0 lds
s_waitcnt lgkmcnt(12)
v_mfma_f32_32x32x16_bf16 a[128:143], v[208:211], v[152:155], a[128:143]
ds_read_b64_tr_b16 v[164:165], v15 offset:16384
ds_read_b64_tr_b16 v[166:167], v15 offset:18432
v_mfma_f32_32x32x16_bf16 a[144:159], v[208:211], v[156:159], a[144:159]
s_add_u32 s55, s56, 19456
buffer_load_dwordx4 v24, s[16:19], s55 offen offset:1024 lds
s_waitcnt lgkmcnt(12)
v_mfma_f32_32x32x16_bf16 a[160:175], v[212:215], v[152:155], a[160:175]
ds_read_b64_tr_b16 v[168:169], v16 offset:16384
ds_read_b64_tr_b16 v[170:171], v16 offset:18432
v_mfma_f32_32x32x16_bf16 a[176:191], v[212:215], v[156:159], a[176:191]
s_add_u32 s55, s56, 22528
buffer_load_dwordx4 v24, s[16:19], s55 offen offset:2048 lds
s_waitcnt lgkmcnt(12)
v_mfma_f32_32x32x16_bf16 a[192:207], v[216:219], v[152:155], a[192:207]
ds_read_b64_tr_b16 v[172:173], v17 offset:16384
ds_read_b64_tr_b16 v[174:175], v17 offset:18432
v_mfma_f32_32x32x16_bf16 a[208:223], v[216:219], v[156:159], a[208:223]
s_add_u32 s55, s56, 25600
buffer_load_dwordx4 v24, s[16:19], s55 offen offset:3072 lds
s_waitcnt lgkmcnt(12)
v_mfma_f32_32x32x16_bf16 a[224:239], v[220:223], v[152:155], a[224:239]
ds_read_b64_tr_b16 v[176:177], v14 offset:20480
ds_read_b64_tr_b16 v[178:179], v14 offset:22528
v_mfma_f32_32x32x16_bf16 a[240:255], v[220:223], v[156:159], a[240:255]
s_waitcnt lgkmcnt(8)
v_mfma_f32_32x32x16_bf16 a[128:143], v[160:163], v[224:227], a[128:143]
ds_read_b64_tr_b16 v[180:181], v15 offset:20480
ds_read_b64_tr_b16 v[182:183], v15 offset:22528
ds_read_b64_tr_b16 v[184:185], v16 offset:20480
ds_read_b64_tr_b16 v[186:187], v16 offset:22528
v_mfma_f32_32x32x16_bf16 a[144:159], v[160:163], v[228:231], a[144:159]
s_waitcnt lgkmcnt(10)
v_mfma_f32_32x32x16_bf16 a[160:175], v[164:167], v[224:227], a[160:175]
ds_read_b64_tr_b16 v[188:189], v17 offset:20480
ds_read_b64_tr_b16 v[190:191], v17 offset:22528
v_mfma_f32_32x32x16_bf16 a[176:191], v[164:167], v[228:231], a[176:191]
s_waitcnt lgkmcnt(10)
v_mfma_f32_32x32x16_bf16 a[192:207], v[168:171], v[224:227], a[192:207]
v_mfma_f32_32x32x16_bf16 a[208:223], v[168:171], v[228:231], a[208:223]
s_waitcnt lgkmcnt(8)
v_mfma_f32_32x32x16_bf16 a[224:239], v[172:175], v[224:227], a[224:239]
s_add_u32 s61, s65, s69
s_and_b32 s61, s61, 15
s_lshr_b32 s60, s61, 2
s_mul_i32 s60, s60, 40960
s_and_b32 s61, s61, 3
s_lshl_b32 s61, s61, 12
s_add_u32 s60, s60, s61
v_add_u32 v27, s60, v26
s_add_u32 s65, s65, 1
ds_read_b128 v[144:147], v27 offset:24576
ds_read_b128 v[148:151], v27 offset:25600
ds_read_b128 v[152:155], v27 offset:26624
ds_read_b128 v[156:159], v27 offset:27648
s_waitcnt vmcnt(0)
ds_read_b64_tr_b16 v[192:193], v14 offset:0
ds_read_b64_tr_b16 v[194:195], v14 offset:2048
v_mfma_f32_32x32x16_bf16 a[240:255], v[172:175], v[228:231], a[240:255]
s_waitcnt lgkmcnt(12)
v_mfma_f32_32x32x16_bf16 a[128:143], v[176:179], v[232:235], a[128:143]
ds_read_b64_tr_b16 v[196:197], v15 offset:0
ds_read_b64_tr_b16 v[198:199], v15 offset:2048
v_mfma_f32_32x32x16_bf16 a[144:159], v[176:179], v[236:239], a[144:159]
s_waitcnt lgkmcnt(12)
v_mfma_f32_32x32x16_bf16 a[160:175], v[180:183], v[232:235], a[160:175]
ds_read_b64_tr_b16 v[200:201], v16 offset:0
ds_read_b64_tr_b16 v[202:203], v16 offset:2048
v_mfma_f32_32x32x16_bf16 a[176:191], v[180:183], v[236:239], a[176:191]
s_waitcnt lgkmcnt(12)
v_mfma_f32_32x32x16_bf16 a[192:207], v[184:187], v[232:235], a[192:207]
ds_read_b64_tr_b16 v[204:205], v17 offset:0
ds_read_b64_tr_b16 v[206:207], v17 offset:2048
v_mfma_f32_32x32x16_bf16 a[208:223], v[184:187], v[236:239], a[208:223]
s_waitcnt lgkmcnt(12)
v_mfma_f32_32x32x16_bf16 a[224:239], v[188:191], v[232:235], a[224:239]
ds_read_b64_tr_b16 v[208:209], v14 offset:4096
ds_read_b64_tr_b16 v[210:211], v14 offset:6144
v_mfma_f32_32x32x16_bf16 a[240:255], v[188:191], v[236:239], a[240:255]
s_waitcnt lgkmcnt(8)
v_mfma_f32_32x32x16_bf16 a[128:143], v[192:195], v[144:147], a[128:143]
ds_read_b64_tr_b16 v[212:213], v15 offset:4096
ds_read_b64_tr_b16 v[214:215], v15 offset:6144
ds_read_b64_tr_b16 v[216:217], v16 offset:4096
ds_read_b64_tr_b16 v[218:219], v16 offset:6144
v_mfma_f32_32x32x16_bf16 a[144:159], v[192:195], v[148:151], a[144:159]
s_waitcnt lgkmcnt(10)
v_mfma_f32_32x32x16_bf16 a[160:175], v[196:199], v[144:147], a[160:175]
ds_read_b64_tr_b16 v[220:221], v17 offset:4096
ds_read_b64_tr_b16 v[222:223], v17 offset:6144
v_mfma_f32_32x32x16_bf16 a[176:191], v[196:199], v[148:151], a[176:191]
s_waitcnt lgkmcnt(10)
v_mfma_f32_32x32x16_bf16 a[192:207], v[200:203], v[144:147], a[192:207]
v_mfma_f32_32x32x16_bf16 a[208:223], v[200:203], v[148:151], a[208:223]
s_waitcnt lgkmcnt(8)
v_mfma_f32_32x32x16_bf16 a[224:239], v[204:207], v[144:147], a[224:239]
v_mfma_f32_32x32x16_bf16 a[240:255], v[204:207], v[148:151], a[240:255]
s_waitcnt lgkmcnt(6)
v_mfma_f32_32x32x16_bf16 a[128:143], v[208:211], v[152:155], a[128:143]
v_mfma_f32_32x32x16_bf16 a[144:159], v[208:211], v[156:159], a[144:159]
s_waitcnt lgkmcnt(4)
v_mfma_f32_32x32x16_bf16 a[160:175], v[212:215], v[152:155], a[160:175]
v_mfma_f32_32x32x16_bf16 a[176:191], v[212:215], v[156:159], a[176:191]
s_waitcnt lgkmcnt(2)
v_mfma_f32_32x32x16_bf16 a[192:207], v[216:219], v[152:155], a[192:207]
v_mfma_f32_32x32x16_bf16 a[208:223], v[216:219], v[156:159], a[208:223]
s_waitcnt lgkmcnt(0)
v_mfma_f32_32x32x16_bf16 a[224:239], v[220:223], v[152:155], a[224:239]
v_mfma_f32_32x32x16_bf16 a[240:255], v[220:223], v[156:159], a[240:255]
s_nop 7
s_nop 7
v_accvgpr_read_b32 v48, a160
v_accvgpr_read_b32 v49, a161
v_accvgpr_read_b32 v50, a162
v_accvgpr_read_b32 v51, a163
v_accvgpr_read_b32 v52, a164
v_accvgpr_read_b32 v53, a165
v_accvgpr_read_b32 v54, a166
v_accvgpr_read_b32 v55, a167
v_accvgpr_read_b32 v56, a168
v_accvgpr_read_b32 v57, a169
v_accvgpr_read_b32 v58, a170
v_accvgpr_read_b32 v59, a171
v_accvgpr_read_b32 v60, a172
v_accvgpr_read_b32 v61, a173
v_accvgpr_read_b32 v62, a174
v_accvgpr_read_b32 v63, a175
v_cvt_pk_bf16_f32 v128, v48, v49
v_cvt_pk_bf16_f32 v129, v50, v51
v_cvt_pk_bf16_f32 v130, v52, v53
v_cvt_pk_bf16_f32 v131, v54, v55
v_cvt_pk_bf16_f32 v132, v56, v57
v_cvt_pk_bf16_f32 v133, v58, v59
v_cvt_pk_bf16_f32 v134, v60, v61
v_cvt_pk_bf16_f32 v135, v62, v63
v_accvgpr_read_b32 v64, a176
v_accvgpr_read_b32 v65, a177
v_accvgpr_read_b32 v66, a178
v_accvgpr_read_b32 v67, a179
v_accvgpr_read_b32 v68, a180
v_accvgpr_read_b32 v69, a181
v_accvgpr_read_b32 v70, a182
v_accvgpr_read_b32 v71, a183
v_accvgpr_read_b32 v72, a184
v_accvgpr_read_b32 v73, a185
v_accvgpr_read_b32 v74, a186
v_accvgpr_read_b32 v75, a187
v_accvgpr_read_b32 v76, a188
v_accvgpr_read_b32 v77, a189
v_accvgpr_read_b32 v78, a190
v_accvgpr_read_b32 v79, a191
v_cvt_pk_bf16_f32 v136, v64, v65
v_cvt_pk_bf16_f32 v137, v66, v67
v_cvt_pk_bf16_f32 v138, v68, v69
v_cvt_pk_bf16_f32 v139, v70, v71
v_cvt_pk_bf16_f32 v140, v72, v73
v_cvt_pk_bf16_f32 v141, v74, v75
v_cvt_pk_bf16_f32 v142, v76, v77
v_cvt_pk_bf16_f32 v143, v78, v79
s_add_u32 s59, s31, 1
s_and_b32 s59, s59, 3
s_lshl_b32 s59, s59, 12
s_add_u32 s59, s59, s68
buffer_store_dwordx4 v[128:131], v26, s[24:27], s59 offen offset:0 sc1
buffer_store_dwordx4 v[132:135], v26, s[24:27], s59 offen offset:1024 sc1
buffer_store_dwordx4 v[136:139], v26, s[24:27], s59 offen offset:2048 sc1
buffer_store_dwordx4 v[140:143], v26, s[24:27], s59 offen offset:3072 sc1
v_accvgpr_read_b32 v48, a192
v_accvgpr_read_b32 v49, a193
v_accvgpr_read_b32 v50, a194
v_accvgpr_read_b32 v51, a195
v_accvgpr_read_b32 v52, a196
v_accvgpr_read_b32 v53, a197
v_accvgpr_read_b32 v54, a198
v_accvgpr_read_b32 v55, a199
v_accvgpr_read_b32 v56, a200
v_accvgpr_read_b32 v57, a201
v_accvgpr_read_b32 v58, a202
v_accvgpr_read_b32 v59, a203
v_accvgpr_read_b32 v60, a204
v_accvgpr_read_b32 v61, a205
v_accvgpr_read_b32 v62, a206
v_accvgpr_read_b32 v63, a207
v_cvt_pk_bf16_f32 v144, v48, v49
v_cvt_pk_bf16_f32 v145, v50, v51
v_cvt_pk_bf16_f32 v146, v52, v53
v_cvt_pk_bf16_f32 v147, v54, v55
v_cvt_pk_bf16_f32 v148, v56, v57
v_cvt_pk_bf16_f32 v149, v58, v59
v_cvt_pk_bf16_f32 v150, v60, v61
v_cvt_pk_bf16_f32 v151, v62, v63
v_accvgpr_read_b32 v64, a208
v_accvgpr_read_b32 v65, a209
v_accvgpr_read_b32 v66, a210
v_accvgpr_read_b32 v67, a211
v_accvgpr_read_b32 v68, a212
v_accvgpr_read_b32 v69, a213
v_accvgpr_read_b32 v70, a214
v_accvgpr_read_b32 v71, a215
v_accvgpr_read_b32 v72, a216
v_accvgpr_read_b32 v73, a217
v_accvgpr_read_b32 v74, a218
v_accvgpr_read_b32 v75, a219
v_accvgpr_read_b32 v76, a220
v_accvgpr_read_b32 v77, a221
v_accvgpr_read_b32 v78, a222
v_accvgpr_read_b32 v79, a223
v_cvt_pk_bf16_f32 v152, v64, v65
v_cvt_pk_bf16_f32 v153, v66, v67
v_cvt_pk_bf16_f32 v154, v68, v69
v_cvt_pk_bf16_f32 v155, v70, v71
v_cvt_pk_bf16_f32 v156, v72, v73
v_cvt_pk_bf16_f32 v157, v74, v75
v_cvt_pk_bf16_f32 v158, v76, v77
v_cvt_pk_bf16_f32 v159, v78, v79
s_add_u32 s59, s31, 2
s_and_b32 s59, s59, 3
s_lshl_b32 s59, s59, 12
s_add_u32 s59, s59, s68
buffer_store_dwordx4 v[144:147], v26, s[24:27], s59 offen offset:0 sc1
buffer_store_dwordx4 v[148:151], v26, s[24:27], s59 offen offset:1024 sc1
buffer_store_dwordx4 v[152:155], v26, s[24:27], s59 offen offset:2048 sc1
buffer_store_dwordx4 v[156:159], v26, s[24:27], s59 offen offset:3072 sc1
v_accvgpr_read_b32 v48, a224
v_accvgpr_read_b32 v49, a225
v_accvgpr_read_b32 v50, a226
v_accvgpr_read_b32 v51, a227
v_accvgpr_read_b32 v52, a228
v_accvgpr_read_b32 v53, a229
v_accvgpr_read_b32 v54, a230
v_accvgpr_read_b32 v55, a231
v_accvgpr_read_b32 v56, a232
v_accvgpr_read_b32 v57, a233
v_accvgpr_read_b32 v58, a234
v_accvgpr_read_b32 v59, a235
v_accvgpr_read_b32 v60, a236
v_accvgpr_read_b32 v61, a237
v_accvgpr_read_b32 v62, a238
v_accvgpr_read_b32 v63, a239
v_cvt_pk_bf16_f32 v160, v48, v49
v_cvt_pk_bf16_f32 v161, v50, v51
v_cvt_pk_bf16_f32 v162, v52, v53
v_cvt_pk_bf16_f32 v163, v54, v55
v_cvt_pk_bf16_f32 v164, v56, v57
v_cvt_pk_bf16_f32 v165, v58, v59
v_cvt_pk_bf16_f32 v166, v60, v61
v_cvt_pk_bf16_f32 v167, v62, v63
v_accvgpr_read_b32 v64, a240
v_accvgpr_read_b32 v65, a241
v_accvgpr_read_b32 v66, a242
v_accvgpr_read_b32 v67, a243
v_accvgpr_read_b32 v68, a244
v_accvgpr_read_b32 v69, a245
v_accvgpr_read_b32 v70, a246
v_accvgpr_read_b32 v71, a247
v_accvgpr_read_b32 v72, a248
v_accvgpr_read_b32 v73, a249
v_accvgpr_read_b32 v74, a250
v_accvgpr_read_b32 v75, a251
v_accvgpr_read_b32 v76, a252
v_accvgpr_read_b32 v77, a253
v_accvgpr_read_b32 v78, a254
v_accvgpr_read_b32 v79, a255
v_cvt_pk_bf16_f32 v168, v64, v65
v_cvt_pk_bf16_f32 v169, v66, v67
v_cvt_pk_bf16_f32 v170, v68, v69
v_cvt_pk_bf16_f32 v171, v70, v71
v_cvt_pk_bf16_f32 v172, v72, v73
v_cvt_pk_bf16_f32 v173, v74, v75
v_cvt_pk_bf16_f32 v174, v76, v77
v_cvt_pk_bf16_f32 v175, v78, v79
s_add_u32 s59, s31, 3
s_and_b32 s59, s59, 3
s_lshl_b32 s59, s59, 12
s_add_u32 s59, s59, s68
buffer_store_dwordx4 v[160:163], v26, s[24:27], s59 offen offset:0 sc1
buffer_store_dwordx4 v[164:167], v26, s[24:27], s59 offen offset:1024 sc1
buffer_store_dwordx4 v[168:171], v26, s[24:27], s59 offen offset:2048 sc1
buffer_store_dwordx4 v[172:175], v26, s[24:27], s59 offen offset:3072 sc1
v_accvgpr_read_b32 v48, a128
v_accvgpr_read_b32 v49, a129
v_accvgpr_read_b32 v50, a130
v_accvgpr_read_b32 v51, a131
v_accvgpr_read_b32 v52, a132
v_accvgpr_read_b32 v53, a133
v_accvgpr_read_b32 v54, a134
v_accvgpr_read_b32 v55, a135
v_accvgpr_read_b32 v56, a136
v_accvgpr_read_b32 v57, a137
v_accvgpr_read_b32 v58, a138
v_accvgpr_read_b32 v59, a139
v_accvgpr_read_b32 v60, a140
v_accvgpr_read_b32 v61, a141
v_accvgpr_read_b32 v62, a142
v_accvgpr_read_b32 v63, a143
v_cvt_pk_bf16_f32 v112, v48, v49
v_cvt_pk_bf16_f32 v113, v50, v51
v_cvt_pk_bf16_f32 v114, v52, v53
v_cvt_pk_bf16_f32 v115, v54, v55
v_cvt_pk_bf16_f32 v116, v56, v57
v_cvt_pk_bf16_f32 v117, v58, v59
v_cvt_pk_bf16_f32 v118, v60, v61
v_cvt_pk_bf16_f32 v119, v62, v63
v_accvgpr_read_b32 v64, a144
v_accvgpr_read_b32 v65, a145
v_accvgpr_read_b32 v66, a146
v_accvgpr_read_b32 v67, a147
v_accvgpr_read_b32 v68, a148
v_accvgpr_read_b32 v69, a149
v_accvgpr_read_b32 v70, a150
v_accvgpr_read_b32 v71, a151
v_accvgpr_read_b32 v72, a152
v_accvgpr_read_b32 v73, a153
v_accvgpr_read_b32 v74, a154
v_accvgpr_read_b32 v75, a155
v_accvgpr_read_b32 v76, a156
v_accvgpr_read_b32 v77, a157
v_accvgpr_read_b32 v78, a158
v_accvgpr_read_b32 v79, a159
v_cvt_pk_bf16_f32 v120, v64, v65
v_cvt_pk_bf16_f32 v121, v66, v67
v_cvt_pk_bf16_f32 v122, v68, v69
v_cvt_pk_bf16_f32 v123, v70, v71
v_cvt_pk_bf16_f32 v124, v72, v73
v_cvt_pk_bf16_f32 v125, v74, v75
v_cvt_pk_bf16_f32 v126, v76, v77
v_cvt_pk_bf16_f32 v127, v78, v79
s_lshl_b32 s59, s30, 5
s_add_u32 s59, s59, s29
s_lshl_b32 s54, s59, 2
s_add_u32 s54, s54, s28
s_lshl_b32 s54, s54, 9
s_add_u32 s54, s54, 0x3000000
s_lshl_b32 s55, s31, 7
s_add_u32 s55, s55, s54
v_mov_b32 v29, 0
s_mov_b64 s[48:49], exec
s_mov_b64 exec, 1
buffer_store_dword v29, v29, s[24:27], s55 offen sc1
s_mov_b64 exec, s[48:49]
s_load_dwordx4 s[40:43], s[0:1], 80
s_lshl_b32 s60, s28, 3
s_lshl_b32 s61, 1, s60
v_mov_b32 v33, s61
s_lshl_b32 s59, s30, 5
s_add_u32 s59, s59, s29
s_lshl_b32 s61, s59, 2
v_mov_b32 v34, s61
s_waitcnt lgkmcnt(0)
s_mov_b32 s44, s42
s_mov_b32 s45, s43
s_mov_b32 s46, 256
s_mov_b32 s47, 0x20000
s_mov_b32 s42, 0x400000
s_mov_b32 s43, 0x20000
s_waitcnt vmcnt(0)
s_mov_b64 exec, 1
buffer_atomic_add v33, v34, s[44:47], 0 offen sc0 sc1
s_waitcnt vmcnt(0)
v_readfirstlane_b32 s61, v33
s_lshr_b32 s61, s61, s60
s_and_b32 s61, s61, 7
s_mov_b32 s38, 0
s_cmp_eq_u32 s61, 3
s_cbranch_scc1 L_last
s_memrealtime s[36:37]
s_waitcnt lgkmcnt(0)
s_add_u32 s39, s36, 6000
L_spin:
s_sleep 8
buffer_load_dword v33, v29, s[24:27], s55 offen sc1
s_memrealtime s[36:37]
s_waitcnt vmcnt(0) lgkmcnt(0)
v_readfirstlane_b32 s61, v33
s_cmp_eq_u32 s61, 1
s_cbranch_scc1 L_go
s_sub_u32 s37, s39, s36
s_cmp_lt_i32 s37, 0
s_cbranch_scc0 L_spin
s_mov_b64 exec, s[48:49]
s_mov_b32 s36, s59
s_add_u32 s59, s31, 0
s_and_b32 s59, s59, 3
s_lshl_b32 s59, s59, 12
s_add_u32 s59, s59, s68
buffer_store_dwordx4 v[112:115], v26, s[24:27], s59 offen offset:0 sc1
buffer_store_dwordx4 v[116:119], v26, s[24:27], s59 offen offset:1024 sc1
buffer_store_dwordx4 v[120:123], v26, s[24:27], s59 offen offset:2048 sc1
buffer_store_dwordx4 v[124:127], v26, s[24:27], s59 offen offset:3072 sc1
s_waitcnt vmcnt(0)
s_mov_b32 s59, s36
s_mov_b64 exec, 1
v_mov_b32 v33, 2
buffer_atomic_swap v33, v29, s[24:27], s55 offen sc0 sc1
s_waitcnt vmcnt(0)
v_readfirstlane_b32 s61, v33
s_cmp_eq_u32 s61, 1
s_cbranch_scc1 L_go
s_mov_b64 exec, s[48:49]
s_branch L_fin
L_last:
s_mov_b64 exec, 15
v_mov_b32 v33, 1
buffer_atomic_swap v33, v25, s[24:27], s54 offen sc0 sc1
s_waitcnt vmcnt(0)
v_cmp_eq_u32 vcc, 2, v33
s_nop 4
s_and_b32 s38, vcc_lo, 15
L_go:
s_mov_b64 exec, s[48:49]
s_lshl_b32 s50, s59, 19
s_lshl_b32 s51, s28, 15
s_add_u32 s50, s50, s51
s_lshl_b32 s52, s29, 17
s_lshl_b32 s51, s30, 10
s_add_u32 s52, s52, s51
s_lshl_b32 s51, s28, 8
s_add_u32 s52, s52, s51
v_and_b32 v35, 31, v1
v_lshlrev_b32 v35, 11, v35
v_lshrrev_b32 v36, 5, v1
v_lshl_add_u32 v35, v36, 4, v35
s_mov_b32 s37, s31
L_quarter:
s_lshl_b32 s51, s37, 12
s_add_u32 s51, s51, s50
s_cmp_lg_u32 s37, s31
s_cbranch_scc1 L_r0mem
v_mov_b32 v176, v112
v_mov_b32 v177, v113
v_mov_b32 v178, v114
v_mov_b32 v179, v115
v_mov_b32 v180, v116
v_mov_b32 v181, v117
v_mov_b32 v182, v118
v_mov_b32 v183, v119
v_mov_b32 v208, v120
v_mov_b32 v209, v121
v_mov_b32 v210, v122
v_mov_b32 v211, v123
v_mov_b32 v212, v124
v_mov_b32 v213, v125
v_mov_b32 v214, v126
v_mov_b32 v215, v127
s_branch L_r0done
L_r0mem:
s_lshl_b32 s53, s37, 17
s_add_u32 s53, s53, s51
buffer_load_dwordx4 v[176:179], v26, s[24:27], s53 offen offset:0 sc1
buffer_load_dwordx4 v[180:183], v26, s[24:27], s53 offen offset:1024 sc1
buffer_load_dwordx4 v[208:211], v26, s[24:27], s53 offen offset:2048 sc1
buffer_load_dwordx4 v[212:215], v26, s[24:27], s53 offen offset:3072 sc1
L_r0done:
s_add_u32 s53, s37, 1
s_and_b32 s53, s53, 3
s_lshl_b32 s53, s53, 17
s_add_u32 s53, s53, s51
buffer_load_dwordx4 v[184:187], v26, s[24:27], s53 offen offset:0 sc1
buffer_load_dwordx4 v[188:191], v26, s[24:27], s53 offen offset:1024 sc1
s_add_u32 s53, s37, 2
s_and_b32 s53, s53, 3
s_lshl_b32 s53, s53, 17
s_add_u32 s53, s53, s51
buffer_load_dwordx4 v[192:195], v26, s[24:27], s53 offen offset:0 sc1
buffer_load_dwordx4 v[196:199], v26, s[24:27], s53 offen offset:1024 sc1
s_add_u32 s53, s37, 3
s_and_b32 s53, s53, 3
s_lshl_b32 s53, s53, 17
s_add_u32 s53, s53, s51
buffer_load_dwordx4 v[200:203], v26, s[24:27], s53 offen offset:0 sc1
buffer_load_dwordx4 v[204:207], v26, s[24:27], s53 offen offset:1024 sc1
s_add_u32 s53, s37, 1
s_and_b32 s53, s53, 3
s_lshl_b32 s53, s53, 17
s_add_u32 s53, s53, s51
buffer_load_dwordx4 v[216:219], v26, s[24:27], s53 offen offset:2048 sc1
buffer_load_dwordx4 v[220:223], v26, s[24:27], s53 offen offset:3072 sc1
s_add_u32 s53, s37, 2
s_and_b32 s53, s53, 3
s_lshl_b32 s53, s53, 17
s_add_u32 s53, s53, s51
buffer_load_dwordx4 v[224:227], v26, s[24:27], s53 offen offset:2048 sc1
buffer_load_dwordx4 v[228:231], v26, s[24:27], s53 offen offset:3072 sc1
s_add_u32 s53, s37, 3
s_and_b32 s53, s53, 3
s_lshl_b32 s53, s53, 17
s_add_u32 s53, s53, s51
buffer_load_dwordx4 v[232:235], v26, s[24:27], s53 offen offset:2048 sc1
buffer_load_dwordx4 v[236:239], v26, s[24:27], s53 offen offset:3072 sc1
s_lshl_b32 s51, s37, 6
s_add_u32 s51, s51, s52
s_waitcnt vmcnt(6)
v_lshlrev_b32 v48, 16, v176
v_and_b32 v49, 0xffff0000, v176
v_lshlrev_b32 v50, 16, v177
v_and_b32 v51, 0xffff0000, v177
v_lshlrev_b32 v52, 16, v178
v_and_b32 v53, 0xffff0000, v178
v_lshlrev_b32 v54, 16, v179
v_and_b32 v55, 0xffff0000, v179
v_lshlrev_b32 v56, 16, v180
v_and_b32 v57, 0xffff0000, v180
v_lshlrev_b32 v58, 16, v181
v_and_b32 v59, 0xffff0000, v181
v_lshlrev_b32 v60, 16, v182
v_and_b32 v61, 0xffff0000, v182
v_lshlrev_b32 v62, 16, v183
v_and_b32 v63, 0xffff0000, v183
v_lshlrev_b32 v64, 16, v184
v_and_b32 v65, 0xffff0000, v184
v_lshlrev_b32 v66, 16, v185
v_and_b32 v67, 0xffff0000, v185
v_lshlrev_b32 v68, 16, v186
v_and_b32 v69, 0xffff0000, v186
v_lshlrev_b32 v70, 16, v187
v_and_b32 v71, 0xffff0000, v187
v_lshlrev_b32 v72, 16, v188
v_and_b32 v73, 0xffff0000, v188
v_lshlrev_b32 v74, 16, v189
v_and_b32 v75, 0xffff0000, v189
v_lshlrev_b32 v76, 16, v190
v_and_b32 v77, 0xffff0000, v190
v_lshlrev_b32 v78, 16, v191
v_and_b32 v79, 0xffff0000, v191
v_add_f32 v48, v48, v64
v_add_f32 v49, v49, v65
v_add_f32 v50, v50, v66
v_add_f32 v51, v51, v67
v_add_f32 v52, v52, v68
v_add_f32 v53, v53, v69
v_add_f32 v54, v54, v70
v_add_f32 v55, v55, v71
v_add_f32 v56, v56, v72
v_add_f32 v57, v57, v73
v_add_f32 v58, v58, v74
v_add_f32 v59, v59, v75
v_add_f32 v60, v60, v76
v_add_f32 v61, v61, v77
v_add_f32 v62, v62, v78
v_add_f32 v63, v63, v79
v_lshlrev_b32 v64, 16, v192
v_and_b32 v65, 0xffff0000, v192
v_lshlrev_b32 v66, 16, v193
v_and_b32 v67, 0xffff0000, v193
v_lshlrev_b32 v68, 16, v194
v_and_b32 v69, 0xffff0000, v194
v_lshlrev_b32 v70, 16, v195
v_and_b32 v71, 0xffff0000, v195
v_lshlrev_b32 v72, 16, v196
v_and_b32 v73, 0xffff0000, v196
v_lshlrev_b32 v74, 16, v197
v_and_b32 v75, 0xffff0000, v197
v_lshlrev_b32 v76, 16, v198
v_and_b32 v77, 0xffff0000, v198
v_lshlrev_b32 v78, 16, v199
v_and_b32 v79, 0xffff0000, v199
v_add_f32 v48, v48, v64
v_add_f32 v49, v49, v65
v_add_f32 v50, v50, v66
v_add_f32 v51, v51, v67
v_add_f32 v52, v52, v68
v_add_f32 v53, v53, v69
v_add_f32 v54, v54, v70
v_add_f32 v55, v55, v71
v_add_f32 v56, v56, v72
v_add_f32 v57, v57, v73
v_add_f32 v58, v58, v74
v_add_f32 v59, v59, v75
v_add_f32 v60, v60, v76
v_add_f32 v61, v61, v77
v_add_f32 v62, v62, v78
v_add_f32 v63, v63, v79
v_lshlrev_b32 v64, 16, v200
v_and_b32 v65, 0xffff0000, v200
v_lshlrev_b32 v66, 16, v201
v_and_b32 v67, 0xffff0000, v201
v_lshlrev_b32 v68, 16, v202
v_and_b32 v69, 0xffff0000, v202
v_lshlrev_b32 v70, 16, v203
v_and_b32 v71, 0xffff0000, v203
v_lshlrev_b32 v72, 16, v204
v_and_b32 v73, 0xffff0000, v204
v_lshlrev_b32 v74, 16, v205
v_and_b32 v75, 0xffff0000, v205
v_lshlrev_b32 v76, 16, v206
v_and_b32 v77, 0xffff0000, v206
v_lshlrev_b32 v78, 16, v207
v_and_b32 v79, 0xffff0000, v207
v_add_f32 v48, v48, v64
v_add_f32 v49, v49, v65
v_add_f32 v50, v50, v66
v_add_f32 v51, v51, v67
v_add_f32 v52, v52, v68
v_add_f32 v53, v53, v69
v_add_f32 v54, v54, v70
v_add_f32 v55, v55, v71
v_add_f32 v56, v56, v72
v_add_f32 v57, v57, v73
v_add_f32 v58, v58, v74
v_add_f32 v59, v59, v75
v_add_f32 v60, v60, v76
v_add_f32 v61, v61, v77
v_add_f32 v62, v62, v78
v_add_f32 v63, v63, v79
v_cvt_pk_bf16_f32 v240, v48, v49
v_cvt_pk_bf16_f32 v241, v50, v51
v_cvt_pk_bf16_f32 v242, v52, v53
v_cvt_pk_bf16_f32 v243, v54, v55
v_cvt_pk_bf16_f32 v244, v56, v57
v_cvt_pk_bf16_f32 v245, v58, v59
v_cvt_pk_bf16_f32 v246, v60, v61
v_cvt_pk_bf16_f32 v247, v62, v63
s_nop 1
v_permlane32_swap_b32 v240, v242
v_permlane32_swap_b32 v241, v243
v_permlane32_swap_b32 v244, v246
v_permlane32_swap_b32 v245, v247
s_add_u32 s53, s51, 0
buffer_store_dwordx4 v[240:243], v35, s[40:43], s53 offen offset:0
buffer_store_dwordx4 v[244:247], v35, s[40:43], s53 offen offset:32
s_waitcnt vmcnt(2)
v_lshlrev_b32 v128, 16, v208
v_and_b32 v129, 0xffff0000, v208
v_lshlrev_b32 v130, 16, v209
v_and_b32 v131, 0xffff0000, v209
v_lshlrev_b32 v132, 16, v210
v_and_b32 v133, 0xffff0000, v210
v_lshlrev_b32 v134, 16, v211
v_and_b32 v135, 0xffff0000, v211
v_lshlrev_b32 v136, 16, v212
v_and_b32 v137, 0xffff0000, v212
v_lshlrev_b32 v138, 16, v213
v_and_b32 v139, 0xffff0000, v213
v_lshlrev_b32 v140, 16, v214
v_and_b32 v141, 0xffff0000, v214
v_lshlrev_b32 v142, 16, v215
v_and_b32 v143, 0xffff0000, v215
v_lshlrev_b32 v144, 16, v216
v_and_b32 v145, 0xffff0000, v216
v_lshlrev_b32 v146, 16, v217
v_and_b32 v147, 0xffff0000, v217
v_lshlrev_b32 v148, 16, v218
v_and_b32 v149, 0xffff0000, v218
v_lshlrev_b32 v150, 16, v219
v_and_b32 v151, 0xffff0000, v219
v_lshlrev_b32 v152, 16, v220
v_and_b32 v153, 0xffff0000, v220
v_lshlrev_b32 v154, 16, v221
v_and_b32 v155, 0xffff0000, v221
v_lshlrev_b32 v156, 16, v222
v_and_b32 v157, 0xffff0000, v222
v_lshlrev_b32 v158, 16, v223
v_and_b32 v159, 0xffff0000, v223
v_add_f32 v128, v128, v144
v_add_f32 v129, v129, v145
v_add_f32 v130, v130, v146
v_add_f32 v131, v131, v147
v_add_f32 v132, v132, v148
v_add_f32 v133, v133, v149
v_add_f32 v134, v134, v150
v_add_f32 v135, v135, v151
v_add_f32 v136, v136, v152
v_add_f32 v137, v137, v153
v_add_f32 v138, v138, v154
v_add_f32 v139, v139, v155
v_add_f32 v140, v140, v156
v_add_f32 v141, v141, v157
v_add_f32 v142, v142, v158
v_add_f32 v143, v143, v159
v_lshlrev_b32 v144, 16, v224
v_and_b32 v145, 0xffff0000, v224
v_lshlrev_b32 v146, 16, v225
v_and_b32 v147, 0xffff0000, v225
v_lshlrev_b32 v148, 16, v226
v_and_b32 v149, 0xffff0000, v226
v_lshlrev_b32 v150, 16, v227
v_and_b32 v151, 0xffff0000, v227
v_lshlrev_b32 v152, 16, v228
v_and_b32 v153, 0xffff0000, v228
v_lshlrev_b32 v154, 16, v229
v_and_b32 v155, 0xffff0000, v229
v_lshlrev_b32 v156, 16, v230
v_and_b32 v157, 0xffff0000, v230
v_lshlrev_b32 v158, 16, v231
v_and_b32 v159, 0xffff0000, v231
v_add_f32 v128, v128, v144
v_add_f32 v129, v129, v145
v_add_f32 v130, v130, v146
v_add_f32 v131, v131, v147
v_add_f32 v132, v132, v148
v_add_f32 v133, v133, v149
v_add_f32 v134, v134, v150
v_add_f32 v135, v135, v151
v_add_f32 v136, v136, v152
v_add_f32 v137, v137, v153
v_add_f32 v138, v138, v154
v_add_f32 v139, v139, v155
v_add_f32 v140, v140, v156
v_add_f32 v141, v141, v157
v_add_f32 v142, v142, v158
v_add_f32 v143, v143, v159
v_lshlrev_b32 v144, 16, v232
v_and_b32 v145, 0xffff0000, v232
v_lshlrev_b32 v146, 16, v233
v_and_b32 v147, 0xffff0000, v233
v_lshlrev_b32 v148, 16, v234
v_and_b32 v149, 0xffff0000, v234
v_lshlrev_b32 v150, 16, v235
v_and_b32 v151, 0xffff0000, v235
v_lshlrev_b32 v152, 16, v236
v_and_b32 v153, 0xffff0000, v236
v_lshlrev_b32 v154, 16, v237
v_and_b32 v155, 0xffff0000, v237
v_lshlrev_b32 v156, 16, v238
v_and_b32 v157, 0xffff0000, v238
v_lshlrev_b32 v158, 16, v239
v_and_b32 v159, 0xffff0000, v239
v_add_f32 v128, v128, v144
v_add_f32 v129, v129, v145
v_add_f32 v130, v130, v146
v_add_f32 v131, v131, v147
v_add_f32 v132, v132, v148
v_add_f32 v133, v133, v149
v_add_f32 v134, v134, v150
v_add_f32 v135, v135, v151
v_add_f32 v136, v136, v152
v_add_f32 v137, v137, v153
v_add_f32 v138, v138, v154
v_add_f32 v139, v139, v155
v_add_f32 v140, v140, v156
v_add_f32 v141, v141, v157
v_add_f32 v142, v142, v158
v_add_f32 v143, v143, v159
v_cvt_pk_bf16_f32 v248, v128, v129
v_cvt_pk_bf16_f32 v249, v130, v131
v_cvt_pk_bf16_f32 v250, v132, v133
v_cvt_pk_bf16_f32 v251, v134, v135
v_cvt_pk_bf16_f32 v252, v136, v137
v_cvt_pk_bf16_f32 v253, v138, v139
v_cvt_pk_bf16_f32 v254, v140, v141
v_cvt_pk_bf16_f32 v255, v142, v143
s_nop 1
v_permlane32_swap_b32 v248, v250
v_permlane32_swap_b32 v249, v251
v_permlane32_swap_b32 v252, v254
v_permlane32_swap_b32 v253, v255
s_add_u32 s53, s51, 65536
buffer_store_dwordx4 v[248:251], v35, s[40:43], s53 offen offset:0
buffer_store_dwordx4 v[252:255], v35, s[40:43], s53 offen offset:32
s_waitcnt vmcnt(0)
L_next:
s_cmp_eq_u32 s38, 0
s_cbranch_scc1 L_fin
s_ff1_i32_b32 s37, s38
s_lshl_b32 s39, 1, s37
s_andn2_b32 s38, s38, s39
s_branch L_quarter
L_fin:
L_end:
s_endpgm
L_rare_l7:
v_max_f32 v35, v35, v29
v_sub_f32 v33, v29, v35
v_mul_f32 v33, s62, v33
v_exp_f32 v33, v33
v_mov_b32 v29, v35
v_add_f32 v30, s67, v35
v_mul_f32 v31, s62, v35
v_mov_b32 v34, v33
v_mov_b32 v32, v31
s_nop 1
v_permlane32_swap_b32 v33, v34
v_permlane32_swap_b32 v31, v32
s_nop 1
v_mul_f32 v40, v40, v33
v_mul_f32 v41, v41, v33
v_mul_f32 v42, v42, v33
v_mul_f32 v43, v43, v33
v_mul_f32 v44, v44, v34
v_mul_f32 v45, v45, v34
v_mul_f32 v46, v46, v34
v_mul_f32 v47, v47, v34
v_accvgpr_read_b32 v240, a0
v_accvgpr_read_b32 v241, a1
v_accvgpr_read_b32 v242, a2
v_accvgpr_read_b32 v243, a3
v_accvgpr_read_b32 v244, a4
v_accvgpr_read_b32 v245, a5
v_accvgpr_read_b32 v246, a6
v_accvgpr_read_b32 v247, a7
v_accvgpr_read_b32 v248, a8
v_accvgpr_read_b32 v249, a9
v_accvgpr_read_b32 v250, a10
v_accvgpr_read_b32 v251, a11
v_accvgpr_read_b32 v252, a12
v_accvgpr_read_b32 v253, a13
v_accvgpr_read_b32 v254, a14
v_accvgpr_read_b32 v255, a15
v_mul_f32 v240, v240, v33
v_mul_f32 v241, v241, v33
v_mul_f32 v242, v242, v33
v_mul_f32 v243, v243, v33
v_mul_f32 v244, v244, v33
v_mul_f32 v245, v245, v33
v_mul_f32 v246, v246, v33
v_mul_f32 v247, v247, v33
v_mul_f32 v248, v248, v33
v_mul_f32 v249, v249, v33
v_mul_f32 v250, v250, v33
v_mul_f32 v251, v251, v33
v_mul_f32 v252, v252, v33
v_mul_f32 v253, v253, v33
v_mul_f32 v254, v254, v33
v_mul_f32 v255, v255, v33
v_accvgpr_write_b32 a0, v240
v_accvgpr_write_b32 a1, v241
v_accvgpr_write_b32 a2, v242
v_accvgpr_write_b32 a3, v243
v_accvgpr_write_b32 a4, v244
v_accvgpr_write_b32 a5, v245
v_accvgpr_write_b32 a6, v246
v_accvgpr_write_b32 a7, v247
v_accvgpr_write_b32 a8, v248
v_accvgpr_write_b32 a9, v249
v_accvgpr_write_b32 a10, v250
v_accvgpr_write_b32 a11, v251
v_accvgpr_write_b32 a12, v252
v_accvgpr_write_b32 a13, v253
v_accvgpr_write_b32 a14, v254
v_accvgpr_write_b32 a15, v255
v_accvgpr_read_b32 v240, a16
v_accvgpr_read_b32 v241, a17
v_accvgpr_read_b32 v242, a18
v_accvgpr_read_b32 v243, a19
v_accvgpr_read_b32 v244, a20
v_accvgpr_read_b32 v245, a21
v_accvgpr_read_b32 v246, a22
v_accvgpr_read_b32 v247, a23
v_accvgpr_read_b32 v248, a24
v_accvgpr_read_b32 v249, a25
v_accvgpr_read_b32 v250, a26
v_accvgpr_read_b32 v251, a27
v_accvgpr_read_b32 v252, a28
v_accvgpr_read_b32 v253, a29
v_accvgpr_read_b32 v254, a30
v_accvgpr_read_b32 v255, a31
v_mul_f32 v240, v240, v34
v_mul_f32 v241, v241, v34
v_mul_f32 v242, v242, v34
v_mul_f32 v243, v243, v34
v_mul_f32 v244, v244, v34
v_mul_f32 v245, v245, v34
v_mul_f32 v246, v246, v34
v_mul_f32 v247, v247, v34
v_mul_f32 v248, v248, v34
v_mul_f32 v249, v249, v34
v_mul_f32 v250, v250, v34
v_mul_f32 v251, v251, v34
v_mul_f32 v252, v252, v34
v_mul_f32 v253, v253, v34
v_mul_f32 v254, v254, v34
v_mul_f32 v255, v255, v34
v_accvgpr_write_b32 a16, v240
v_accvgpr_write_b32 a17, v241
v_accvgpr_write_b32 a18, v242
v_accvgpr_write_b32 a19, v243
v_accvgpr_write_b32 a20, v244
v_accvgpr_write_b32 a21, v245
v_accvgpr_write_b32 a22, v246
v_accvgpr_write_b32 a23, v247
v_accvgpr_write_b32 a24, v248
v_accvgpr_write_b32 a25, v249
v_accvgpr_write_b32 a26, v250
v_accvgpr_write_b32 a27, v251
v_accvgpr_write_b32 a28, v252
v_accvgpr_write_b32 a29, v253
v_accvgpr_write_b32 a30, v254
v_accvgpr_write_b32 a31, v255
v_accvgpr_read_b32 v240, a32
v_accvgpr_read_b32 v241, a33
v_accvgpr_read_b32 v242, a34
v_accvgpr_read_b32 v243, a35
v_accvgpr_read_b32 v244, a36
v_accvgpr_read_b32 v245, a37
v_accvgpr_read_b32 v246, a38
v_accvgpr_read_b32 v247, a39
v_accvgpr_read_b32 v248, a40
v_accvgpr_read_b32 v249, a41
v_accvgpr_read_b32 v250, a42
v_accvgpr_read_b32 v251, a43
v_accvgpr_read_b32 v252, a44
v_accvgpr_read_b32 v253, a45
v_accvgpr_read_b32 v254, a46
v_accvgpr_read_b32 v255, a47
v_mul_f32 v240, v240, v33
v_mul_f32 v241, v241, v33
v_mul_f32 v242, v242, v33
v_mul_f32 v243, v243, v33
v_mul_f32 v244, v244, v33
v_mul_f32 v245, v245, v33
v_mul_f32 v246, v246, v33
v_mul_f32 v247, v247, v33
v_mul_f32 v248, v248, v33
v_mul_f32 v249, v249, v33
v_mul_f32 v250, v250, v33
v_mul_f32 v251, v251, v33
v_mul_f32 v252, v252, v33
v_mul_f32 v253, v253, v33
v_mul_f32 v254, v254, v33
v_mul_f32 v255, v255, v33
v_accvgpr_write_b32 a32, v240
v_accvgpr_write_b32 a33, v241
v_accvgpr_write_b32 a34, v242
v_accvgpr_write_b32 a35, v243
v_accvgpr_write_b32 a36, v244
v_accvgpr_write_b32 a37, v245
v_accvgpr_write_b32 a38, v246
v_accvgpr_write_b32 a39, v247
v_accvgpr_write_b32 a40, v248
v_accvgpr_write_b32 a41, v249
v_accvgpr_write_b32 a42, v250
v_accvgpr_write_b32 a43, v251
v_accvgpr_write_b32 a44, v252
v_accvgpr_write_b32 a45, v253
v_accvgpr_write_b32 a46, v254
v_accvgpr_write_b32 a47, v255
v_accvgpr_read_b32 v240, a48
v_accvgpr_read_b32 v241, a49
v_accvgpr_read_b32 v242, a50
v_accvgpr_read_b32 v243, a51
v_accvgpr_read_b32 v244, a52
v_accvgpr_read_b32 v245, a53
v_accvgpr_read_b32 v246, a54
v_accvgpr_read_b32 v247, a55
v_accvgpr_read_b32 v248, a56
v_accvgpr_read_b32 v249, a57
v_accvgpr_read_b32 v250, a58
v_accvgpr_read_b32 v251, a59
v_accvgpr_read_b32 v252, a60
v_accvgpr_read_b32 v253, a61
v_accvgpr_read_b32 v254, a62
v_accvgpr_read_b32 v255, a63
v_mul_f32 v240, v240, v34
v_mul_f32 v241, v241, v34
v_mul_f32 v242, v242, v34
v_mul_f32 v243, v243, v34
v_mul_f32 v244, v244, v34
v_mul_f32 v245, v245, v34
v_mul_f32 v246, v246, v34
v_mul_f32 v247, v247, v34
v_mul_f32 v248, v248, v34
v_mul_f32 v249, v249, v34
v_mul_f32 v250, v250, v34
v_mul_f32 v251, v251, v34
v_mul_f32 v252, v252, v34
v_mul_f32 v253, v253, v34
v_mul_f32 v254, v254, v34
v_mul_f32 v255, v255, v34
v_accvgpr_write_b32 a48, v240
v_accvgpr_write_b32 a49, v241
v_accvgpr_write_b32 a50, v242
v_accvgpr_write_b32 a51, v243
v_accvgpr_write_b32 a52, v244
v_accvgpr_write_b32 a53, v245
v_accvgpr_write_b32 a54, v246
v_accvgpr_write_b32 a55, v247
v_accvgpr_write_b32 a56, v248
v_accvgpr_write_b32 a57, v249
v_accvgpr_write_b32 a58, v250
v_accvgpr_write_b32 a59, v251
v_accvgpr_write_b32 a60, v252
v_accvgpr_write_b32 a61, v253
v_accvgpr_write_b32 a62, v254
v_accvgpr_write_b32 a63, v255
v_accvgpr_read_b32 v240, a64
v_accvgpr_read_b32 v241, a65
v_accvgpr_read_b32 v242, a66
v_accvgpr_read_b32 v243, a67
v_accvgpr_read_b32 v244, a68
v_accvgpr_read_b32 v245, a69
v_accvgpr_read_b32 v246, a70
v_accvgpr_read_b32 v247, a71
v_accvgpr_read_b32 v248, a72
v_accvgpr_read_b32 v249, a73
v_accvgpr_read_b32 v250, a74
v_accvgpr_read_b32 v251, a75
v_accvgpr_read_b32 v252, a76
v_accvgpr_read_b32 v253, a77
v_accvgpr_read_b32 v254, a78
v_accvgpr_read_b32 v255, a79
v_mul_f32 v240, v240, v33
v_mul_f32 v241, v241, v33
v_mul_f32 v242, v242, v33
v_mul_f32 v243, v243, v33
v_mul_f32 v244, v244, v33
v_mul_f32 v245, v245, v33
v_mul_f32 v246, v246, v33
v_mul_f32 v247, v247, v33
v_mul_f32 v248, v248, v33
v_mul_f32 v249, v249, v33
v_mul_f32 v250, v250, v33
v_mul_f32 v251, v251, v33
v_mul_f32 v252, v252, v33
v_mul_f32 v253, v253, v33
v_mul_f32 v254, v254, v33
v_mul_f32 v255, v255, v33
v_accvgpr_write_b32 a64, v240
v_accvgpr_write_b32 a65, v241
v_accvgpr_write_b32 a66, v242
v_accvgpr_write_b32 a67, v243
v_accvgpr_write_b32 a68, v244
v_accvgpr_write_b32 a69, v245
v_accvgpr_write_b32 a70, v246
v_accvgpr_write_b32 a71, v247
v_accvgpr_write_b32 a72, v248
v_accvgpr_write_b32 a73, v249
v_accvgpr_write_b32 a74, v250
v_accvgpr_write_b32 a75, v251
v_accvgpr_write_b32 a76, v252
v_accvgpr_write_b32 a77, v253
v_accvgpr_write_b32 a78, v254
v_accvgpr_write_b32 a79, v255
v_accvgpr_read_b32 v240, a80
v_accvgpr_read_b32 v241, a81
v_accvgpr_read_b32 v242, a82
v_accvgpr_read_b32 v243, a83
v_accvgpr_read_b32 v244, a84
v_accvgpr_read_b32 v245, a85
v_accvgpr_read_b32 v246, a86
v_accvgpr_read_b32 v247, a87
v_accvgpr_read_b32 v248, a88
v_accvgpr_read_b32 v249, a89
v_accvgpr_read_b32 v250, a90
v_accvgpr_read_b32 v251, a91
v_accvgpr_read_b32 v252, a92
v_accvgpr_read_b32 v253, a93
v_accvgpr_read_b32 v254, a94
v_accvgpr_read_b32 v255, a95
v_mul_f32 v240, v240, v34
v_mul_f32 v241, v241, v34
v_mul_f32 v242, v242, v34
v_mul_f32 v243, v243, v34
v_mul_f32 v244, v244, v34
v_mul_f32 v245, v245, v34
v_mul_f32 v246, v246, v34
v_mul_f32 v247, v247, v34
v_mul_f32 v248, v248, v34
v_mul_f32 v249, v249, v34
v_mul_f32 v250, v250, v34
v_mul_f32 v251, v251, v34
v_mul_f32 v252, v252, v34
v_mul_f32 v253, v253, v34
v_mul_f32 v254, v254, v34
v_mul_f32 v255, v255, v34
v_accvgpr_write_b32 a80, v240
v_accvgpr_write_b32 a81, v241
v_accvgpr_write_b32 a82, v242
v_accvgpr_write_b32 a83, v243
v_accvgpr_write_b32 a84, v244
v_accvgpr_write_b32 a85, v245
v_accvgpr_write_b32 a86, v246
v_accvgpr_write_b32 a87, v247
v_accvgpr_write_b32 a88, v248
v_accvgpr_write_b32 a89, v249
v_accvgpr_write_b32 a90, v250
v_accvgpr_write_b32 a91, v251
v_accvgpr_write_b32 a92, v252
v_accvgpr_write_b32 a93, v253
v_accvgpr_write_b32 a94, v254
v_accvgpr_write_b32 a95, v255
v_accvgpr_read_b32 v240, a96
v_accvgpr_read_b32 v241, a97
v_accvgpr_read_b32 v242, a98
v_accvgpr_read_b32 v243, a99
v_accvgpr_read_b32 v244, a100
v_accvgpr_read_b32 v245, a101
v_accvgpr_read_b32 v246, a102
v_accvgpr_read_b32 v247, a103
v_accvgpr_read_b32 v248, a104
v_accvgpr_read_b32 v249, a105
v_accvgpr_read_b32 v250, a106
v_accvgpr_read_b32 v251, a107
v_accvgpr_read_b32 v252, a108
v_accvgpr_read_b32 v253, a109
v_accvgpr_read_b32 v254, a110
v_accvgpr_read_b32 v255, a111
v_mul_f32 v240, v240, v33
v_mul_f32 v241, v241, v33
v_mul_f32 v242, v242, v33
v_mul_f32 v243, v243, v33
v_mul_f32 v244, v244, v33
v_mul_f32 v245, v245, v33
v_mul_f32 v246, v246, v33
v_mul_f32 v247, v247, v33
v_mul_f32 v248, v248, v33
v_mul_f32 v249, v249, v33
v_mul_f32 v250, v250, v33
v_mul_f32 v251, v251, v33
v_mul_f32 v252, v252, v33
v_mul_f32 v253, v253, v33
v_mul_f32 v254, v254, v33
v_mul_f32 v255, v255, v33
v_accvgpr_write_b32 a96, v240
v_accvgpr_write_b32 a97, v241
v_accvgpr_write_b32 a98, v242
v_accvgpr_write_b32 a99, v243
v_accvgpr_write_b32 a100, v244
v_accvgpr_write_b32 a101, v245
v_accvgpr_write_b32 a102, v246
v_accvgpr_write_b32 a103, v247
v_accvgpr_write_b32 a104, v248
v_accvgpr_write_b32 a105, v249
v_accvgpr_write_b32 a106, v250
v_accvgpr_write_b32 a107, v251
v_accvgpr_write_b32 a108, v252
v_accvgpr_write_b32 a109, v253
v_accvgpr_write_b32 a110, v254
v_accvgpr_write_b32 a111, v255
v_accvgpr_read_b32 v240, a112
v_accvgpr_read_b32 v241, a113
v_accvgpr_read_b32 v242, a114
v_accvgpr_read_b32 v243, a115
v_accvgpr_read_b32 v244, a116
v_accvgpr_read_b32 v245, a117
v_accvgpr_read_b32 v246, a118
v_accvgpr_read_b32 v247, a119
v_accvgpr_read_b32 v248, a120
v_accvgpr_read_b32 v249, a121
v_accvgpr_read_b32 v250, a122
v_accvgpr_read_b32 v251, a123
v_accvgpr_read_b32 v252, a124
v_accvgpr_read_b32 v253, a125
v_accvgpr_read_b32 v254, a126
v_accvgpr_read_b32 v255, a127
v_mul_f32 v240, v240, v34
v_mul_f32 v241, v241, v34
v_mul_f32 v242, v242, v34
v_mul_f32 v243, v243, v34
v_mul_f32 v244, v244, v34
v_mul_f32 v245, v245, v34
v_mul_f32 v246, v246, v34
v_mul_f32 v247, v247, v34
v_mul_f32 v248, v248, v34
v_mul_f32 v249, v249, v34
v_mul_f32 v250, v250, v34
v_mul_f32 v251, v251, v34
v_mul_f32 v252, v252, v34
v_mul_f32 v253, v253, v34
v_mul_f32 v254, v254, v34
v_mul_f32 v255, v255, v34
v_accvgpr_write_b32 a112, v240
v_accvgpr_write_b32 a113, v241
v_accvgpr_write_b32 a114, v242
v_accvgpr_write_b32 a115, v243
v_accvgpr_write_b32 a116, v244
v_accvgpr_write_b32 a117, v245
v_accvgpr_write_b32 a118, v246
v_accvgpr_write_b32 a119, v247
v_accvgpr_write_b32 a120, v248
v_accvgpr_write_b32 a121, v249
v_accvgpr_write_b32 a122, v250
v_accvgpr_write_b32 a123, v251
v_accvgpr_write_b32 a124, v252
v_accvgpr_write_b32 a125, v253
v_accvgpr_write_b32 a126, v254
v_accvgpr_write_b32 a127, v255
s_nop 1
s_branch L_back_l7
L_rare_l8:
v_max_f32 v35, v35, v29
v_sub_f32 v33, v29, v35
v_mul_f32 v33, s62, v33
v_exp_f32 v33, v33
v_mov_b32 v29, v35
v_add_f32 v30, s67, v35
v_mul_f32 v31, s62, v35
v_mov_b32 v34, v33
v_mov_b32 v32, v31
s_nop 1
v_permlane32_swap_b32 v33, v34
v_permlane32_swap_b32 v31, v32
s_nop 1
v_mul_f32 v40, v40, v33
v_mul_f32 v41, v41, v33
v_mul_f32 v42, v42, v33
v_mul_f32 v43, v43, v33
v_mul_f32 v44, v44, v34
v_mul_f32 v45, v45, v34
v_mul_f32 v46, v46, v34
v_mul_f32 v47, v47, v34
v_accvgpr_read_b32 v240, a0
v_accvgpr_read_b32 v241, a1
v_accvgpr_read_b32 v242, a2
v_accvgpr_read_b32 v243, a3
v_accvgpr_read_b32 v244, a4
v_accvgpr_read_b32 v245, a5
v_accvgpr_read_b32 v246, a6
v_accvgpr_read_b32 v247, a7
v_accvgpr_read_b32 v248, a8
v_accvgpr_read_b32 v249, a9
v_accvgpr_read_b32 v250, a10
v_accvgpr_read_b32 v251, a11
v_accvgpr_read_b32 v252, a12
v_accvgpr_read_b32 v253, a13
v_accvgpr_read_b32 v254, a14
v_accvgpr_read_b32 v255, a15
v_mul_f32 v240, v240, v33
v_mul_f32 v241, v241, v33
v_mul_f32 v242, v242, v33
v_mul_f32 v243, v243, v33
v_mul_f32 v244, v244, v33
v_mul_f32 v245, v245, v33
v_mul_f32 v246, v246, v33
v_mul_f32 v247, v247, v33
v_mul_f32 v248, v248, v33
v_mul_f32 v249, v249, v33
v_mul_f32 v250, v250, v33
v_mul_f32 v251, v251, v33
v_mul_f32 v252, v252, v33
v_mul_f32 v253, v253, v33
v_mul_f32 v254, v254, v33
v_mul_f32 v255, v255, v33
v_accvgpr_write_b32 a0, v240
v_accvgpr_write_b32 a1, v241
v_accvgpr_write_b32 a2, v242
v_accvgpr_write_b32 a3, v243
v_accvgpr_write_b32 a4, v244
v_accvgpr_write_b32 a5, v245
v_accvgpr_write_b32 a6, v246
v_accvgpr_write_b32 a7, v247
v_accvgpr_write_b32 a8, v248
v_accvgpr_write_b32 a9, v249
v_accvgpr_write_b32 a10, v250
v_accvgpr_write_b32 a11, v251
v_accvgpr_write_b32 a12, v252
v_accvgpr_write_b32 a13, v253
v_accvgpr_write_b32 a14, v254
v_accvgpr_write_b32 a15, v255
v_accvgpr_read_b32 v240, a16
v_accvgpr_read_b32 v241, a17
v_accvgpr_read_b32 v242, a18
v_accvgpr_read_b32 v243, a19
v_accvgpr_read_b32 v244, a20
v_accvgpr_read_b32 v245, a21
v_accvgpr_read_b32 v246, a22
v_accvgpr_read_b32 v247, a23
v_accvgpr_read_b32 v248, a24
v_accvgpr_read_b32 v249, a25
v_accvgpr_read_b32 v250, a26
v_accvgpr_read_b32 v251, a27
v_accvgpr_read_b32 v252, a28
v_accvgpr_read_b32 v253, a29
v_accvgpr_read_b32 v254, a30
v_accvgpr_read_b32 v255, a31
v_mul_f32 v240, v240, v34
v_mul_f32 v241, v241, v34
v_mul_f32 v242, v242, v34
v_mul_f32 v243, v243, v34
v_mul_f32 v244, v244, v34
v_mul_f32 v245, v245, v34
v_mul_f32 v246, v246, v34
v_mul_f32 v247, v247, v34
v_mul_f32 v248, v248, v34
v_mul_f32 v249, v249, v34
v_mul_f32 v250, v250, v34
v_mul_f32 v251, v251, v34
v_mul_f32 v252, v252, v34
v_mul_f32 v253, v253, v34
v_mul_f32 v254, v254, v34
v_mul_f32 v255, v255, v34
v_accvgpr_write_b32 a16, v240
v_accvgpr_write_b32 a17, v241
v_accvgpr_write_b32 a18, v242
v_accvgpr_write_b32 a19, v243
v_accvgpr_write_b32 a20, v244
v_accvgpr_write_b32 a21, v245
v_accvgpr_write_b32 a22, v246
v_accvgpr_write_b32 a23, v247
v_accvgpr_write_b32 a24, v248
v_accvgpr_write_b32 a25, v249
v_accvgpr_write_b32 a26, v250
v_accvgpr_write_b32 a27, v251
v_accvgpr_write_b32 a28, v252
v_accvgpr_write_b32 a29, v253
v_accvgpr_write_b32 a30, v254
v_accvgpr_write_b32 a31, v255
v_accvgpr_read_b32 v240, a32
v_accvgpr_read_b32 v241, a33
v_accvgpr_read_b32 v242, a34
v_accvgpr_read_b32 v243, a35
v_accvgpr_read_b32 v244, a36
v_accvgpr_read_b32 v245, a37
v_accvgpr_read_b32 v246, a38
v_accvgpr_read_b32 v247, a39
v_accvgpr_read_b32 v248, a40
v_accvgpr_read_b32 v249, a41
v_accvgpr_read_b32 v250, a42
v_accvgpr_read_b32 v251, a43
v_accvgpr_read_b32 v252, a44
v_accvgpr_read_b32 v253, a45
v_accvgpr_read_b32 v254, a46
v_accvgpr_read_b32 v255, a47
v_mul_f32 v240, v240, v33
v_mul_f32 v241, v241, v33
v_mul_f32 v242, v242, v33
v_mul_f32 v243, v243, v33
v_mul_f32 v244, v244, v33
v_mul_f32 v245, v245, v33
v_mul_f32 v246, v246, v33
v_mul_f32 v247, v247, v33
v_mul_f32 v248, v248, v33
v_mul_f32 v249, v249, v33
v_mul_f32 v250, v250, v33
v_mul_f32 v251, v251, v33
v_mul_f32 v252, v252, v33
v_mul_f32 v253, v253, v33
v_mul_f32 v254, v254, v33
v_mul_f32 v255, v255, v33
v_accvgpr_write_b32 a32, v240
v_accvgpr_write_b32 a33, v241
v_accvgpr_write_b32 a34, v242
v_accvgpr_write_b32 a35, v243
v_accvgpr_write_b32 a36, v244
v_accvgpr_write_b32 a37, v245
v_accvgpr_write_b32 a38, v246
v_accvgpr_write_b32 a39, v247
v_accvgpr_write_b32 a40, v248
v_accvgpr_write_b32 a41, v249
v_accvgpr_write_b32 a42, v250
v_accvgpr_write_b32 a43, v251
v_accvgpr_write_b32 a44, v252
v_accvgpr_write_b32 a45, v253
v_accvgpr_write_b32 a46, v254
v_accvgpr_write_b32 a47, v255
v_accvgpr_read_b32 v240, a48
v_accvgpr_read_b32 v241, a49
v_accvgpr_read_b32 v242, a50
v_accvgpr_read_b32 v243, a51
v_accvgpr_read_b32 v244, a52
v_accvgpr_read_b32 v245, a53
v_accvgpr_read_b32 v246, a54
v_accvgpr_read_b32 v247, a55
v_accvgpr_read_b32 v248, a56
v_accvgpr_read_b32 v249, a57
v_accvgpr_read_b32 v250, a58
v_accvgpr_read_b32 v251, a59
v_accvgpr_read_b32 v252, a60
v_accvgpr_read_b32 v253, a61
v_accvgpr_read_b32 v254, a62
v_accvgpr_read_b32 v255, a63
v_mul_f32 v240, v240, v34
v_mul_f32 v241, v241, v34
v_mul_f32 v242, v242, v34
v_mul_f32 v243, v243, v34
v_mul_f32 v244, v244, v34
v_mul_f32 v245, v245, v34
v_mul_f32 v246, v246, v34
v_mul_f32 v247, v247, v34
v_mul_f32 v248, v248, v34
v_mul_f32 v249, v249, v34
v_mul_f32 v250, v250, v34
v_mul_f32 v251, v251, v34
v_mul_f32 v252, v252, v34
v_mul_f32 v253, v253, v34
v_mul_f32 v254, v254, v34
v_mul_f32 v255, v255, v34
v_accvgpr_write_b32 a48, v240
v_accvgpr_write_b32 a49, v241
v_accvgpr_write_b32 a50, v242
v_accvgpr_write_b32 a51, v243
v_accvgpr_write_b32 a52, v244
v_accvgpr_write_b32 a53, v245
v_accvgpr_write_b32 a54, v246
v_accvgpr_write_b32 a55, v247
v_accvgpr_write_b32 a56, v248
v_accvgpr_write_b32 a57, v249
v_accvgpr_write_b32 a58, v250
v_accvgpr_write_b32 a59, v251
v_accvgpr_write_b32 a60, v252
v_accvgpr_write_b32 a61, v253
v_accvgpr_write_b32 a62, v254
v_accvgpr_write_b32 a63, v255
v_accvgpr_read_b32 v240, a64
v_accvgpr_read_b32 v241, a65
v_accvgpr_read_b32 v242, a66
v_accvgpr_read_b32 v243, a67
v_accvgpr_read_b32 v244, a68
v_accvgpr_read_b32 v245, a69
v_accvgpr_read_b32 v246, a70
v_accvgpr_read_b32 v247, a71
v_accvgpr_read_b32 v248, a72
v_accvgpr_read_b32 v249, a73
v_accvgpr_read_b32 v250, a74
v_accvgpr_read_b32 v251, a75
v_accvgpr_read_b32 v252, a76
v_accvgpr_read_b32 v253, a77
v_accvgpr_read_b32 v254, a78
v_accvgpr_read_b32 v255, a79
v_mul_f32 v240, v240, v33
v_mul_f32 v241, v241, v33
v_mul_f32 v242, v242, v33
v_mul_f32 v243, v243, v33
v_mul_f32 v244, v244, v33
v_mul_f32 v245, v245, v33
v_mul_f32 v246, v246, v33
v_mul_f32 v247, v247, v33
v_mul_f32 v248, v248, v33
v_mul_f32 v249, v249, v33
v_mul_f32 v250, v250, v33
v_mul_f32 v251, v251, v33
v_mul_f32 v252, v252, v33
v_mul_f32 v253, v253, v33
v_mul_f32 v254, v254, v33
v_mul_f32 v255, v255, v33
v_accvgpr_write_b32 a64, v240
v_accvgpr_write_b32 a65, v241
v_accvgpr_write_b32 a66, v242
v_accvgpr_write_b32 a67, v243
v_accvgpr_write_b32 a68, v244
v_accvgpr_write_b32 a69, v245
v_accvgpr_write_b32 a70, v246
v_accvgpr_write_b32 a71, v247
v_accvgpr_write_b32 a72, v248
v_accvgpr_write_b32 a73, v249
v_accvgpr_write_b32 a74, v250
v_accvgpr_write_b32 a75, v251
v_accvgpr_write_b32 a76, v252
v_accvgpr_write_b32 a77, v253
v_accvgpr_write_b32 a78, v254
v_accvgpr_write_b32 a79, v255
v_accvgpr_read_b32 v240, a80
v_accvgpr_read_b32 v241, a81
v_accvgpr_read_b32 v242, a82
v_accvgpr_read_b32 v243, a83
v_accvgpr_read_b32 v244, a84
v_accvgpr_read_b32 v245, a85
v_accvgpr_read_b32 v246, a86
v_accvgpr_read_b32 v247, a87
v_accvgpr_read_b32 v248, a88
v_accvgpr_read_b32 v249, a89
v_accvgpr_read_b32 v250, a90
v_accvgpr_read_b32 v251, a91
v_accvgpr_read_b32 v252, a92
v_accvgpr_read_b32 v253, a93
v_accvgpr_read_b32 v254, a94
v_accvgpr_read_b32 v255, a95
v_mul_f32 v240, v240, v34
v_mul_f32 v241, v241, v34
v_mul_f32 v242, v242, v34
v_mul_f32 v243, v243, v34
v_mul_f32 v244, v244, v34
v_mul_f32 v245, v245, v34
v_mul_f32 v246, v246, v34
v_mul_f32 v247, v247, v34
v_mul_f32 v248, v248, v34
v_mul_f32 v249, v249, v34
v_mul_f32 v250, v250, v34
v_mul_f32 v251, v251, v34
v_mul_f32 v252, v252, v34
v_mul_f32 v253, v253, v34
v_mul_f32 v254, v254, v34
v_mul_f32 v255, v255, v34
v_accvgpr_write_b32 a80, v240
v_accvgpr_write_b32 a81, v241
v_accvgpr_write_b32 a82, v242
v_accvgpr_write_b32 a83, v243
v_accvgpr_write_b32 a84, v244
v_accvgpr_write_b32 a85, v245
v_accvgpr_write_b32 a86, v246
v_accvgpr_write_b32 a87, v247
v_accvgpr_write_b32 a88, v248
v_accvgpr_write_b32 a89, v249
v_accvgpr_write_b32 a90, v250
v_accvgpr_write_b32 a91, v251
v_accvgpr_write_b32 a92, v252
v_accvgpr_write_b32 a93, v253
v_accvgpr_write_b32 a94, v254
v_accvgpr_write_b32 a95, v255
v_accvgpr_read_b32 v240, a96
v_accvgpr_read_b32 v241, a97
v_accvgpr_read_b32 v242, a98
v_accvgpr_read_b32 v243, a99
v_accvgpr_read_b32 v244, a100
v_accvgpr_read_b32 v245, a101
v_accvgpr_read_b32 v246, a102
v_accvgpr_read_b32 v247, a103
v_accvgpr_read_b32 v248, a104
v_accvgpr_read_b32 v249, a105
v_accvgpr_read_b32 v250, a106
v_accvgpr_read_b32 v251, a107
v_accvgpr_read_b32 v252, a108
v_accvgpr_read_b32 v253, a109
v_accvgpr_read_b32 v254, a110
v_accvgpr_read_b32 v255, a111
v_mul_f32 v240, v240, v33
v_mul_f32 v241, v241, v33
v_mul_f32 v242, v242, v33
v_mul_f32 v243, v243, v33
v_mul_f32 v244, v244, v33
v_mul_f32 v245, v245, v33
v_mul_f32 v246, v246, v33
v_mul_f32 v247, v247, v33
v_mul_f32 v248, v248, v33
v_mul_f32 v249, v249, v33
v_mul_f32 v250, v250, v33
v_mul_f32 v251, v251, v33
v_mul_f32 v252, v252, v33
v_mul_f32 v253, v253, v33
v_mul_f32 v254, v254, v33
v_mul_f32 v255, v255, v33
v_accvgpr_write_b32 a96, v240
v_accvgpr_write_b32 a97, v241
v_accvgpr_write_b32 a98, v242
v_accvgpr_write_b32 a99, v243
v_accvgpr_write_b32 a100, v244
v_accvgpr_write_b32 a101, v245
v_accvgpr_write_b32 a102, v246
v_accvgpr_write_b32 a103, v247
v_accvgpr_write_b32 a104, v248
v_accvgpr_write_b32 a105, v249
v_accvgpr_write_b32 a106, v250
v_accvgpr_write_b32 a107, v251
v_accvgpr_write_b32 a108, v252
v_accvgpr_write_b32 a109, v253
v_accvgpr_write_b32 a110, v254
v_accvgpr_write_b32 a111, v255
v_accvgpr_read_b32 v240, a112
v_accvgpr_read_b32 v241, a113
v_accvgpr_read_b32 v242, a114
v_accvgpr_read_b32 v243, a115
v_accvgpr_read_b32 v244, a116
v_accvgpr_read_b32 v245, a117
v_accvgpr_read_b32 v246, a118
v_accvgpr_read_b32 v247, a119
v_accvgpr_read_b32 v248, a120
v_accvgpr_read_b32 v249, a121
v_accvgpr_read_b32 v250, a122
v_accvgpr_read_b32 v251, a123
v_accvgpr_read_b32 v252, a124
v_accvgpr_read_b32 v253, a125
v_accvgpr_read_b32 v254, a126
v_accvgpr_read_b32 v255, a127
v_mul_f32 v240, v240, v34
v_mul_f32 v241, v241, v34
v_mul_f32 v242, v242, v34
v_mul_f32 v243, v243, v34
v_mul_f32 v244, v244, v34
v_mul_f32 v245, v245, v34
v_mul_f32 v246, v246, v34
v_mul_f32 v247, v247, v34
v_mul_f32 v248, v248, v34
v_mul_f32 v249, v249, v34
v_mul_f32 v250, v250, v34
v_mul_f32 v251, v251, v34
v_mul_f32 v252, v252, v34
v_mul_f32 v253, v253, v34
v_mul_f32 v254, v254, v34
v_mul_f32 v255, v255, v34
v_accvgpr_write_b32 a112, v240
v_accvgpr_write_b32 a113, v241
v_accvgpr_write_b32 a114, v242
v_accvgpr_write_b32 a115, v243
v_accvgpr_write_b32 a116, v244
v_accvgpr_write_b32 a117, v245
v_accvgpr_write_b32 a118, v246
v_accvgpr_write_b32 a119, v247
v_accvgpr_write_b32 a120, v248
v_accvgpr_write_b32 a121, v249
v_accvgpr_write_b32 a122, v250
v_accvgpr_write_b32 a123, v251
v_accvgpr_write_b32 a124, v252
v_accvgpr_write_b32 a125, v253
v_accvgpr_write_b32 a126, v254
v_accvgpr_write_b32 a127, v255
s_nop 1
s_branch L_back_l8
L_rare_l11:
v_max_f32 v35, v35, v29
v_sub_f32 v33, v29, v35
v_mul_f32 v33, s62, v33
v_exp_f32 v33, v33
v_mov_b32 v29, v35
v_add_f32 v30, s67, v35
v_mul_f32 v31, s62, v35
v_mov_b32 v34, v33
v_mov_b32 v32, v31
s_nop 1
v_permlane32_swap_b32 v33, v34
v_permlane32_swap_b32 v31, v32
s_nop 1
v_mul_f32 v40, v40, v33
v_mul_f32 v41, v41, v33
v_mul_f32 v42, v42, v33
v_mul_f32 v43, v43, v33
v_mul_f32 v44, v44, v34
v_mul_f32 v45, v45, v34
v_mul_f32 v46, v46, v34
v_mul_f32 v47, v47, v34
v_accvgpr_read_b32 v240, a0
v_accvgpr_read_b32 v241, a1
v_accvgpr_read_b32 v242, a2
v_accvgpr_read_b32 v243, a3
v_accvgpr_read_b32 v244, a4
v_accvgpr_read_b32 v245, a5
v_accvgpr_read_b32 v246, a6
v_accvgpr_read_b32 v247, a7
v_accvgpr_read_b32 v248, a8
v_accvgpr_read_b32 v249, a9
v_accvgpr_read_b32 v250, a10
v_accvgpr_read_b32 v251, a11
v_accvgpr_read_b32 v252, a12
v_accvgpr_read_b32 v253, a13
v_accvgpr_read_b32 v254, a14
v_accvgpr_read_b32 v255, a15
v_mul_f32 v240, v240, v33
v_mul_f32 v241, v241, v33
v_mul_f32 v242, v242, v33
v_mul_f32 v243, v243, v33
v_mul_f32 v244, v244, v33
v_mul_f32 v245, v245, v33
v_mul_f32 v246, v246, v33
v_mul_f32 v247, v247, v33
v_mul_f32 v248, v248, v33
v_mul_f32 v249, v249, v33
v_mul_f32 v250, v250, v33
v_mul_f32 v251, v251, v33
v_mul_f32 v252, v252, v33
v_mul_f32 v253, v253, v33
v_mul_f32 v254, v254, v33
v_mul_f32 v255, v255, v33
v_accvgpr_write_b32 a0, v240
v_accvgpr_write_b32 a1, v241
v_accvgpr_write_b32 a2, v242
v_accvgpr_write_b32 a3, v243
v_accvgpr_write_b32 a4, v244
v_accvgpr_write_b32 a5, v245
v_accvgpr_write_b32 a6, v246
v_accvgpr_write_b32 a7, v247
v_accvgpr_write_b32 a8, v248
v_accvgpr_write_b32 a9, v249
v_accvgpr_write_b32 a10, v250
v_accvgpr_write_b32 a11, v251
v_accvgpr_write_b32 a12, v252
v_accvgpr_write_b32 a13, v253
v_accvgpr_write_b32 a14, v254
v_accvgpr_write_b32 a15, v255
v_accvgpr_read_b32 v240, a16
v_accvgpr_read_b32 v241, a17
v_accvgpr_read_b32 v242, a18
v_accvgpr_read_b32 v243, a19
v_accvgpr_read_b32 v244, a20
v_accvgpr_read_b32 v245, a21
v_accvgpr_read_b32 v246, a22
v_accvgpr_read_b32 v247, a23
v_accvgpr_read_b32 v248, a24
v_accvgpr_read_b32 v249, a25
v_accvgpr_read_b32 v250, a26
v_accvgpr_read_b32 v251, a27
v_accvgpr_read_b32 v252, a28
v_accvgpr_read_b32 v253, a29
v_accvgpr_read_b32 v254, a30
v_accvgpr_read_b32 v255, a31
v_mul_f32 v240, v240, v34
v_mul_f32 v241, v241, v34
v_mul_f32 v242, v242, v34
v_mul_f32 v243, v243, v34
v_mul_f32 v244, v244, v34
v_mul_f32 v245, v245, v34
v_mul_f32 v246, v246, v34
v_mul_f32 v247, v247, v34
v_mul_f32 v248, v248, v34
v_mul_f32 v249, v249, v34
v_mul_f32 v250, v250, v34
v_mul_f32 v251, v251, v34
v_mul_f32 v252, v252, v34
v_mul_f32 v253, v253, v34
v_mul_f32 v254, v254, v34
v_mul_f32 v255, v255, v34
v_accvgpr_write_b32 a16, v240
v_accvgpr_write_b32 a17, v241
v_accvgpr_write_b32 a18, v242
v_accvgpr_write_b32 a19, v243
v_accvgpr_write_b32 a20, v244
v_accvgpr_write_b32 a21, v245
v_accvgpr_write_b32 a22, v246
v_accvgpr_write_b32 a23, v247
v_accvgpr_write_b32 a24, v248
v_accvgpr_write_b32 a25, v249
v_accvgpr_write_b32 a26, v250
v_accvgpr_write_b32 a27, v251
v_accvgpr_write_b32 a28, v252
v_accvgpr_write_b32 a29, v253
v_accvgpr_write_b32 a30, v254
v_accvgpr_write_b32 a31, v255
v_accvgpr_read_b32 v240, a32
v_accvgpr_read_b32 v241, a33
v_accvgpr_read_b32 v242, a34
v_accvgpr_read_b32 v243, a35
v_accvgpr_read_b32 v244, a36
v_accvgpr_read_b32 v245, a37
v_accvgpr_read_b32 v246, a38
v_accvgpr_read_b32 v247, a39
v_accvgpr_read_b32 v248, a40
v_accvgpr_read_b32 v249, a41
v_accvgpr_read_b32 v250, a42
v_accvgpr_read_b32 v251, a43
v_accvgpr_read_b32 v252, a44
v_accvgpr_read_b32 v253, a45
v_accvgpr_read_b32 v254, a46
v_accvgpr_read_b32 v255, a47
v_mul_f32 v240, v240, v33
v_mul_f32 v241, v241, v33
v_mul_f32 v242, v242, v33
v_mul_f32 v243, v243, v33
v_mul_f32 v244, v244, v33
v_mul_f32 v245, v245, v33
v_mul_f32 v246, v246, v33
v_mul_f32 v247, v247, v33
v_mul_f32 v248, v248, v33
v_mul_f32 v249, v249, v33
v_mul_f32 v250, v250, v33
v_mul_f32 v251, v251, v33
v_mul_f32 v252, v252, v33
v_mul_f32 v253, v253, v33
v_mul_f32 v254, v254, v33
v_mul_f32 v255, v255, v33
v_accvgpr_write_b32 a32, v240
v_accvgpr_write_b32 a33, v241
v_accvgpr_write_b32 a34, v242
v_accvgpr_write_b32 a35, v243
v_accvgpr_write_b32 a36, v244
v_accvgpr_write_b32 a37, v245
v_accvgpr_write_b32 a38, v246
v_accvgpr_write_b32 a39, v247
v_accvgpr_write_b32 a40, v248
v_accvgpr_write_b32 a41, v249
v_accvgpr_write_b32 a42, v250
v_accvgpr_write_b32 a43, v251
v_accvgpr_write_b32 a44, v252
v_accvgpr_write_b32 a45, v253
v_accvgpr_write_b32 a46, v254
v_accvgpr_write_b32 a47, v255
v_accvgpr_read_b32 v240, a48
v_accvgpr_read_b32 v241, a49
v_accvgpr_read_b32 v242, a50
v_accvgpr_read_b32 v243, a51
v_accvgpr_read_b32 v244, a52
v_accvgpr_read_b32 v245, a53
v_accvgpr_read_b32 v246, a54
v_accvgpr_read_b32 v247, a55
v_accvgpr_read_b32 v248, a56
v_accvgpr_read_b32 v249, a57
v_accvgpr_read_b32 v250, a58
v_accvgpr_read_b32 v251, a59
v_accvgpr_read_b32 v252, a60
v_accvgpr_read_b32 v253, a61
v_accvgpr_read_b32 v254, a62
v_accvgpr_read_b32 v255, a63
v_mul_f32 v240, v240, v34
v_mul_f32 v241, v241, v34
v_mul_f32 v242, v242, v34
v_mul_f32 v243, v243, v34
v_mul_f32 v244, v244, v34
v_mul_f32 v245, v245, v34
v_mul_f32 v246, v246, v34
v_mul_f32 v247, v247, v34
v_mul_f32 v248, v248, v34
v_mul_f32 v249, v249, v34
v_mul_f32 v250, v250, v34
v_mul_f32 v251, v251, v34
v_mul_f32 v252, v252, v34
v_mul_f32 v253, v253, v34
v_mul_f32 v254, v254, v34
v_mul_f32 v255, v255, v34
v_accvgpr_write_b32 a48, v240
v_accvgpr_write_b32 a49, v241
v_accvgpr_write_b32 a50, v242
v_accvgpr_write_b32 a51, v243
v_accvgpr_write_b32 a52, v244
v_accvgpr_write_b32 a53, v245
v_accvgpr_write_b32 a54, v246
v_accvgpr_write_b32 a55, v247
v_accvgpr_write_b32 a56, v248
v_accvgpr_write_b32 a57, v249
v_accvgpr_write_b32 a58, v250
v_accvgpr_write_b32 a59, v251
v_accvgpr_write_b32 a60, v252
v_accvgpr_write_b32 a61, v253
v_accvgpr_write_b32 a62, v254
v_accvgpr_write_b32 a63, v255
v_accvgpr_read_b32 v240, a64
v_accvgpr_read_b32 v241, a65
v_accvgpr_read_b32 v242, a66
v_accvgpr_read_b32 v243, a67
v_accvgpr_read_b32 v244, a68
v_accvgpr_read_b32 v245, a69
v_accvgpr_read_b32 v246, a70
v_accvgpr_read_b32 v247, a71
v_accvgpr_read_b32 v248, a72
v_accvgpr_read_b32 v249, a73
v_accvgpr_read_b32 v250, a74
v_accvgpr_read_b32 v251, a75
v_accvgpr_read_b32 v252, a76
v_accvgpr_read_b32 v253, a77
v_accvgpr_read_b32 v254, a78
v_accvgpr_read_b32 v255, a79
v_mul_f32 v240, v240, v33
v_mul_f32 v241, v241, v33
v_mul_f32 v242, v242, v33
v_mul_f32 v243, v243, v33
v_mul_f32 v244, v244, v33
v_mul_f32 v245, v245, v33
v_mul_f32 v246, v246, v33
v_mul_f32 v247, v247, v33
v_mul_f32 v248, v248, v33
v_mul_f32 v249, v249, v33
v_mul_f32 v250, v250, v33
v_mul_f32 v251, v251, v33
v_mul_f32 v252, v252, v33
v_mul_f32 v253, v253, v33
v_mul_f32 v254, v254, v33
v_mul_f32 v255, v255, v33
v_accvgpr_write_b32 a64, v240
v_accvgpr_write_b32 a65, v241
v_accvgpr_write_b32 a66, v242
v_accvgpr_write_b32 a67, v243
v_accvgpr_write_b32 a68, v244
v_accvgpr_write_b32 a69, v245
v_accvgpr_write_b32 a70, v246
v_accvgpr_write_b32 a71, v247
v_accvgpr_write_b32 a72, v248
v_accvgpr_write_b32 a73, v249
v_accvgpr_write_b32 a74, v250
v_accvgpr_write_b32 a75, v251
v_accvgpr_write_b32 a76, v252
v_accvgpr_write_b32 a77, v253
v_accvgpr_write_b32 a78, v254
v_accvgpr_write_b32 a79, v255
v_accvgpr_read_b32 v240, a80
v_accvgpr_read_b32 v241, a81
v_accvgpr_read_b32 v242, a82
v_accvgpr_read_b32 v243, a83
v_accvgpr_read_b32 v244, a84
v_accvgpr_read_b32 v245, a85
v_accvgpr_read_b32 v246, a86
v_accvgpr_read_b32 v247, a87
v_accvgpr_read_b32 v248, a88
v_accvgpr_read_b32 v249, a89
v_accvgpr_read_b32 v250, a90
v_accvgpr_read_b32 v251, a91
v_accvgpr_read_b32 v252, a92
v_accvgpr_read_b32 v253, a93
v_accvgpr_read_b32 v254, a94
v_accvgpr_read_b32 v255, a95
v_mul_f32 v240, v240, v34
v_mul_f32 v241, v241, v34
v_mul_f32 v242, v242, v34
v_mul_f32 v243, v243, v34
v_mul_f32 v244, v244, v34
v_mul_f32 v245, v245, v34
v_mul_f32 v246, v246, v34
v_mul_f32 v247, v247, v34
v_mul_f32 v248, v248, v34
v_mul_f32 v249, v249, v34
v_mul_f32 v250, v250, v34
v_mul_f32 v251, v251, v34
v_mul_f32 v252, v252, v34
v_mul_f32 v253, v253, v34
v_mul_f32 v254, v254, v34
v_mul_f32 v255, v255, v34
v_accvgpr_write_b32 a80, v240
v_accvgpr_write_b32 a81, v241
v_accvgpr_write_b32 a82, v242
v_accvgpr_write_b32 a83, v243
v_accvgpr_write_b32 a84, v244
v_accvgpr_write_b32 a85, v245
v_accvgpr_write_b32 a86, v246
v_accvgpr_write_b32 a87, v247
v_accvgpr_write_b32 a88, v248
v_accvgpr_write_b32 a89, v249
v_accvgpr_write_b32 a90, v250
v_accvgpr_write_b32 a91, v251
v_accvgpr_write_b32 a92, v252
v_accvgpr_write_b32 a93, v253
v_accvgpr_write_b32 a94, v254
v_accvgpr_write_b32 a95, v255
v_accvgpr_read_b32 v240, a96
v_accvgpr_read_b32 v241, a97
v_accvgpr_read_b32 v242, a98
v_accvgpr_read_b32 v243, a99
v_accvgpr_read_b32 v244, a100
v_accvgpr_read_b32 v245, a101
v_accvgpr_read_b32 v246, a102
v_accvgpr_read_b32 v247, a103
v_accvgpr_read_b32 v248, a104
v_accvgpr_read_b32 v249, a105
v_accvgpr_read_b32 v250, a106
v_accvgpr_read_b32 v251, a107
v_accvgpr_read_b32 v252, a108
v_accvgpr_read_b32 v253, a109
v_accvgpr_read_b32 v254, a110
v_accvgpr_read_b32 v255, a111
v_mul_f32 v240, v240, v33
v_mul_f32 v241, v241, v33
v_mul_f32 v242, v242, v33
v_mul_f32 v243, v243, v33
v_mul_f32 v244, v244, v33
v_mul_f32 v245, v245, v33
v_mul_f32 v246, v246, v33
v_mul_f32 v247, v247, v33
v_mul_f32 v248, v248, v33
v_mul_f32 v249, v249, v33
v_mul_f32 v250, v250, v33
v_mul_f32 v251, v251, v33
v_mul_f32 v252, v252, v33
v_mul_f32 v253, v253, v33
v_mul_f32 v254, v254, v33
v_mul_f32 v255, v255, v33
v_accvgpr_write_b32 a96, v240
v_accvgpr_write_b32 a97, v241
v_accvgpr_write_b32 a98, v242
v_accvgpr_write_b32 a99, v243
v_accvgpr_write_b32 a100, v244
v_accvgpr_write_b32 a101, v245
v_accvgpr_write_b32 a102, v246
v_accvgpr_write_b32 a103, v247
v_accvgpr_write_b32 a104, v248
v_accvgpr_write_b32 a105, v249
v_accvgpr_write_b32 a106, v250
v_accvgpr_write_b32 a107, v251
v_accvgpr_write_b32 a108, v252
v_accvgpr_write_b32 a109, v253
v_accvgpr_write_b32 a110, v254
v_accvgpr_write_b32 a111, v255
v_accvgpr_read_b32 v240, a112
v_accvgpr_read_b32 v241, a113
v_accvgpr_read_b32 v242, a114
v_accvgpr_read_b32 v243, a115
v_accvgpr_read_b32 v244, a116
v_accvgpr_read_b32 v245, a117
v_accvgpr_read_b32 v246, a118
v_accvgpr_read_b32 v247, a119
v_accvgpr_read_b32 v248, a120
v_accvgpr_read_b32 v249, a121
v_accvgpr_read_b32 v250, a122
v_accvgpr_read_b32 v251, a123
v_accvgpr_read_b32 v252, a124
v_accvgpr_read_b32 v253, a125
v_accvgpr_read_b32 v254, a126
v_accvgpr_read_b32 v255, a127
v_mul_f32 v240, v240, v34
v_mul_f32 v241, v241, v34
v_mul_f32 v242, v242, v34
v_mul_f32 v243, v243, v34
v_mul_f32 v244, v244, v34
v_mul_f32 v245, v245, v34
v_mul_f32 v246, v246, v34
v_mul_f32 v247, v247, v34
v_mul_f32 v248, v248, v34
v_mul_f32 v249, v249, v34
v_mul_f32 v250, v250, v34
v_mul_f32 v251, v251, v34
v_mul_f32 v252, v252, v34
v_mul_f32 v253, v253, v34
v_mul_f32 v254, v254, v34
v_mul_f32 v255, v255, v34
v_accvgpr_write_b32 a112, v240
v_accvgpr_write_b32 a113, v241
v_accvgpr_write_b32 a114, v242
v_accvgpr_write_b32 a115, v243
v_accvgpr_write_b32 a116, v244
v_accvgpr_write_b32 a117, v245
v_accvgpr_write_b32 a118, v246
v_accvgpr_write_b32 a119, v247
v_accvgpr_write_b32 a120, v248
v_accvgpr_write_b32 a121, v249
v_accvgpr_write_b32 a122, v250
v_accvgpr_write_b32 a123, v251
v_accvgpr_write_b32 a124, v252
v_accvgpr_write_b32 a125, v253
v_accvgpr_write_b32 a126, v254
v_accvgpr_write_b32 a127, v255
s_nop 1
s_branch L_back_l11
L_rare_l12:
v_max_f32 v35, v35, v29
v_sub_f32 v33, v29, v35
v_mul_f32 v33, s62, v33
v_exp_f32 v33, v33
v_mov_b32 v29, v35
v_add_f32 v30, s67, v35
v_mul_f32 v31, s62, v35
v_mov_b32 v34, v33
v_mov_b32 v32, v31
s_nop 1
v_permlane32_swap_b32 v33, v34
v_permlane32_swap_b32 v31, v32
s_nop 1
v_mul_f32 v40, v40, v33
v_mul_f32 v41, v41, v33
v_mul_f32 v42, v42, v33
v_mul_f32 v43, v43, v33
v_mul_f32 v44, v44, v34
v_mul_f32 v45, v45, v34
v_mul_f32 v46, v46, v34
v_mul_f32 v47, v47, v34
v_accvgpr_read_b32 v240, a0
v_accvgpr_read_b32 v241, a1
v_accvgpr_read_b32 v242, a2
v_accvgpr_read_b32 v243, a3
v_accvgpr_read_b32 v244, a4
v_accvgpr_read_b32 v245, a5
v_accvgpr_read_b32 v246, a6
v_accvgpr_read_b32 v247, a7
v_accvgpr_read_b32 v248, a8
v_accvgpr_read_b32 v249, a9
v_accvgpr_read_b32 v250, a10
v_accvgpr_read_b32 v251, a11
v_accvgpr_read_b32 v252, a12
v_accvgpr_read_b32 v253, a13
v_accvgpr_read_b32 v254, a14
v_accvgpr_read_b32 v255, a15
v_mul_f32 v240, v240, v33
v_mul_f32 v241, v241, v33
v_mul_f32 v242, v242, v33
v_mul_f32 v243, v243, v33
v_mul_f32 v244, v244, v33
v_mul_f32 v245, v245, v33
v_mul_f32 v246, v246, v33
v_mul_f32 v247, v247, v33
v_mul_f32 v248, v248, v33
v_mul_f32 v249, v249, v33
v_mul_f32 v250, v250, v33
v_mul_f32 v251, v251, v33
v_mul_f32 v252, v252, v33
v_mul_f32 v253, v253, v33
v_mul_f32 v254, v254, v33
v_mul_f32 v255, v255, v33
v_accvgpr_write_b32 a0, v240
v_accvgpr_write_b32 a1, v241
v_accvgpr_write_b32 a2, v242
v_accvgpr_write_b32 a3, v243
v_accvgpr_write_b32 a4, v244
v_accvgpr_write_b32 a5, v245
v_accvgpr_write_b32 a6, v246
v_accvgpr_write_b32 a7, v247
v_accvgpr_write_b32 a8, v248
v_accvgpr_write_b32 a9, v249
v_accvgpr_write_b32 a10, v250
v_accvgpr_write_b32 a11, v251
v_accvgpr_write_b32 a12, v252
v_accvgpr_write_b32 a13, v253
v_accvgpr_write_b32 a14, v254
v_accvgpr_write_b32 a15, v255
v_accvgpr_read_b32 v240, a16
v_accvgpr_read_b32 v241, a17
v_accvgpr_read_b32 v242, a18
v_accvgpr_read_b32 v243, a19
v_accvgpr_read_b32 v244, a20
v_accvgpr_read_b32 v245, a21
v_accvgpr_read_b32 v246, a22
v_accvgpr_read_b32 v247, a23
v_accvgpr_read_b32 v248, a24
v_accvgpr_read_b32 v249, a25
v_accvgpr_read_b32 v250, a26
v_accvgpr_read_b32 v251, a27
v_accvgpr_read_b32 v252, a28
v_accvgpr_read_b32 v253, a29
v_accvgpr_read_b32 v254, a30
v_accvgpr_read_b32 v255, a31
v_mul_f32 v240, v240, v34
v_mul_f32 v241, v241, v34
v_mul_f32 v242, v242, v34
v_mul_f32 v243, v243, v34
v_mul_f32 v244, v244, v34
v_mul_f32 v245, v245, v34
v_mul_f32 v246, v246, v34
v_mul_f32 v247, v247, v34
v_mul_f32 v248, v248, v34
v_mul_f32 v249, v249, v34
v_mul_f32 v250, v250, v34
v_mul_f32 v251, v251, v34
v_mul_f32 v252, v252, v34
v_mul_f32 v253, v253, v34
v_mul_f32 v254, v254, v34
v_mul_f32 v255, v255, v34
v_accvgpr_write_b32 a16, v240
v_accvgpr_write_b32 a17, v241
v_accvgpr_write_b32 a18, v242
v_accvgpr_write_b32 a19, v243
v_accvgpr_write_b32 a20, v244
v_accvgpr_write_b32 a21, v245
v_accvgpr_write_b32 a22, v246
v_accvgpr_write_b32 a23, v247
v_accvgpr_write_b32 a24, v248
v_accvgpr_write_b32 a25, v249
v_accvgpr_write_b32 a26, v250
v_accvgpr_write_b32 a27, v251
v_accvgpr_write_b32 a28, v252
v_accvgpr_write_b32 a29, v253
v_accvgpr_write_b32 a30, v254
v_accvgpr_write_b32 a31, v255
v_accvgpr_read_b32 v240, a32
v_accvgpr_read_b32 v241, a33
v_accvgpr_read_b32 v242, a34
v_accvgpr_read_b32 v243, a35
v_accvgpr_read_b32 v244, a36
v_accvgpr_read_b32 v245, a37
v_accvgpr_read_b32 v246, a38
v_accvgpr_read_b32 v247, a39
v_accvgpr_read_b32 v248, a40
v_accvgpr_read_b32 v249, a41
v_accvgpr_read_b32 v250, a42
v_accvgpr_read_b32 v251, a43
v_accvgpr_read_b32 v252, a44
v_accvgpr_read_b32 v253, a45
v_accvgpr_read_b32 v254, a46
v_accvgpr_read_b32 v255, a47
v_mul_f32 v240, v240, v33
v_mul_f32 v241, v241, v33
v_mul_f32 v242, v242, v33
v_mul_f32 v243, v243, v33
v_mul_f32 v244, v244, v33
v_mul_f32 v245, v245, v33
v_mul_f32 v246, v246, v33
v_mul_f32 v247, v247, v33
v_mul_f32 v248, v248, v33
v_mul_f32 v249, v249, v33
v_mul_f32 v250, v250, v33
v_mul_f32 v251, v251, v33
v_mul_f32 v252, v252, v33
v_mul_f32 v253, v253, v33
v_mul_f32 v254, v254, v33
v_mul_f32 v255, v255, v33
v_accvgpr_write_b32 a32, v240
v_accvgpr_write_b32 a33, v241
v_accvgpr_write_b32 a34, v242
v_accvgpr_write_b32 a35, v243
v_accvgpr_write_b32 a36, v244
v_accvgpr_write_b32 a37, v245
v_accvgpr_write_b32 a38, v246
v_accvgpr_write_b32 a39, v247
v_accvgpr_write_b32 a40, v248
v_accvgpr_write_b32 a41, v249
v_accvgpr_write_b32 a42, v250
v_accvgpr_write_b32 a43, v251
v_accvgpr_write_b32 a44, v252
v_accvgpr_write_b32 a45, v253
v_accvgpr_write_b32 a46, v254
v_accvgpr_write_b32 a47, v255
v_accvgpr_read_b32 v240, a48
v_accvgpr_read_b32 v241, a49
v_accvgpr_read_b32 v242, a50
v_accvgpr_read_b32 v243, a51
v_accvgpr_read_b32 v244, a52
v_accvgpr_read_b32 v245, a53
v_accvgpr_read_b32 v246, a54
v_accvgpr_read_b32 v247, a55
v_accvgpr_read_b32 v248, a56
v_accvgpr_read_b32 v249, a57
v_accvgpr_read_b32 v250, a58
v_accvgpr_read_b32 v251, a59
v_accvgpr_read_b32 v252, a60
v_accvgpr_read_b32 v253, a61
v_accvgpr_read_b32 v254, a62
v_accvgpr_read_b32 v255, a63
v_mul_f32 v240, v240, v34
v_mul_f32 v241, v241, v34
v_mul_f32 v242, v242, v34
v_mul_f32 v243, v243, v34
v_mul_f32 v244, v244, v34
v_mul_f32 v245, v245, v34
v_mul_f32 v246, v246, v34
v_mul_f32 v247, v247, v34
v_mul_f32 v248, v248, v34
v_mul_f32 v249, v249, v34
v_mul_f32 v250, v250, v34
v_mul_f32 v251, v251, v34
v_mul_f32 v252, v252, v34
v_mul_f32 v253, v253, v34
v_mul_f32 v254, v254, v34
v_mul_f32 v255, v255, v34
v_accvgpr_write_b32 a48, v240
v_accvgpr_write_b32 a49, v241
v_accvgpr_write_b32 a50, v242
v_accvgpr_write_b32 a51, v243
v_accvgpr_write_b32 a52, v244
v_accvgpr_write_b32 a53, v245
v_accvgpr_write_b32 a54, v246
v_accvgpr_write_b32 a55, v247
v_accvgpr_write_b32 a56, v248
v_accvgpr_write_b32 a57, v249
v_accvgpr_write_b32 a58, v250
v_accvgpr_write_b32 a59, v251
v_accvgpr_write_b32 a60, v252
v_accvgpr_write_b32 a61, v253
v_accvgpr_write_b32 a62, v254
v_accvgpr_write_b32 a63, v255
v_accvgpr_read_b32 v240, a64
v_accvgpr_read_b32 v241, a65
v_accvgpr_read_b32 v242, a66
v_accvgpr_read_b32 v243, a67
v_accvgpr_read_b32 v244, a68
v_accvgpr_read_b32 v245, a69
v_accvgpr_read_b32 v246, a70
v_accvgpr_read_b32 v247, a71
v_accvgpr_read_b32 v248, a72
v_accvgpr_read_b32 v249, a73
v_accvgpr_read_b32 v250, a74
v_accvgpr_read_b32 v251, a75
v_accvgpr_read_b32 v252, a76
v_accvgpr_read_b32 v253, a77
v_accvgpr_read_b32 v254, a78
v_accvgpr_read_b32 v255, a79
v_mul_f32 v240, v240, v33
v_mul_f32 v241, v241, v33
v_mul_f32 v242, v242, v33
v_mul_f32 v243, v243, v33
v_mul_f32 v244, v244, v33
v_mul_f32 v245, v245, v33
v_mul_f32 v246, v246, v33
v_mul_f32 v247, v247, v33
v_mul_f32 v248, v248, v33
v_mul_f32 v249, v249, v33
v_mul_f32 v250, v250, v33
v_mul_f32 v251, v251, v33
v_mul_f32 v252, v252, v33
v_mul_f32 v253, v253, v33
v_mul_f32 v254, v254, v33
v_mul_f32 v255, v255, v33
v_accvgpr_write_b32 a64, v240
v_accvgpr_write_b32 a65, v241
v_accvgpr_write_b32 a66, v242
v_accvgpr_write_b32 a67, v243
v_accvgpr_write_b32 a68, v244
v_accvgpr_write_b32 a69, v245
v_accvgpr_write_b32 a70, v246
v_accvgpr_write_b32 a71, v247
v_accvgpr_write_b32 a72, v248
v_accvgpr_write_b32 a73, v249
v_accvgpr_write_b32 a74, v250
v_accvgpr_write_b32 a75, v251
v_accvgpr_write_b32 a76, v252
v_accvgpr_write_b32 a77, v253
v_accvgpr_write_b32 a78, v254
v_accvgpr_write_b32 a79, v255
v_accvgpr_read_b32 v240, a80
v_accvgpr_read_b32 v241, a81
v_accvgpr_read_b32 v242, a82
v_accvgpr_read_b32 v243, a83
v_accvgpr_read_b32 v244, a84
v_accvgpr_read_b32 v245, a85
v_accvgpr_read_b32 v246, a86
v_accvgpr_read_b32 v247, a87
v_accvgpr_read_b32 v248, a88
v_accvgpr_read_b32 v249, a89
v_accvgpr_read_b32 v250, a90
v_accvgpr_read_b32 v251, a91
v_accvgpr_read_b32 v252, a92
v_accvgpr_read_b32 v253, a93
v_accvgpr_read_b32 v254, a94
v_accvgpr_read_b32 v255, a95
v_mul_f32 v240, v240, v34
v_mul_f32 v241, v241, v34
v_mul_f32 v242, v242, v34
v_mul_f32 v243, v243, v34
v_mul_f32 v244, v244, v34
v_mul_f32 v245, v245, v34
v_mul_f32 v246, v246, v34
v_mul_f32 v247, v247, v34
v_mul_f32 v248, v248, v34
v_mul_f32 v249, v249, v34
v_mul_f32 v250, v250, v34
v_mul_f32 v251, v251, v34
v_mul_f32 v252, v252, v34
v_mul_f32 v253, v253, v34
v_mul_f32 v254, v254, v34
v_mul_f32 v255, v255, v34
v_accvgpr_write_b32 a80, v240
v_accvgpr_write_b32 a81, v241
v_accvgpr_write_b32 a82, v242
v_accvgpr_write_b32 a83, v243
v_accvgpr_write_b32 a84, v244
v_accvgpr_write_b32 a85, v245
v_accvgpr_write_b32 a86, v246
v_accvgpr_write_b32 a87, v247
v_accvgpr_write_b32 a88, v248
v_accvgpr_write_b32 a89, v249
v_accvgpr_write_b32 a90, v250
v_accvgpr_write_b32 a91, v251
v_accvgpr_write_b32 a92, v252
v_accvgpr_write_b32 a93, v253
v_accvgpr_write_b32 a94, v254
v_accvgpr_write_b32 a95, v255
v_accvgpr_read_b32 v240, a96
v_accvgpr_read_b32 v241, a97
v_accvgpr_read_b32 v242, a98
v_accvgpr_read_b32 v243, a99
v_accvgpr_read_b32 v244, a100
v_accvgpr_read_b32 v245, a101
v_accvgpr_read_b32 v246, a102
v_accvgpr_read_b32 v247, a103
v_accvgpr_read_b32 v248, a104
v_accvgpr_read_b32 v249, a105
v_accvgpr_read_b32 v250, a106
v_accvgpr_read_b32 v251, a107
v_accvgpr_read_b32 v252, a108
v_accvgpr_read_b32 v253, a109
v_accvgpr_read_b32 v254, a110
v_accvgpr_read_b32 v255, a111
v_mul_f32 v240, v240, v33
v_mul_f32 v241, v241, v33
v_mul_f32 v242, v242, v33
v_mul_f32 v243, v243, v33
v_mul_f32 v244, v244, v33
v_mul_f32 v245, v245, v33
v_mul_f32 v246, v246, v33
v_mul_f32 v247, v247, v33
v_mul_f32 v248, v248, v33
v_mul_f32 v249, v249, v33
v_mul_f32 v250, v250, v33
v_mul_f32 v251, v251, v33
v_mul_f32 v252, v252, v33
v_mul_f32 v253, v253, v33
v_mul_f32 v254, v254, v33
v_mul_f32 v255, v255, v33
v_accvgpr_write_b32 a96, v240
v_accvgpr_write_b32 a97, v241
v_accvgpr_write_b32 a98, v242
v_accvgpr_write_b32 a99, v243
v_accvgpr_write_b32 a100, v244
v_accvgpr_write_b32 a101, v245
v_accvgpr_write_b32 a102, v246
v_accvgpr_write_b32 a103, v247
v_accvgpr_write_b32 a104, v248
v_accvgpr_write_b32 a105, v249
v_accvgpr_write_b32 a106, v250
v_accvgpr_write_b32 a107, v251
v_accvgpr_write_b32 a108, v252
v_accvgpr_write_b32 a109, v253
v_accvgpr_write_b32 a110, v254
v_accvgpr_write_b32 a111, v255
v_accvgpr_read_b32 v240, a112
v_accvgpr_read_b32 v241, a113
v_accvgpr_read_b32 v242, a114
v_accvgpr_read_b32 v243, a115
v_accvgpr_read_b32 v244, a116
v_accvgpr_read_b32 v245, a117
v_accvgpr_read_b32 v246, a118
v_accvgpr_read_b32 v247, a119
v_accvgpr_read_b32 v248, a120
v_accvgpr_read_b32 v249, a121
v_accvgpr_read_b32 v250, a122
v_accvgpr_read_b32 v251, a123
v_accvgpr_read_b32 v252, a124
v_accvgpr_read_b32 v253, a125
v_accvgpr_read_b32 v254, a126
v_accvgpr_read_b32 v255, a127
v_mul_f32 v240, v240, v34
v_mul_f32 v241, v241, v34
v_mul_f32 v242, v242, v34
v_mul_f32 v243, v243, v34
v_mul_f32 v244, v244, v34
v_mul_f32 v245, v245, v34
v_mul_f32 v246, v246, v34
v_mul_f32 v247, v247, v34
v_mul_f32 v248, v248, v34
v_mul_f32 v249, v249, v34
v_mul_f32 v250, v250, v34
v_mul_f32 v251, v251, v34
v_mul_f32 v252, v252, v34
v_mul_f32 v253, v253, v34
v_mul_f32 v254, v254, v34
v_mul_f32 v255, v255, v34
v_accvgpr_write_b32 a112, v240
v_accvgpr_write_b32 a113, v241
v_accvgpr_write_b32 a114, v242
v_accvgpr_write_b32 a115, v243
v_accvgpr_write_b32 a116, v244
v_accvgpr_write_b32 a117, v245
v_accvgpr_write_b32 a118, v246
v_accvgpr_write_b32 a119, v247
v_accvgpr_write_b32 a120, v248
v_accvgpr_write_b32 a121, v249
v_accvgpr_write_b32 a122, v250
v_accvgpr_write_b32 a123, v251
v_accvgpr_write_b32 a124, v252
v_accvgpr_write_b32 a125, v253
v_accvgpr_write_b32 a126, v254
v_accvgpr_write_b32 a127, v255
s_nop 1
s_branch L_back_l12
.section .rodata,"a"
.p2align 6
.amdhsa_kernel concat_heads__mha_block_cached__mha_block_cached__near_ridge_kernel
  .amdhsa_next_free_vgpr 512
  .amdhsa_next_free_sgpr 102
  .amdhsa_accum_offset 256
  .amdhsa_group_segment_fixed_size 0
  .amdhsa_kernarg_size 104
  .amdhsa_user_sgpr_count 2
  .amdhsa_user_sgpr_kernarg_segment_ptr 1
  .amdhsa_system_sgpr_workgroup_id_x 1
.end_amdhsa_kernel
```
